```python
import torch

def _softmax(x, axis=-1):
    return torch.softmax(x, dim=axis)
def _gelu(x):
    return torch.nn.functional.gelu(x, approximate="tanh")
def _silu(x):
    return torch.nn.functional.silu(x)
def _sigmoid(x):
    return torch.sigmoid(x)
def _layernorm(x, axis=-1, eps=1e-5):
    m = x.mean(dim=axis, keepdim=True)
    v = x.var(dim=axis, keepdim=True, unbiased=False)
    return (x - m) / torch.sqrt(v + eps)
def _scatter_add(tgt, idx, src, axis=0):
    return tgt.clone().index_add_(axis, idx, src)
def _segment_sum(src, seg, n):
    out = torch.zeros((n,) + src.shape[1:], dtype=src.dtype)
    return out.index_add_(0, seg, src)
def _pad(x, pw):
    flat = tuple(v for pair in reversed(pw) for v in pair)
    return torch.nn.functional.pad(x, flat)

kernel_name = 'standalone__gqa_block_cached__near_ridge'

def setup_inputs():

    _w = (lambda a: (lambda t: t.to(torch.bfloat16) if t.is_floating_point() else t)(torch.as_tensor(a)))
    B, Sq, D = 8, 160, 640
    Hq, Hkv, Sk, Dh = 32, 32, 1024, 128
    assert Hq % Hkv == 0, (Hq, Hkv)
    return {
        "x": _w((lambda *s: torch.randn(*s, dtype=torch.bfloat16) * 0.8)(B, Sq, D)),
        "k_cache": _w((lambda *s: torch.randn(*s, dtype=torch.bfloat16) * 0.8)(B, Hkv, Sk, Dh)),
        "v_cache": _w((lambda *s: torch.randn(*s, dtype=torch.bfloat16) * 0.05)(B, Hkv, Sk, Dh)),
        "wq": _w((lambda *s: torch.randn(*s, dtype=torch.bfloat16) * 0.8)(D, Hq * Dh) * (D ** -0.5)),
        "wo": _w((lambda *s: torch.randn(*s, dtype=torch.bfloat16) * 0.05)(Hq * Dh, D) * ((Hq * Dh) ** -0.5)),
    }

def reference(x, k_cache, v_cache, wq, wo):
    B, Sq, D = x.shape
    Hq, Dh = 32, 128
    Hkv = k_cache.shape[1]
    rep = Hq // Hkv
    q = (lambda x, *d: x.permute(*d))((x @ wq).reshape(B, Sq, Hq, Dh), 0, 2, 1, 3)
    k = (lambda x, n, axis: torch.repeat_interleave(x, n, dim=axis))(k_cache, rep, axis=1)
    v = (lambda x, n, axis: torch.repeat_interleave(x, n, dim=axis))(v_cache, rep, axis=1)
    scores = torch.einsum("bhqd,bhkd->bhqk", q, k) * (Dh ** -0.5)
    p = _softmax(scores, axis=-1)
    o = torch.einsum("bhqk,bhkd->bhqd", p, v)
    return (lambda x, *d: x.permute(*d))(o, 0, 2, 1, 3).reshape(B, Sq, Hq * Dh) @ wo
```

```asm
; @launch grid=(256,1,1) block=(256,1,1) lds=163840
.amdgcn_target "amdgcn-amd-amdhsa--gfx950"
.text
.globl standalone__gqa_block_cached__near_ridge_kernel
.p2align 8
.type standalone__gqa_block_cached__near_ridge_kernel,@function
standalone__gqa_block_cached__near_ridge_kernel:
  s_cmpk_ge_u32 s2, 256
  s_cbranch_scc1 L1_done
  s_load_dwordx8 s[4:11], s[0:1], 0
  s_mov_b32 s79, 0x20000
  s_getpc_b64 s[76:77]
  s_movk_i32 s78, 3072
  v_lshlrev_b32 v254, 7, v0
  buffer_load_dword v245, v254, s[76:79], 0 offen
  v_lshrrev_b32 v3, 6, v0
  v_and_b32 v1, 63, v0
  v_readfirstlane_b32 s42, v3
  s_and_b32 s48, s2, 1
  s_lshr_b32 s50, s2, 6
  s_lshl2_add_u32 s40, s48, s50
  s_bfe_u32 s93, s2, 131073
  s_bfe_u32 s92, s2, 196611
  s_lshl3_add_u32 s41, s93, s92
  s_lshl1_add_u32 s43, s50, s92
  s_and_b32 s43, s43, 7
  v_lshrrev_b32 v36, 4, v1
  v_and_b32 v37, 15, v1
  s_lshl_b32 s47, s42, 12
  s_lshl_b32 s56, s42, 17
  v_lshlrev_b32 v3, 1, v36
  v_xor_b32 v3, v3, v37
  v_lshlrev_b32 v3, 4, v3
  v_lshl_add_u32 v180, v36, 13, v3
  v_xor_b32 v182, 128, v180
  s_mov_b32 s27, s79
  s_lshl_b32 s48, s41, 8
  s_sub_u32 s26, 5242880, s48
  s_lshl_b32 s44, s43, 19
  s_add_u32 m0, s47, 126976
  s_add_u32 s44, s44, s56
  s_waitcnt lgkmcnt(0)
  s_add_u32 s24, s10, s48
  s_addc_u32 s25, s11, 0
  buffer_load_dwordx4 v180, s[24:27], s44 offen lds
  s_addk_i32 s44, 31744
  buffer_load_dwordx4 v180, s[24:27], s44 offen offset:1024 lds
  s_addk_i32 s44, 31744
  buffer_load_dwordx4 v182, s[24:27], s44 offen offset:2048 lds
  s_addk_i32 s44, 31744
  buffer_load_dwordx4 v182, s[24:27], s44 offen offset:3072 lds
  v_lshrrev_b32 v38, 3, v1
  v_and_b32 v39, 7, v1
  s_mul_i32 s57, s42, 5120
  v_lshrrev_b32 v3, 1, v38
  v_xor_b32 v3, v3, v39
  v_lshlrev_b32 v3, 4, v3
  v_and_b32 v39, 64, v0
  v_xor_b32 v3, v39, v3
  s_mul_i32 s48, s57, 10
  v_mul_u32_u24 v38, 1280, v38
  v_add3_u32 v184, v38, v3, s48
  v_xor_b32 v185, 64, v184
  s_mov_b32 s22, 204800
  s_mul_i32 s48, s40, s22
  s_add_u32 s20, s4, s48
  s_addc_u32 s21, s5, 0
  s_mov_b32 s23, s79
  s_add_u32 m0, s57, 143360
  s_lshl_b32 s45, s43, 7
  buffer_load_dwordx4 v184, s[20:23], s45 offen lds
  s_addk_i32 s45, 9216
  buffer_load_dwordx4 v185, s[20:23], s45 offen offset:1024 lds
  s_addk_i32 s45, 9216
  buffer_load_dwordx4 v184, s[20:23], s45 offen offset:2048 lds
  s_addk_i32 s45, 9216
  buffer_load_dwordx4 v185, s[20:23], s45 offen offset:3072 lds
  s_addk_i32 m0, 4096
  s_addk_i32 s45, 13312
  buffer_load_dwordx4 v184, s[20:23], s45 offen lds
  s_add_u32 s43, s43, 1
  s_cmp_eq_u32 s43, 10
  s_cselect_b32 s43, 0, s43
  s_and_b32 s58, s42, 1
  v_add_u32 v181, 31744, v180
  v_add_u32 v183, 95232, v182
  v_add_u32 v182, 63488, v182
  v_add_u32 v186, 18432, v184
  v_add_u32 v187, 27648, v185
  v_add_u32 v188, 40960, v184
  v_add_u32 v185, 9216, v185
  s_load_dwordx8 s[12:19], s[0:1], 32
  s_getpc_b64 s[76:77]
Lpc0:
  s_and_b32 s76, s76, 0xffffff80
  s_mov_b32 s78, L1_done-Lpc0
  s_mov_b32 s79, 0x20000
  s_lshr_b32 s48, s2, 3
  s_and_b32 s48, s48, 7
  s_lshl_b32 s48, s48, 2
  s_add_u32 s48, s48, s42
  s_mul_i32 s48, s48, 2048
  v_lshlrev_b32 v254, 7, v1
  v_cmp_gt_u32 vcc, 16, v1
  v_mov_b32 v229, 1073741824
  s_nop 0
  v_cndmask_b32 v254, v229, v254, vcc
  buffer_load_dword v229, v254, s[76:79], s48 offen
  s_lshr_b32 s59, s42, 1
  v_lshrrev_b32 v204, 4, v1
  v_bfe_u32 v205, v1, 2, 2
  v_and_b32 v206, 3, v1
  v_and_b32 v207, 15, v1
  v_and_b32 v209, 1, v204
  v_lshl_add_u32 v209, v209, 2, v205
  v_lshl_add_u32 v210, v204, 3, v205
  v_lshlrev_b32 v210, 8, v210
  v_lshl_add_u32 v210, v206, 3, v210
  s_lshl_b32 s48, s59, 2
  v_xor_b32 v208, s48, v209
  v_lshl_add_u32 v210, v208, 5, v210
  v_xor_b32 v208, 0, v210
  v_add_u32 v190, 53248, v208
  v_add_u32 v196, 126976, v208
  v_xor_b32 v208, 32, v210
  v_add_u32 v191, 53248, v208
  v_add_u32 v197, 126976, v208
  v_xor_b32 v208, 64, v210
  v_add_u32 v192, 53248, v208
  v_add_u32 v198, 126976, v208
  v_xor_b32 v208, 96, v210
  v_add_u32 v193, 53248, v208
  v_add_u32 v199, 126976, v208
  v_lshrrev_b32 v208, 1, v207
  v_xor_b32 v208, v208, v204
  v_lshlrev_b32 v208, 4, v208
  v_lshl_add_u32 v210, v207, 7, v208
  s_mul_i32 s48, s58, 10240
  s_add_u32 s50, s48, 69632
  s_add_u32 s51, s48, 143360
  v_xor_b32 v208, 64, v210
  v_add_u32 v194, s50, v210
  v_add_u32 v195, s50, v208
  v_add_u32 v200, s51, v210
  v_add_u32 v201, s51, v208
  s_lshl_b32 s44, s43, 19
  s_add_u32 m0, s47, 53248
  s_add_u32 s44, s44, s56
  buffer_load_dwordx4 v180, s[24:27], s44 offen lds
  buffer_load_dwordx4 v181, s[24:27], s44 offen offset:1024 lds
  buffer_load_dwordx4 v182, s[24:27], s44 offen offset:2048 lds
  buffer_load_dwordx4 v183, s[24:27], s44 offen offset:3072 lds
  s_add_u32 m0, s57, 69632
  s_lshl_b32 s45, s43, 7
  buffer_load_dwordx4 v184, s[20:23], s45 offen lds
  buffer_load_dwordx4 v185, s[20:23], s45 offen offset:1024 lds
  buffer_load_dwordx4 v186, s[20:23], s45 offen offset:2048 lds
  buffer_load_dwordx4 v187, s[20:23], s45 offen offset:3072 lds
  s_add_u32 m0, s57, 73728
  s_add_u32 s43, s43, 1
  s_cmp_eq_u32 s43, 10
  s_cselect_b32 s43, 0, s43
  buffer_load_dwordx4 v188, s[20:23], s45 offen lds
  s_lshl_b32 s51, s40, 5
  s_add_u32 s51, s51, s41
  s_lshl_b32 s51, s51, 18
  v_lshlrev_b32 v3, 1, v36
  v_xor_b32 v3, v3, v37
  v_lshlrev_b32 v3, 4, v3
  v_lshl_add_u32 v8, v36, 8, v3
  v_xor_b32 v9, 128, v8
  v_lshlrev_b32 v2, 4, v1
  v_add_u32 v3, 0, v36
  v_xor_b32 v3, v3, v37
  v_lshlrev_b32 v3, 4, v3
  v_lshl_add_u32 v4, v36, 8, v3
  v_add_u32 v3, 4, v36
  v_xor_b32 v3, v3, v37
  v_lshlrev_b32 v3, 4, v3
  v_lshl_add_u32 v5, v36, 8, v3
  v_add_u32 v3, 8, v36
  v_xor_b32 v3, v3, v37
  v_lshlrev_b32 v3, 4, v3
  v_lshl_add_u32 v6, v36, 8, v3
  v_add_u32 v3, 12, v36
  v_xor_b32 v3, v3, v37
  v_lshlrev_b32 v3, 4, v3
  v_lshl_add_u32 v7, v36, 8, v3
  s_add_u32 s28, s6, s51
  s_addc_u32 s29, s7, 0
  s_mov_b32 s30, 262144
  s_mov_b32 s31, 0x20000
  s_add_u32 s32, s8, s51
  s_addc_u32 s33, s9, 0
  s_mov_b32 s34, 262144
  s_mov_b32 s35, 0x20000
  s_mov_b32 s49, 0x47800000
  s_mov_b32 s54, 0x3e0293ee
  s_mov_b32 s55, 0x3e0293ee
  s_lshl_b32 s48, s59, 13
  v_xor_b32 v208, v207, v204
  v_lshlrev_b32 v208, 4, v208
  v_lshl_add_u32 v210, v207, 8, v208
  v_add_u32 v210, s48, v210
  v_xor_b32 v10, 0, v210
  v_xor_b32 v11, 64, v210
  v_xor_b32 v12, 128, v210
  v_xor_b32 v13, 192, v210
  v_lshl_add_u32 v210, v204, 2, v205
  v_lshlrev_b32 v210, 8, v210
  v_lshl_add_u32 v210, v206, 3, v210
  s_add_u32 s48, s48, 65536
  v_add_u32 v210, s48, v210
  s_lshl_b32 s48, s59, 2
  v_xor_b32 v208, s48, v209
  v_lshl_add_u32 v210, v208, 5, v210
  v_xor_b32 v14, 0, v210
  v_xor_b32 v15, 32, v210
  v_xor_b32 v16, 64, v210
  v_xor_b32 v17, 96, v210
  v_xor_b32 v18, 128, v210
  v_xor_b32 v19, 160, v210
  v_xor_b32 v20, 192, v210
  v_xor_b32 v21, 224, v210
  v_mov_b32 v22, 0
  v_mov_b32 v23, 0
  v_mov_b32 v24, 0
  v_mov_b32 v25, 0
  v_mov_b32 v26, 0
  s_waitcnt lgkmcnt(0)
  s_mov_b32 s36, s18
  s_mov_b32 s37, s19
  s_mov_b32 s38, 33554432
  s_mov_b32 s39, 0x20000
  s_lshl_b32 s3, s92, 2
  s_lshl1_add_u32 s4, s59, s3
  s_mul_i32 s48, s59, 14
  s_add_u32 s3, s3, s48
  s_add_u32 s3, s3, 2
  s_lshl_b32 s100, s93, 5
  s_lshl_b32 s101, s40, 7
  s_add_u32 s101, s101, s100
  s_mul_i32 s101, s101, 10240
  s_mul_i32 s48, s58, 5120
  s_add_u32 s101, s101, s48
  s_mul_i32 s48, s92, 160
  s_add_u32 s80, s12, s48
  s_addc_u32 s81, s13, 0
  s_sub_u32 s82, 5242880, s48
  s_mov_b32 s83, 0x20000
  s_mov_b32 s84, s16
  s_mov_b32 s85, s17
  s_mov_b32 s86, 256
  s_mov_b32 s87, 0x20000
  s_mov_b32 s88, s14
  s_mov_b32 s89, s15
  s_mov_b32 s90, 1638400
  s_mov_b32 s91, 0x20000
  v_add_u32 v208, 0, v1
  v_mul_u32_u24 v210, 6554, v208
  v_lshrrev_b32 v210, 16, v210
  v_mul_u32_u24 v254, 1120, v210
  v_lshl_add_u32 v224, v208, 4, v254
  v_add_u32 v208, 64, v1
  v_mul_u32_u24 v210, 6554, v208
  v_lshrrev_b32 v210, 16, v210
  v_mul_u32_u24 v254, 1120, v210
  v_lshl_add_u32 v225, v208, 4, v254
  v_subrev_u32 v225, 1024, v225
  v_add_u32 v208, 128, v1
  v_mul_u32_u24 v210, 6554, v208
  v_lshrrev_b32 v210, 16, v210
  v_mul_u32_u24 v254, 1120, v210
  v_lshl_add_u32 v226, v208, 4, v254
  v_subrev_u32 v226, 2048, v226
  v_add_u32 v208, 192, v1
  v_mul_u32_u24 v210, 6554, v208
  v_lshrrev_b32 v210, 16, v210
  v_mul_u32_u24 v254, 1120, v210
  v_lshl_add_u32 v227, v208, 4, v254
  v_subrev_u32 v227, 3072, v227
  v_add_u32 v208, 256, v1
  v_mul_u32_u24 v210, 6554, v208
  v_lshrrev_b32 v210, 16, v210
  v_mul_u32_u24 v254, 1120, v210
  v_lshl_add_u32 v228, v208, 4, v254
  s_waitcnt vmcnt(10)
  s_barrier
  ds_read_b128 a[16:19], v200
  ds_read_b64_tr_b16 a[0:1], v196
  ds_read_b64_tr_b16 a[2:3], v196 offset:1024
  ds_read_b128 a[20:23], v200 offset:2048
  ds_read_b128 a[24:27], v200 offset:4096
  ds_read_b128 a[28:31], v200 offset:6144
  ds_read_b128 a[32:35], v200 offset:8192
  ds_read_b64_tr_b16 a[4:5], v197
  ds_read_b64_tr_b16 a[6:7], v197 offset:1024
  ds_read_b64_tr_b16 a[8:9], v198
  ds_read_b64_tr_b16 a[10:11], v198 offset:1024
  ds_read_b64_tr_b16 a[12:13], v199
  ds_read_b64_tr_b16 a[14:15], v199 offset:1024
  s_waitcnt lgkmcnt(6)
  v_mfma_f32_16x16x32_bf16 v[40:43], a[0:3], a[16:19], 0
  ds_read_b128 a[52:55], v201
  v_mfma_f32_16x16x32_bf16 v[44:47], a[0:3], a[20:23], 0
  ds_read_b64_tr_b16 a[36:37], v196 offset:8192
  s_lshl_b32 s44, s43, 19
  s_add_u32 m0, s47, 90112
  s_add_u32 s44, s44, s56
  buffer_load_dwordx4 v180, s[24:27], s44 offen lds
  v_mfma_f32_16x16x32_bf16 v[48:51], a[0:3], a[24:27], 0
  ds_read_b64_tr_b16 a[38:39], v196 offset:9216
  v_mfma_f32_16x16x32_bf16 v[52:55], a[0:3], a[28:31], 0
  ds_read_b128 a[56:59], v201 offset:2048
  buffer_load_dwordx4 v181, s[24:27], s44 offen offset:1024 lds
  v_mfma_f32_16x16x32_bf16 v[56:59], a[0:3], a[32:35], 0
  ds_read_b128 a[60:63], v201 offset:4096
  s_waitcnt lgkmcnt(5)
  v_mfma_f32_16x16x32_bf16 v[60:63], a[4:7], a[16:19], 0
  ds_read_b128 a[64:67], v201 offset:6144
  buffer_load_dwordx4 v182, s[24:27], s44 offen offset:2048 lds
  v_mfma_f32_16x16x32_bf16 v[64:67], a[4:7], a[20:23], 0
  ds_read_b128 a[68:71], v201 offset:8192
  v_mfma_f32_16x16x32_bf16 v[68:71], a[4:7], a[24:27], 0
  ds_read_b64_tr_b16 a[40:41], v197 offset:8192
  buffer_load_dwordx4 v183, s[24:27], s44 offen offset:3072 lds
  v_mfma_f32_16x16x32_bf16 v[72:75], a[4:7], a[28:31], 0
  ds_read_b64_tr_b16 a[42:43], v197 offset:9216
  v_mfma_f32_16x16x32_bf16 v[76:79], a[4:7], a[32:35], 0
  ds_read_b64_tr_b16 a[44:45], v198 offset:8192
  s_add_u32 m0, s57, 106496
  s_lshl_b32 s45, s43, 7
  buffer_load_dwordx4 v184, s[20:23], s45 offen lds
  v_mfma_f32_16x16x32_bf16 v[80:83], a[8:11], a[16:19], 0
  ds_read_b64_tr_b16 a[46:47], v198 offset:9216
  v_mfma_f32_16x16x32_bf16 v[84:87], a[8:11], a[20:23], 0
  ds_read_b64_tr_b16 a[48:49], v199 offset:8192
  buffer_load_dwordx4 v185, s[20:23], s45 offen offset:1024 lds
  v_mfma_f32_16x16x32_bf16 v[88:91], a[8:11], a[24:27], 0
  ds_read_b64_tr_b16 a[50:51], v199 offset:9216
  v_mfma_f32_16x16x32_bf16 v[92:95], a[8:11], a[28:31], 0
  buffer_load_dwordx4 v186, s[20:23], s45 offen offset:2048 lds
  v_mfma_f32_16x16x32_bf16 v[96:99], a[8:11], a[32:35], 0
  v_mfma_f32_16x16x32_bf16 v[100:103], a[12:15], a[16:19], 0
  buffer_load_dwordx4 v187, s[20:23], s45 offen offset:3072 lds
  v_mfma_f32_16x16x32_bf16 v[104:107], a[12:15], a[20:23], 0
  v_mfma_f32_16x16x32_bf16 v[108:111], a[12:15], a[24:27], 0
  s_add_u32 m0, s57, 110592
  s_add_u32 s43, s43, 1
  s_cmp_eq_u32 s43, 10
  s_cselect_b32 s43, 0, s43
  buffer_load_dwordx4 v188, s[20:23], s45 offen lds
  v_mfma_f32_16x16x32_bf16 v[112:115], a[12:15], a[28:31], 0
  v_mfma_f32_16x16x32_bf16 v[116:119], a[12:15], a[32:35], 0
  s_waitcnt lgkmcnt(0)
  v_mfma_f32_16x16x32_bf16 v[40:43], a[36:39], a[52:55], v[40:43]
  v_mfma_f32_16x16x32_bf16 v[44:47], a[36:39], a[56:59], v[44:47]
  v_mfma_f32_16x16x32_bf16 v[48:51], a[36:39], a[60:63], v[48:51]
  v_mfma_f32_16x16x32_bf16 v[52:55], a[36:39], a[64:67], v[52:55]
  v_mfma_f32_16x16x32_bf16 v[56:59], a[36:39], a[68:71], v[56:59]
  v_mfma_f32_16x16x32_bf16 v[60:63], a[40:43], a[52:55], v[60:63]
  s_waitcnt vmcnt(9)
  s_barrier
  ds_read_b128 a[16:19], v194
  v_mfma_f32_16x16x32_bf16 v[64:67], a[40:43], a[56:59], v[64:67]
  ds_read_b64_tr_b16 a[0:1], v190
  s_lshl_b32 s44, s43, 19
  s_add_u32 m0, s47, 126976
  s_add_u32 s44, s44, s56
  buffer_load_dwordx4 v180, s[24:27], s44 offen lds
  v_mfma_f32_16x16x32_bf16 v[68:71], a[40:43], a[60:63], v[68:71]
  ds_read_b64_tr_b16 a[2:3], v190 offset:1024
  v_mfma_f32_16x16x32_bf16 v[72:75], a[40:43], a[64:67], v[72:75]
  ds_read_b128 a[20:23], v194 offset:2048
  v_mfma_f32_16x16x32_bf16 v[76:79], a[40:43], a[68:71], v[76:79]
  ds_read_b128 a[24:27], v194 offset:4096
  buffer_load_dwordx4 v181, s[24:27], s44 offen offset:1024 lds
  v_mfma_f32_16x16x32_bf16 v[80:83], a[44:47], a[52:55], v[80:83]
  ds_read_b128 a[28:31], v194 offset:6144
  v_mfma_f32_16x16x32_bf16 v[84:87], a[44:47], a[56:59], v[84:87]
  ds_read_b128 a[32:35], v194 offset:8192
  v_mfma_f32_16x16x32_bf16 v[88:91], a[44:47], a[60:63], v[88:91]
  buffer_load_dwordx4 v182, s[24:27], s44 offen offset:2048 lds
  v_mfma_f32_16x16x32_bf16 v[92:95], a[44:47], a[64:67], v[92:95]
  ds_read_b64_tr_b16 a[4:5], v191
  v_mfma_f32_16x16x32_bf16 v[96:99], a[44:47], a[68:71], v[96:99]
  ds_read_b64_tr_b16 a[6:7], v191 offset:1024
  v_mfma_f32_16x16x32_bf16 v[100:103], a[48:51], a[52:55], v[100:103]
  ds_read_b64_tr_b16 a[8:9], v192
  buffer_load_dwordx4 v183, s[24:27], s44 offen offset:3072 lds
  v_mfma_f32_16x16x32_bf16 v[104:107], a[48:51], a[56:59], v[104:107]
  ds_read_b64_tr_b16 a[10:11], v192 offset:1024
  v_mfma_f32_16x16x32_bf16 v[108:111], a[48:51], a[60:63], v[108:111]
  ds_read_b64_tr_b16 a[12:13], v193
  v_mfma_f32_16x16x32_bf16 v[112:115], a[48:51], a[64:67], v[112:115]
  ds_read_b64_tr_b16 a[14:15], v193 offset:1024
  s_add_u32 m0, s57, 143360
  s_lshl_b32 s45, s43, 7
  buffer_load_dwordx4 v184, s[20:23], s45 offen lds
  v_mfma_f32_16x16x32_bf16 v[116:119], a[48:51], a[68:71], v[116:119]
  s_waitcnt lgkmcnt(6)
  v_mfma_f32_16x16x32_bf16 v[40:43], a[0:3], a[16:19], v[40:43]
  ds_read_b128 a[52:55], v195
  v_mfma_f32_16x16x32_bf16 v[44:47], a[0:3], a[20:23], v[44:47]
  ds_read_b64_tr_b16 a[36:37], v190 offset:8192
  buffer_load_dwordx4 v185, s[20:23], s45 offen offset:1024 lds
  v_mfma_f32_16x16x32_bf16 v[48:51], a[0:3], a[24:27], v[48:51]
  ds_read_b64_tr_b16 a[38:39], v190 offset:9216
  v_mfma_f32_16x16x32_bf16 v[52:55], a[0:3], a[28:31], v[52:55]
  ds_read_b128 a[56:59], v195 offset:2048
  v_mfma_f32_16x16x32_bf16 v[56:59], a[0:3], a[32:35], v[56:59]
  ds_read_b128 a[60:63], v195 offset:4096
  buffer_load_dwordx4 v186, s[20:23], s45 offen offset:2048 lds
  s_waitcnt lgkmcnt(5)
  v_mfma_f32_16x16x32_bf16 v[60:63], a[4:7], a[16:19], v[60:63]
  ds_read_b128 a[64:67], v195 offset:6144
  v_mfma_f32_16x16x32_bf16 v[64:67], a[4:7], a[20:23], v[64:67]
  ds_read_b128 a[68:71], v195 offset:8192
  v_mfma_f32_16x16x32_bf16 v[68:71], a[4:7], a[24:27], v[68:71]
  ds_read_b64_tr_b16 a[40:41], v191 offset:8192
  buffer_load_dwordx4 v187, s[20:23], s45 offen offset:3072 lds
  v_mfma_f32_16x16x32_bf16 v[72:75], a[4:7], a[28:31], v[72:75]
  ds_read_b64_tr_b16 a[42:43], v191 offset:9216
  v_mfma_f32_16x16x32_bf16 v[76:79], a[4:7], a[32:35], v[76:79]
  ds_read_b64_tr_b16 a[44:45], v192 offset:8192
  v_mfma_f32_16x16x32_bf16 v[80:83], a[8:11], a[16:19], v[80:83]
  ds_read_b64_tr_b16 a[46:47], v192 offset:9216
  s_add_u32 m0, s57, 147456
  s_add_u32 s43, s43, 1
  s_cmp_eq_u32 s43, 10
  s_cselect_b32 s43, 0, s43
  buffer_load_dwordx4 v188, s[20:23], s45 offen lds
  v_mfma_f32_16x16x32_bf16 v[84:87], a[8:11], a[20:23], v[84:87]
  ds_read_b64_tr_b16 a[48:49], v193 offset:8192
  v_mfma_f32_16x16x32_bf16 v[88:91], a[8:11], a[24:27], v[88:91]
  ds_read_b64_tr_b16 a[50:51], v193 offset:9216
  v_mfma_f32_16x16x32_bf16 v[92:95], a[8:11], a[28:31], v[92:95]
  v_mfma_f32_16x16x32_bf16 v[96:99], a[8:11], a[32:35], v[96:99]
  v_mfma_f32_16x16x32_bf16 v[100:103], a[12:15], a[16:19], v[100:103]
  v_mfma_f32_16x16x32_bf16 v[104:107], a[12:15], a[20:23], v[104:107]
  v_mfma_f32_16x16x32_bf16 v[108:111], a[12:15], a[24:27], v[108:111]
  v_mfma_f32_16x16x32_bf16 v[112:115], a[12:15], a[28:31], v[112:115]
  v_mfma_f32_16x16x32_bf16 v[116:119], a[12:15], a[32:35], v[116:119]
  s_waitcnt lgkmcnt(0)
  v_mfma_f32_16x16x32_bf16 v[40:43], a[36:39], a[52:55], v[40:43]
  v_mfma_f32_16x16x32_bf16 v[44:47], a[36:39], a[56:59], v[44:47]
  v_mfma_f32_16x16x32_bf16 v[48:51], a[36:39], a[60:63], v[48:51]
  v_mfma_f32_16x16x32_bf16 v[52:55], a[36:39], a[64:67], v[52:55]
  v_mfma_f32_16x16x32_bf16 v[56:59], a[36:39], a[68:71], v[56:59]
  v_mfma_f32_16x16x32_bf16 v[60:63], a[40:43], a[52:55], v[60:63]
  s_waitcnt vmcnt(9)
  s_barrier
  ds_read_b128 a[16:19], v194 offset:36864
  v_mfma_f32_16x16x32_bf16 v[64:67], a[40:43], a[56:59], v[64:67]
  ds_read_b64_tr_b16 a[0:1], v190 offset:36864
  s_lshl_b32 s44, s43, 19
  s_add_u32 m0, s47, 53248
  s_add_u32 s44, s44, s56
  buffer_load_dwordx4 v180, s[24:27], s44 offen lds
  v_mfma_f32_16x16x32_bf16 v[68:71], a[40:43], a[60:63], v[68:71]
  ds_read_b64_tr_b16 a[2:3], v190 offset:37888
  v_mfma_f32_16x16x32_bf16 v[72:75], a[40:43], a[64:67], v[72:75]
  ds_read_b128 a[20:23], v194 offset:38912
  v_mfma_f32_16x16x32_bf16 v[76:79], a[40:43], a[68:71], v[76:79]
  ds_read_b128 a[24:27], v194 offset:40960
  buffer_load_dwordx4 v181, s[24:27], s44 offen offset:1024 lds
  v_mfma_f32_16x16x32_bf16 v[80:83], a[44:47], a[52:55], v[80:83]
  ds_read_b128 a[28:31], v194 offset:43008
  v_mfma_f32_16x16x32_bf16 v[84:87], a[44:47], a[56:59], v[84:87]
  ds_read_b128 a[32:35], v194 offset:45056
  v_mfma_f32_16x16x32_bf16 v[88:91], a[44:47], a[60:63], v[88:91]
  buffer_load_dwordx4 v182, s[24:27], s44 offen offset:2048 lds
  v_mfma_f32_16x16x32_bf16 v[92:95], a[44:47], a[64:67], v[92:95]
  ds_read_b64_tr_b16 a[4:5], v191 offset:36864
  v_mfma_f32_16x16x32_bf16 v[96:99], a[44:47], a[68:71], v[96:99]
  ds_read_b64_tr_b16 a[6:7], v191 offset:37888
  v_mfma_f32_16x16x32_bf16 v[100:103], a[48:51], a[52:55], v[100:103]
  ds_read_b64_tr_b16 a[8:9], v192 offset:36864
  buffer_load_dwordx4 v183, s[24:27], s44 offen offset:3072 lds
  v_mfma_f32_16x16x32_bf16 v[104:107], a[48:51], a[56:59], v[104:107]
  ds_read_b64_tr_b16 a[10:11], v192 offset:37888
  v_mfma_f32_16x16x32_bf16 v[108:111], a[48:51], a[60:63], v[108:111]
  ds_read_b64_tr_b16 a[12:13], v193 offset:36864
  v_mfma_f32_16x16x32_bf16 v[112:115], a[48:51], a[64:67], v[112:115]
  ds_read_b64_tr_b16 a[14:15], v193 offset:37888
  s_add_u32 m0, s57, 69632
  s_lshl_b32 s45, s43, 7
  buffer_load_dwordx4 v184, s[20:23], s45 offen lds
  v_mfma_f32_16x16x32_bf16 v[116:119], a[48:51], a[68:71], v[116:119]
  s_waitcnt lgkmcnt(6)
  v_mfma_f32_16x16x32_bf16 v[40:43], a[0:3], a[16:19], v[40:43]
  ds_read_b128 a[52:55], v195 offset:36864
  v_mfma_f32_16x16x32_bf16 v[44:47], a[0:3], a[20:23], v[44:47]
  ds_read_b64_tr_b16 a[36:37], v190 offset:45056
  buffer_load_dwordx4 v185, s[20:23], s45 offen offset:1024 lds
  v_mfma_f32_16x16x32_bf16 v[48:51], a[0:3], a[24:27], v[48:51]
  ds_read_b64_tr_b16 a[38:39], v190 offset:46080
  v_mfma_f32_16x16x32_bf16 v[52:55], a[0:3], a[28:31], v[52:55]
  ds_read_b128 a[56:59], v195 offset:38912
  v_mfma_f32_16x16x32_bf16 v[56:59], a[0:3], a[32:35], v[56:59]
  ds_read_b128 a[60:63], v195 offset:40960
  buffer_load_dwordx4 v186, s[20:23], s45 offen offset:2048 lds
  s_waitcnt lgkmcnt(5)
  v_mfma_f32_16x16x32_bf16 v[60:63], a[4:7], a[16:19], v[60:63]
  ds_read_b128 a[64:67], v195 offset:43008
  v_mfma_f32_16x16x32_bf16 v[64:67], a[4:7], a[20:23], v[64:67]
  ds_read_b128 a[68:71], v195 offset:45056
  v_mfma_f32_16x16x32_bf16 v[68:71], a[4:7], a[24:27], v[68:71]
  ds_read_b64_tr_b16 a[40:41], v191 offset:45056
  buffer_load_dwordx4 v187, s[20:23], s45 offen offset:3072 lds
  v_mfma_f32_16x16x32_bf16 v[72:75], a[4:7], a[28:31], v[72:75]
  ds_read_b64_tr_b16 a[42:43], v191 offset:46080
  v_mfma_f32_16x16x32_bf16 v[76:79], a[4:7], a[32:35], v[76:79]
  ds_read_b64_tr_b16 a[44:45], v192 offset:45056
  v_mfma_f32_16x16x32_bf16 v[80:83], a[8:11], a[16:19], v[80:83]
  ds_read_b64_tr_b16 a[46:47], v192 offset:46080
  s_add_u32 m0, s57, 73728
  s_add_u32 s43, s43, 1
  s_cmp_eq_u32 s43, 10
  s_cselect_b32 s43, 0, s43
  buffer_load_dwordx4 v188, s[20:23], s45 offen lds
  v_mfma_f32_16x16x32_bf16 v[84:87], a[8:11], a[20:23], v[84:87]
  ds_read_b64_tr_b16 a[48:49], v193 offset:45056
  v_mfma_f32_16x16x32_bf16 v[88:91], a[8:11], a[24:27], v[88:91]
  ds_read_b64_tr_b16 a[50:51], v193 offset:46080
  v_mfma_f32_16x16x32_bf16 v[92:95], a[8:11], a[28:31], v[92:95]
  v_mfma_f32_16x16x32_bf16 v[96:99], a[8:11], a[32:35], v[96:99]
  v_mfma_f32_16x16x32_bf16 v[100:103], a[12:15], a[16:19], v[100:103]
  v_mfma_f32_16x16x32_bf16 v[104:107], a[12:15], a[20:23], v[104:107]
  v_mfma_f32_16x16x32_bf16 v[108:111], a[12:15], a[24:27], v[108:111]
  v_mfma_f32_16x16x32_bf16 v[112:115], a[12:15], a[28:31], v[112:115]
  v_mfma_f32_16x16x32_bf16 v[116:119], a[12:15], a[32:35], v[116:119]
  s_waitcnt lgkmcnt(0)
  v_mfma_f32_16x16x32_bf16 v[40:43], a[36:39], a[52:55], v[40:43]
  v_mfma_f32_16x16x32_bf16 v[44:47], a[36:39], a[56:59], v[44:47]
  v_mfma_f32_16x16x32_bf16 v[48:51], a[36:39], a[60:63], v[48:51]
  v_mfma_f32_16x16x32_bf16 v[52:55], a[36:39], a[64:67], v[52:55]
  v_mfma_f32_16x16x32_bf16 v[56:59], a[36:39], a[68:71], v[56:59]
  v_mfma_f32_16x16x32_bf16 v[60:63], a[40:43], a[52:55], v[60:63]
  s_waitcnt vmcnt(9)
  s_barrier
  ds_read_b128 a[16:19], v200
  v_mfma_f32_16x16x32_bf16 v[64:67], a[40:43], a[56:59], v[64:67]
  ds_read_b64_tr_b16 a[0:1], v196
  s_lshl_b32 s44, s43, 19
  s_add_u32 m0, s47, 90112
  s_add_u32 s44, s44, s56
  buffer_load_dwordx4 v180, s[24:27], s44 offen lds
  v_mfma_f32_16x16x32_bf16 v[68:71], a[40:43], a[60:63], v[68:71]
  ds_read_b64_tr_b16 a[2:3], v196 offset:1024
  v_mfma_f32_16x16x32_bf16 v[72:75], a[40:43], a[64:67], v[72:75]
  ds_read_b128 a[20:23], v200 offset:2048
  v_mfma_f32_16x16x32_bf16 v[76:79], a[40:43], a[68:71], v[76:79]
  ds_read_b128 a[24:27], v200 offset:4096
  buffer_load_dwordx4 v181, s[24:27], s44 offen offset:1024 lds
  v_mfma_f32_16x16x32_bf16 v[80:83], a[44:47], a[52:55], v[80:83]
  ds_read_b128 a[28:31], v200 offset:6144
  v_mfma_f32_16x16x32_bf16 v[84:87], a[44:47], a[56:59], v[84:87]
  ds_read_b128 a[32:35], v200 offset:8192
  v_mfma_f32_16x16x32_bf16 v[88:91], a[44:47], a[60:63], v[88:91]
  buffer_load_dwordx4 v182, s[24:27], s44 offen offset:2048 lds
  v_mfma_f32_16x16x32_bf16 v[92:95], a[44:47], a[64:67], v[92:95]
  ds_read_b64_tr_b16 a[4:5], v197
  v_mfma_f32_16x16x32_bf16 v[96:99], a[44:47], a[68:71], v[96:99]
  ds_read_b64_tr_b16 a[6:7], v197 offset:1024
  v_mfma_f32_16x16x32_bf16 v[100:103], a[48:51], a[52:55], v[100:103]
  ds_read_b64_tr_b16 a[8:9], v198
  buffer_load_dwordx4 v183, s[24:27], s44 offen offset:3072 lds
  v_mfma_f32_16x16x32_bf16 v[104:107], a[48:51], a[56:59], v[104:107]
  ds_read_b64_tr_b16 a[10:11], v198 offset:1024
  v_mfma_f32_16x16x32_bf16 v[108:111], a[48:51], a[60:63], v[108:111]
  ds_read_b64_tr_b16 a[12:13], v199
  v_mfma_f32_16x16x32_bf16 v[112:115], a[48:51], a[64:67], v[112:115]
  ds_read_b64_tr_b16 a[14:15], v199 offset:1024
  s_add_u32 m0, s57, 106496
  s_lshl_b32 s45, s43, 7
  buffer_load_dwordx4 v184, s[20:23], s45 offen lds
  v_mfma_f32_16x16x32_bf16 v[116:119], a[48:51], a[68:71], v[116:119]
  s_waitcnt lgkmcnt(6)
  v_mfma_f32_16x16x32_bf16 v[40:43], a[0:3], a[16:19], v[40:43]
  ds_read_b128 a[52:55], v201
  v_mfma_f32_16x16x32_bf16 v[44:47], a[0:3], a[20:23], v[44:47]
  ds_read_b64_tr_b16 a[36:37], v196 offset:8192
  buffer_load_dwordx4 v185, s[20:23], s45 offen offset:1024 lds
  v_mfma_f32_16x16x32_bf16 v[48:51], a[0:3], a[24:27], v[48:51]
  ds_read_b64_tr_b16 a[38:39], v196 offset:9216
  v_mfma_f32_16x16x32_bf16 v[52:55], a[0:3], a[28:31], v[52:55]
  ds_read_b128 a[56:59], v201 offset:2048
  v_mfma_f32_16x16x32_bf16 v[56:59], a[0:3], a[32:35], v[56:59]
  ds_read_b128 a[60:63], v201 offset:4096
  buffer_load_dwordx4 v186, s[20:23], s45 offen offset:2048 lds
  s_waitcnt lgkmcnt(5)
  v_mfma_f32_16x16x32_bf16 v[60:63], a[4:7], a[16:19], v[60:63]
  ds_read_b128 a[64:67], v201 offset:6144
  v_mfma_f32_16x16x32_bf16 v[64:67], a[4:7], a[20:23], v[64:67]
  ds_read_b128 a[68:71], v201 offset:8192
  v_mfma_f32_16x16x32_bf16 v[68:71], a[4:7], a[24:27], v[68:71]
  ds_read_b64_tr_b16 a[40:41], v197 offset:8192
  buffer_load_dwordx4 v187, s[20:23], s45 offen offset:3072 lds
  v_mfma_f32_16x16x32_bf16 v[72:75], a[4:7], a[28:31], v[72:75]
  ds_read_b64_tr_b16 a[42:43], v197 offset:9216
  v_mfma_f32_16x16x32_bf16 v[76:79], a[4:7], a[32:35], v[76:79]
  ds_read_b64_tr_b16 a[44:45], v198 offset:8192
  v_mfma_f32_16x16x32_bf16 v[80:83], a[8:11], a[16:19], v[80:83]
  ds_read_b64_tr_b16 a[46:47], v198 offset:9216
  s_add_u32 m0, s57, 110592
  s_add_u32 s43, s43, 1
  s_cmp_eq_u32 s43, 10
  s_cselect_b32 s43, 0, s43
  buffer_load_dwordx4 v188, s[20:23], s45 offen lds
  v_mfma_f32_16x16x32_bf16 v[84:87], a[8:11], a[20:23], v[84:87]
  ds_read_b64_tr_b16 a[48:49], v199 offset:8192
  v_mfma_f32_16x16x32_bf16 v[88:91], a[8:11], a[24:27], v[88:91]
  ds_read_b64_tr_b16 a[50:51], v199 offset:9216
  v_mfma_f32_16x16x32_bf16 v[92:95], a[8:11], a[28:31], v[92:95]
  v_mfma_f32_16x16x32_bf16 v[96:99], a[8:11], a[32:35], v[96:99]
  v_mfma_f32_16x16x32_bf16 v[100:103], a[12:15], a[16:19], v[100:103]
  v_mfma_f32_16x16x32_bf16 v[104:107], a[12:15], a[20:23], v[104:107]
  v_mfma_f32_16x16x32_bf16 v[108:111], a[12:15], a[24:27], v[108:111]
  v_mfma_f32_16x16x32_bf16 v[112:115], a[12:15], a[28:31], v[112:115]
  v_mfma_f32_16x16x32_bf16 v[116:119], a[12:15], a[32:35], v[116:119]
  s_waitcnt lgkmcnt(0)
  v_mfma_f32_16x16x32_bf16 v[40:43], a[36:39], a[52:55], v[40:43]
  v_mfma_f32_16x16x32_bf16 v[44:47], a[36:39], a[56:59], v[44:47]
  v_mfma_f32_16x16x32_bf16 v[48:51], a[36:39], a[60:63], v[48:51]
  v_mfma_f32_16x16x32_bf16 v[52:55], a[36:39], a[64:67], v[52:55]
  v_mfma_f32_16x16x32_bf16 v[56:59], a[36:39], a[68:71], v[56:59]
  v_mfma_f32_16x16x32_bf16 v[60:63], a[40:43], a[52:55], v[60:63]
  s_waitcnt vmcnt(9)
  s_barrier
  ds_read_b128 a[16:19], v194
  v_mfma_f32_16x16x32_bf16 v[64:67], a[40:43], a[56:59], v[64:67]
  ds_read_b64_tr_b16 a[0:1], v190
  s_lshl_b32 s44, s43, 19
  s_add_u32 m0, s47, 126976
  s_add_u32 s44, s44, s56
  buffer_load_dwordx4 v180, s[24:27], s44 offen lds
  v_mfma_f32_16x16x32_bf16 v[68:71], a[40:43], a[60:63], v[68:71]
  ds_read_b64_tr_b16 a[2:3], v190 offset:1024
  v_mfma_f32_16x16x32_bf16 v[72:75], a[40:43], a[64:67], v[72:75]
  ds_read_b128 a[20:23], v194 offset:2048
  v_mfma_f32_16x16x32_bf16 v[76:79], a[40:43], a[68:71], v[76:79]
  ds_read_b128 a[24:27], v194 offset:4096
  buffer_load_dwordx4 v181, s[24:27], s44 offen offset:1024 lds
  v_mfma_f32_16x16x32_bf16 v[80:83], a[44:47], a[52:55], v[80:83]
  ds_read_b128 a[28:31], v194 offset:6144
  v_mfma_f32_16x16x32_bf16 v[84:87], a[44:47], a[56:59], v[84:87]
  ds_read_b128 a[32:35], v194 offset:8192
  v_mfma_f32_16x16x32_bf16 v[88:91], a[44:47], a[60:63], v[88:91]
  buffer_load_dwordx4 v182, s[24:27], s44 offen offset:2048 lds
  v_mfma_f32_16x16x32_bf16 v[92:95], a[44:47], a[64:67], v[92:95]
  ds_read_b64_tr_b16 a[4:5], v191
  v_mfma_f32_16x16x32_bf16 v[96:99], a[44:47], a[68:71], v[96:99]
  ds_read_b64_tr_b16 a[6:7], v191 offset:1024
  v_mfma_f32_16x16x32_bf16 v[100:103], a[48:51], a[52:55], v[100:103]
  ds_read_b64_tr_b16 a[8:9], v192
  buffer_load_dwordx4 v183, s[24:27], s44 offen offset:3072 lds
  v_mfma_f32_16x16x32_bf16 v[104:107], a[48:51], a[56:59], v[104:107]
  ds_read_b64_tr_b16 a[10:11], v192 offset:1024
  v_mfma_f32_16x16x32_bf16 v[108:111], a[48:51], a[60:63], v[108:111]
  ds_read_b64_tr_b16 a[12:13], v193
  v_mfma_f32_16x16x32_bf16 v[112:115], a[48:51], a[64:67], v[112:115]
  ds_read_b64_tr_b16 a[14:15], v193 offset:1024
  s_add_u32 m0, s57, 143360
  s_lshl_b32 s45, s43, 7
  buffer_load_dwordx4 v184, s[20:23], s45 offen lds
  v_mfma_f32_16x16x32_bf16 v[116:119], a[48:51], a[68:71], v[116:119]
  s_waitcnt lgkmcnt(6)
  v_mfma_f32_16x16x32_bf16 v[40:43], a[0:3], a[16:19], v[40:43]
  ds_read_b128 a[52:55], v195
  v_mfma_f32_16x16x32_bf16 v[44:47], a[0:3], a[20:23], v[44:47]
  ds_read_b64_tr_b16 a[36:37], v190 offset:8192
  buffer_load_dwordx4 v185, s[20:23], s45 offen offset:1024 lds
  v_mfma_f32_16x16x32_bf16 v[48:51], a[0:3], a[24:27], v[48:51]
  ds_read_b64_tr_b16 a[38:39], v190 offset:9216
  v_mfma_f32_16x16x32_bf16 v[52:55], a[0:3], a[28:31], v[52:55]
  ds_read_b128 a[56:59], v195 offset:2048
  v_mfma_f32_16x16x32_bf16 v[56:59], a[0:3], a[32:35], v[56:59]
  ds_read_b128 a[60:63], v195 offset:4096
  buffer_load_dwordx4 v186, s[20:23], s45 offen offset:2048 lds
  s_waitcnt lgkmcnt(5)
  v_mfma_f32_16x16x32_bf16 v[60:63], a[4:7], a[16:19], v[60:63]
  ds_read_b128 a[64:67], v195 offset:6144
  v_mfma_f32_16x16x32_bf16 v[64:67], a[4:7], a[20:23], v[64:67]
  ds_read_b128 a[68:71], v195 offset:8192
  v_mfma_f32_16x16x32_bf16 v[68:71], a[4:7], a[24:27], v[68:71]
  ds_read_b64_tr_b16 a[40:41], v191 offset:8192
  buffer_load_dwordx4 v187, s[20:23], s45 offen offset:3072 lds
  v_mfma_f32_16x16x32_bf16 v[72:75], a[4:7], a[28:31], v[72:75]
  ds_read_b64_tr_b16 a[42:43], v191 offset:9216
  v_mfma_f32_16x16x32_bf16 v[76:79], a[4:7], a[32:35], v[76:79]
  ds_read_b64_tr_b16 a[44:45], v192 offset:8192
  v_mfma_f32_16x16x32_bf16 v[80:83], a[8:11], a[16:19], v[80:83]
  ds_read_b64_tr_b16 a[46:47], v192 offset:9216
  s_add_u32 m0, s57, 147456
  s_add_u32 s43, s43, 1
  s_cmp_eq_u32 s43, 10
  s_cselect_b32 s43, 0, s43
  buffer_load_dwordx4 v188, s[20:23], s45 offen lds
  v_mfma_f32_16x16x32_bf16 v[84:87], a[8:11], a[20:23], v[84:87]
  ds_read_b64_tr_b16 a[48:49], v193 offset:8192
  v_mfma_f32_16x16x32_bf16 v[88:91], a[8:11], a[24:27], v[88:91]
  ds_read_b64_tr_b16 a[50:51], v193 offset:9216
  v_mfma_f32_16x16x32_bf16 v[92:95], a[8:11], a[28:31], v[92:95]
  v_mfma_f32_16x16x32_bf16 v[96:99], a[8:11], a[32:35], v[96:99]
  v_mfma_f32_16x16x32_bf16 v[100:103], a[12:15], a[16:19], v[100:103]
  v_mfma_f32_16x16x32_bf16 v[104:107], a[12:15], a[20:23], v[104:107]
  v_mfma_f32_16x16x32_bf16 v[108:111], a[12:15], a[24:27], v[108:111]
  v_mfma_f32_16x16x32_bf16 v[112:115], a[12:15], a[28:31], v[112:115]
  v_mfma_f32_16x16x32_bf16 v[116:119], a[12:15], a[32:35], v[116:119]
  s_waitcnt lgkmcnt(0)
  v_mfma_f32_16x16x32_bf16 v[40:43], a[36:39], a[52:55], v[40:43]
  v_mfma_f32_16x16x32_bf16 v[44:47], a[36:39], a[56:59], v[44:47]
  v_mfma_f32_16x16x32_bf16 v[48:51], a[36:39], a[60:63], v[48:51]
  v_mfma_f32_16x16x32_bf16 v[52:55], a[36:39], a[64:67], v[52:55]
  v_mfma_f32_16x16x32_bf16 v[56:59], a[36:39], a[68:71], v[56:59]
  v_mfma_f32_16x16x32_bf16 v[60:63], a[40:43], a[52:55], v[60:63]
  s_waitcnt vmcnt(9)
  s_barrier
  ds_read_b128 a[16:19], v194 offset:36864
  v_mfma_f32_16x16x32_bf16 v[64:67], a[40:43], a[56:59], v[64:67]
  ds_read_b64_tr_b16 a[0:1], v190 offset:36864
  s_lshl_b32 s44, s43, 19
  s_add_u32 m0, s47, 53248
  s_add_u32 s44, s44, s56
  buffer_load_dwordx4 v180, s[24:27], s44 offen lds
  v_mfma_f32_16x16x32_bf16 v[68:71], a[40:43], a[60:63], v[68:71]
  ds_read_b64_tr_b16 a[2:3], v190 offset:37888
  v_mfma_f32_16x16x32_bf16 v[72:75], a[40:43], a[64:67], v[72:75]
  ds_read_b128 a[20:23], v194 offset:38912
  v_mfma_f32_16x16x32_bf16 v[76:79], a[40:43], a[68:71], v[76:79]
  ds_read_b128 a[24:27], v194 offset:40960
  buffer_load_dwordx4 v181, s[24:27], s44 offen offset:1024 lds
  v_mfma_f32_16x16x32_bf16 v[80:83], a[44:47], a[52:55], v[80:83]
  ds_read_b128 a[28:31], v194 offset:43008
  v_mfma_f32_16x16x32_bf16 v[84:87], a[44:47], a[56:59], v[84:87]
  ds_read_b128 a[32:35], v194 offset:45056
  v_mfma_f32_16x16x32_bf16 v[88:91], a[44:47], a[60:63], v[88:91]
  buffer_load_dwordx4 v182, s[24:27], s44 offen offset:2048 lds
  v_mfma_f32_16x16x32_bf16 v[92:95], a[44:47], a[64:67], v[92:95]
  ds_read_b64_tr_b16 a[4:5], v191 offset:36864
  v_mfma_f32_16x16x32_bf16 v[96:99], a[44:47], a[68:71], v[96:99]
  ds_read_b64_tr_b16 a[6:7], v191 offset:37888
  v_mfma_f32_16x16x32_bf16 v[100:103], a[48:51], a[52:55], v[100:103]
  ds_read_b64_tr_b16 a[8:9], v192 offset:36864
  buffer_load_dwordx4 v183, s[24:27], s44 offen offset:3072 lds
  v_mfma_f32_16x16x32_bf16 v[104:107], a[48:51], a[56:59], v[104:107]
  ds_read_b64_tr_b16 a[10:11], v192 offset:37888
  v_mfma_f32_16x16x32_bf16 v[108:111], a[48:51], a[60:63], v[108:111]
  ds_read_b64_tr_b16 a[12:13], v193 offset:36864
  v_mfma_f32_16x16x32_bf16 v[112:115], a[48:51], a[64:67], v[112:115]
  ds_read_b64_tr_b16 a[14:15], v193 offset:37888
  s_add_u32 m0, s57, 69632
  s_lshl_b32 s45, s43, 7
  buffer_load_dwordx4 v184, s[20:23], s45 offen lds
  v_mfma_f32_16x16x32_bf16 v[116:119], a[48:51], a[68:71], v[116:119]
  s_waitcnt lgkmcnt(6)
  v_mfma_f32_16x16x32_bf16 v[40:43], a[0:3], a[16:19], v[40:43]
  ds_read_b128 a[52:55], v195 offset:36864
  v_mfma_f32_16x16x32_bf16 v[44:47], a[0:3], a[20:23], v[44:47]
  ds_read_b64_tr_b16 a[36:37], v190 offset:45056
  buffer_load_dwordx4 v185, s[20:23], s45 offen offset:1024 lds
  v_mfma_f32_16x16x32_bf16 v[48:51], a[0:3], a[24:27], v[48:51]
  ds_read_b64_tr_b16 a[38:39], v190 offset:46080
  v_mfma_f32_16x16x32_bf16 v[52:55], a[0:3], a[28:31], v[52:55]
  ds_read_b128 a[56:59], v195 offset:38912
  v_mfma_f32_16x16x32_bf16 v[56:59], a[0:3], a[32:35], v[56:59]
  ds_read_b128 a[60:63], v195 offset:40960
  buffer_load_dwordx4 v186, s[20:23], s45 offen offset:2048 lds
  s_waitcnt lgkmcnt(5)
  v_mfma_f32_16x16x32_bf16 v[60:63], a[4:7], a[16:19], v[60:63]
  ds_read_b128 a[64:67], v195 offset:43008
  v_mfma_f32_16x16x32_bf16 v[64:67], a[4:7], a[20:23], v[64:67]
  ds_read_b128 a[68:71], v195 offset:45056
  v_mfma_f32_16x16x32_bf16 v[68:71], a[4:7], a[24:27], v[68:71]
  ds_read_b64_tr_b16 a[40:41], v191 offset:45056
  buffer_load_dwordx4 v187, s[20:23], s45 offen offset:3072 lds
  v_mfma_f32_16x16x32_bf16 v[72:75], a[4:7], a[28:31], v[72:75]
  ds_read_b64_tr_b16 a[42:43], v191 offset:46080
  v_mfma_f32_16x16x32_bf16 v[76:79], a[4:7], a[32:35], v[76:79]
  ds_read_b64_tr_b16 a[44:45], v192 offset:45056
  v_mfma_f32_16x16x32_bf16 v[80:83], a[8:11], a[16:19], v[80:83]
  ds_read_b64_tr_b16 a[46:47], v192 offset:46080
  s_add_u32 m0, s57, 73728
  s_add_u32 s43, s43, 1
  s_cmp_eq_u32 s43, 10
  s_cselect_b32 s43, 0, s43
  buffer_load_dwordx4 v188, s[20:23], s45 offen lds
  v_mfma_f32_16x16x32_bf16 v[84:87], a[8:11], a[20:23], v[84:87]
  ds_read_b64_tr_b16 a[48:49], v193 offset:45056
  v_mfma_f32_16x16x32_bf16 v[88:91], a[8:11], a[24:27], v[88:91]
  ds_read_b64_tr_b16 a[50:51], v193 offset:46080
  v_mfma_f32_16x16x32_bf16 v[92:95], a[8:11], a[28:31], v[92:95]
  s_add_u32 m0, s47, 0
  s_add_u32 s46, s47, 0
  buffer_load_dwordx4 v4, s[28:31], s46 offen nt lds
  v_mfma_f32_16x16x32_bf16 v[96:99], a[8:11], a[32:35], v[96:99]
  v_mfma_f32_16x16x32_bf16 v[100:103], a[12:15], a[16:19], v[100:103]
  buffer_load_dwordx4 v5, s[28:31], s46 offen offset:1024 nt lds
  v_mfma_f32_16x16x32_bf16 v[104:107], a[12:15], a[20:23], v[104:107]
  v_mfma_f32_16x16x32_bf16 v[108:111], a[12:15], a[24:27], v[108:111]
  buffer_load_dwordx4 v6, s[28:31], s46 offen offset:2048 nt lds
  v_mfma_f32_16x16x32_bf16 v[112:115], a[12:15], a[28:31], v[112:115]
  v_mfma_f32_16x16x32_bf16 v[116:119], a[12:15], a[32:35], v[116:119]
  buffer_load_dwordx4 v7, s[28:31], s46 offen offset:3072 nt lds
  s_waitcnt lgkmcnt(0)
  v_mfma_f32_16x16x32_bf16 v[40:43], a[36:39], a[52:55], v[40:43]
  v_mfma_f32_16x16x32_bf16 v[44:47], a[36:39], a[56:59], v[44:47]
  v_mfma_f32_16x16x32_bf16 v[48:51], a[36:39], a[60:63], v[48:51]
  v_mfma_f32_16x16x32_bf16 v[52:55], a[36:39], a[64:67], v[52:55]
  v_mfma_f32_16x16x32_bf16 v[56:59], a[36:39], a[68:71], v[56:59]
  v_mfma_f32_16x16x32_bf16 v[60:63], a[40:43], a[52:55], v[60:63]
  s_waitcnt vmcnt(13)
  s_barrier
  ds_read_b128 a[16:19], v200
  v_mfma_f32_16x16x32_bf16 v[64:67], a[40:43], a[56:59], v[64:67]
  ds_read_b64_tr_b16 a[0:1], v196
  s_lshl_b32 s44, s43, 19
  s_add_u32 m0, s47, 90112
  s_add_u32 s44, s44, s56
  buffer_load_dwordx4 v180, s[24:27], s44 offen lds
  v_mfma_f32_16x16x32_bf16 v[68:71], a[40:43], a[60:63], v[68:71]
  ds_read_b64_tr_b16 a[2:3], v196 offset:1024
  v_mfma_f32_16x16x32_bf16 v[72:75], a[40:43], a[64:67], v[72:75]
  ds_read_b128 a[20:23], v200 offset:2048
  v_mfma_f32_16x16x32_bf16 v[76:79], a[40:43], a[68:71], v[76:79]
  ds_read_b128 a[24:27], v200 offset:4096
  buffer_load_dwordx4 v181, s[24:27], s44 offen offset:1024 lds
  v_mfma_f32_16x16x32_bf16 v[80:83], a[44:47], a[52:55], v[80:83]
  ds_read_b128 a[28:31], v200 offset:6144
  v_mfma_f32_16x16x32_bf16 v[84:87], a[44:47], a[56:59], v[84:87]
  ds_read_b128 a[32:35], v200 offset:8192
  v_mfma_f32_16x16x32_bf16 v[88:91], a[44:47], a[60:63], v[88:91]
  buffer_load_dwordx4 v182, s[24:27], s44 offen offset:2048 lds
  v_mfma_f32_16x16x32_bf16 v[92:95], a[44:47], a[64:67], v[92:95]
  ds_read_b64_tr_b16 a[4:5], v197
  v_mfma_f32_16x16x32_bf16 v[96:99], a[44:47], a[68:71], v[96:99]
  ds_read_b64_tr_b16 a[6:7], v197 offset:1024
  v_mfma_f32_16x16x32_bf16 v[100:103], a[48:51], a[52:55], v[100:103]
  ds_read_b64_tr_b16 a[8:9], v198
  buffer_load_dwordx4 v183, s[24:27], s44 offen offset:3072 lds
  v_mfma_f32_16x16x32_bf16 v[104:107], a[48:51], a[56:59], v[104:107]
  ds_read_b64_tr_b16 a[10:11], v198 offset:1024
  v_mfma_f32_16x16x32_bf16 v[108:111], a[48:51], a[60:63], v[108:111]
  ds_read_b64_tr_b16 a[12:13], v199
  v_mfma_f32_16x16x32_bf16 v[112:115], a[48:51], a[64:67], v[112:115]
  ds_read_b64_tr_b16 a[14:15], v199 offset:1024
  s_add_u32 m0, s57, 106496
  s_lshl_b32 s45, s43, 7
  buffer_load_dwordx4 v184, s[20:23], s45 offen lds
  v_mfma_f32_16x16x32_bf16 v[116:119], a[48:51], a[68:71], v[116:119]
  s_waitcnt lgkmcnt(6)
  v_mfma_f32_16x16x32_bf16 v[40:43], a[0:3], a[16:19], v[40:43]
  ds_read_b128 a[52:55], v201
  v_mfma_f32_16x16x32_bf16 v[44:47], a[0:3], a[20:23], v[44:47]
  ds_read_b64_tr_b16 a[36:37], v196 offset:8192
  buffer_load_dwordx4 v185, s[20:23], s45 offen offset:1024 lds
  v_mfma_f32_16x16x32_bf16 v[48:51], a[0:3], a[24:27], v[48:51]
  ds_read_b64_tr_b16 a[38:39], v196 offset:9216
  v_mfma_f32_16x16x32_bf16 v[52:55], a[0:3], a[28:31], v[52:55]
  ds_read_b128 a[56:59], v201 offset:2048
  v_mfma_f32_16x16x32_bf16 v[56:59], a[0:3], a[32:35], v[56:59]
  ds_read_b128 a[60:63], v201 offset:4096
  buffer_load_dwordx4 v186, s[20:23], s45 offen offset:2048 lds
  s_waitcnt lgkmcnt(5)
  v_mfma_f32_16x16x32_bf16 v[60:63], a[4:7], a[16:19], v[60:63]
  ds_read_b128 a[64:67], v201 offset:6144
  v_mfma_f32_16x16x32_bf16 v[64:67], a[4:7], a[20:23], v[64:67]
  ds_read_b128 a[68:71], v201 offset:8192
  v_mfma_f32_16x16x32_bf16 v[68:71], a[4:7], a[24:27], v[68:71]
  ds_read_b64_tr_b16 a[40:41], v197 offset:8192
  buffer_load_dwordx4 v187, s[20:23], s45 offen offset:3072 lds
  v_mfma_f32_16x16x32_bf16 v[72:75], a[4:7], a[28:31], v[72:75]
  ds_read_b64_tr_b16 a[42:43], v197 offset:9216
  v_mfma_f32_16x16x32_bf16 v[76:79], a[4:7], a[32:35], v[76:79]
  ds_read_b64_tr_b16 a[44:45], v198 offset:8192
  v_mfma_f32_16x16x32_bf16 v[80:83], a[8:11], a[16:19], v[80:83]
  ds_read_b64_tr_b16 a[46:47], v198 offset:9216
  s_add_u32 m0, s57, 110592
  s_add_u32 s43, s43, 1
  s_cmp_eq_u32 s43, 10
  s_cselect_b32 s43, 0, s43
  buffer_load_dwordx4 v188, s[20:23], s45 offen lds
  v_mfma_f32_16x16x32_bf16 v[84:87], a[8:11], a[20:23], v[84:87]
  ds_read_b64_tr_b16 a[48:49], v199 offset:8192
  v_mfma_f32_16x16x32_bf16 v[88:91], a[8:11], a[24:27], v[88:91]
  ds_read_b64_tr_b16 a[50:51], v199 offset:9216
  v_mfma_f32_16x16x32_bf16 v[92:95], a[8:11], a[28:31], v[92:95]
  v_mfma_f32_16x16x32_bf16 v[96:99], a[8:11], a[32:35], v[96:99]
  v_mfma_f32_16x16x32_bf16 v[100:103], a[12:15], a[16:19], v[100:103]
  v_mfma_f32_16x16x32_bf16 v[104:107], a[12:15], a[20:23], v[104:107]
  v_mfma_f32_16x16x32_bf16 v[108:111], a[12:15], a[24:27], v[108:111]
  v_mfma_f32_16x16x32_bf16 v[112:115], a[12:15], a[28:31], v[112:115]
  v_mfma_f32_16x16x32_bf16 v[116:119], a[12:15], a[32:35], v[116:119]
  s_waitcnt lgkmcnt(0)
  v_mfma_f32_16x16x32_bf16 v[40:43], a[36:39], a[52:55], v[40:43]
  v_mfma_f32_16x16x32_bf16 v[44:47], a[36:39], a[56:59], v[44:47]
  v_mfma_f32_16x16x32_bf16 v[48:51], a[36:39], a[60:63], v[48:51]
  v_mfma_f32_16x16x32_bf16 v[52:55], a[36:39], a[64:67], v[52:55]
  v_mfma_f32_16x16x32_bf16 v[56:59], a[36:39], a[68:71], v[56:59]
  v_mfma_f32_16x16x32_bf16 v[60:63], a[40:43], a[52:55], v[60:63]
  s_waitcnt vmcnt(13)
  s_barrier
  ds_read_b128 a[16:19], v194
  v_mfma_f32_16x16x32_bf16 v[64:67], a[40:43], a[56:59], v[64:67]
  ds_read_b64_tr_b16 a[0:1], v190
  s_lshl_b32 s44, s43, 19
  s_add_u32 m0, s47, 126976
  s_add_u32 s44, s44, s56
  buffer_load_dwordx4 v180, s[24:27], s44 offen lds
  v_mfma_f32_16x16x32_bf16 v[68:71], a[40:43], a[60:63], v[68:71]
  ds_read_b64_tr_b16 a[2:3], v190 offset:1024
  v_mfma_f32_16x16x32_bf16 v[72:75], a[40:43], a[64:67], v[72:75]
  ds_read_b128 a[20:23], v194 offset:2048
  v_mfma_f32_16x16x32_bf16 v[76:79], a[40:43], a[68:71], v[76:79]
  ds_read_b128 a[24:27], v194 offset:4096
  buffer_load_dwordx4 v181, s[24:27], s44 offen offset:1024 lds
  v_mfma_f32_16x16x32_bf16 v[80:83], a[44:47], a[52:55], v[80:83]
  ds_read_b128 a[28:31], v194 offset:6144
  v_mfma_f32_16x16x32_bf16 v[84:87], a[44:47], a[56:59], v[84:87]
  ds_read_b128 a[32:35], v194 offset:8192
  v_mfma_f32_16x16x32_bf16 v[88:91], a[44:47], a[60:63], v[88:91]
  buffer_load_dwordx4 v182, s[24:27], s44 offen offset:2048 lds
  v_mfma_f32_16x16x32_bf16 v[92:95], a[44:47], a[64:67], v[92:95]
  ds_read_b64_tr_b16 a[4:5], v191
  v_mfma_f32_16x16x32_bf16 v[96:99], a[44:47], a[68:71], v[96:99]
  ds_read_b64_tr_b16 a[6:7], v191 offset:1024
  v_mfma_f32_16x16x32_bf16 v[100:103], a[48:51], a[52:55], v[100:103]
  ds_read_b64_tr_b16 a[8:9], v192
  buffer_load_dwordx4 v183, s[24:27], s44 offen offset:3072 lds
  v_mfma_f32_16x16x32_bf16 v[104:107], a[48:51], a[56:59], v[104:107]
  ds_read_b64_tr_b16 a[10:11], v192 offset:1024
  v_mfma_f32_16x16x32_bf16 v[108:111], a[48:51], a[60:63], v[108:111]
  ds_read_b64_tr_b16 a[12:13], v193
  v_mfma_f32_16x16x32_bf16 v[112:115], a[48:51], a[64:67], v[112:115]
  ds_read_b64_tr_b16 a[14:15], v193 offset:1024
  s_add_u32 m0, s57, 143360
  s_lshl_b32 s45, s43, 7
  buffer_load_dwordx4 v184, s[20:23], s45 offen lds
  v_mfma_f32_16x16x32_bf16 v[116:119], a[48:51], a[68:71], v[116:119]
  s_waitcnt lgkmcnt(6)
  v_mfma_f32_16x16x32_bf16 v[40:43], a[0:3], a[16:19], v[40:43]
  ds_read_b128 a[52:55], v195
  v_mfma_f32_16x16x32_bf16 v[44:47], a[0:3], a[20:23], v[44:47]
  ds_read_b64_tr_b16 a[36:37], v190 offset:8192
  buffer_load_dwordx4 v185, s[20:23], s45 offen offset:1024 lds
  v_mfma_f32_16x16x32_bf16 v[48:51], a[0:3], a[24:27], v[48:51]
  ds_read_b64_tr_b16 a[38:39], v190 offset:9216
  v_mfma_f32_16x16x32_bf16 v[52:55], a[0:3], a[28:31], v[52:55]
  ds_read_b128 a[56:59], v195 offset:2048
  v_mfma_f32_16x16x32_bf16 v[56:59], a[0:3], a[32:35], v[56:59]
  ds_read_b128 a[60:63], v195 offset:4096
  buffer_load_dwordx4 v186, s[20:23], s45 offen offset:2048 lds
  s_waitcnt lgkmcnt(5)
  v_mfma_f32_16x16x32_bf16 v[60:63], a[4:7], a[16:19], v[60:63]
  ds_read_b128 a[64:67], v195 offset:6144
  v_mfma_f32_16x16x32_bf16 v[64:67], a[4:7], a[20:23], v[64:67]
  ds_read_b128 a[68:71], v195 offset:8192
  v_mfma_f32_16x16x32_bf16 v[68:71], a[4:7], a[24:27], v[68:71]
  ds_read_b64_tr_b16 a[40:41], v191 offset:8192
  buffer_load_dwordx4 v187, s[20:23], s45 offen offset:3072 lds
  v_mfma_f32_16x16x32_bf16 v[72:75], a[4:7], a[28:31], v[72:75]
  ds_read_b64_tr_b16 a[42:43], v191 offset:9216
  v_mfma_f32_16x16x32_bf16 v[76:79], a[4:7], a[32:35], v[76:79]
  ds_read_b64_tr_b16 a[44:45], v192 offset:8192
  v_mfma_f32_16x16x32_bf16 v[80:83], a[8:11], a[16:19], v[80:83]
  ds_read_b64_tr_b16 a[46:47], v192 offset:9216
  s_add_u32 m0, s57, 147456
  s_add_u32 s43, s43, 1
  s_cmp_eq_u32 s43, 10
  s_cselect_b32 s43, 0, s43
  buffer_load_dwordx4 v188, s[20:23], s45 offen lds
  v_mfma_f32_16x16x32_bf16 v[84:87], a[8:11], a[20:23], v[84:87]
  ds_read_b64_tr_b16 a[48:49], v193 offset:8192
  v_mfma_f32_16x16x32_bf16 v[88:91], a[8:11], a[24:27], v[88:91]
  ds_read_b64_tr_b16 a[50:51], v193 offset:9216
  v_mfma_f32_16x16x32_bf16 v[92:95], a[8:11], a[28:31], v[92:95]
  s_add_u32 m0, s47, 16384
  s_add_u32 s46, s47, 16384
  buffer_load_dwordx4 v4, s[28:31], s46 offen nt lds
  v_mfma_f32_16x16x32_bf16 v[96:99], a[8:11], a[32:35], v[96:99]
  v_mfma_f32_16x16x32_bf16 v[100:103], a[12:15], a[16:19], v[100:103]
  buffer_load_dwordx4 v5, s[28:31], s46 offen offset:1024 nt lds
  v_mfma_f32_16x16x32_bf16 v[104:107], a[12:15], a[20:23], v[104:107]
  v_mfma_f32_16x16x32_bf16 v[108:111], a[12:15], a[24:27], v[108:111]
  buffer_load_dwordx4 v6, s[28:31], s46 offen offset:2048 nt lds
  v_mfma_f32_16x16x32_bf16 v[112:115], a[12:15], a[28:31], v[112:115]
  v_mfma_f32_16x16x32_bf16 v[116:119], a[12:15], a[32:35], v[116:119]
  buffer_load_dwordx4 v7, s[28:31], s46 offen offset:3072 nt lds
  s_waitcnt lgkmcnt(0)
  v_mfma_f32_16x16x32_bf16 v[40:43], a[36:39], a[52:55], v[40:43]
  v_mfma_f32_16x16x32_bf16 v[44:47], a[36:39], a[56:59], v[44:47]
  s_add_u32 m0, s47, 32768
  s_add_u32 s46, s47, 32768
  buffer_load_dwordx4 v4, s[28:31], s46 offen nt lds
  v_mfma_f32_16x16x32_bf16 v[48:51], a[36:39], a[60:63], v[48:51]
  v_mfma_f32_16x16x32_bf16 v[52:55], a[36:39], a[64:67], v[52:55]
  buffer_load_dwordx4 v5, s[28:31], s46 offen offset:1024 nt lds
  v_mfma_f32_16x16x32_bf16 v[56:59], a[36:39], a[68:71], v[56:59]
  v_mfma_f32_16x16x32_bf16 v[60:63], a[40:43], a[52:55], v[60:63]
  s_waitcnt vmcnt(15)
  s_barrier
  ds_read_b128 a[16:19], v194 offset:36864
  buffer_load_dwordx4 v6, s[28:31], s46 offen offset:2048 nt lds
  v_mfma_f32_16x16x32_bf16 v[64:67], a[40:43], a[56:59], v[64:67]
  ds_read_b64_tr_b16 a[0:1], v190 offset:36864
  v_mfma_f32_16x16x32_bf16 v[68:71], a[40:43], a[60:63], v[68:71]
  ds_read_b64_tr_b16 a[2:3], v190 offset:37888
  buffer_load_dwordx4 v7, s[28:31], s46 offen offset:3072 nt lds
  v_mfma_f32_16x16x32_bf16 v[72:75], a[40:43], a[64:67], v[72:75]
  ds_read_b128 a[20:23], v194 offset:38912
  v_mfma_f32_16x16x32_bf16 v[76:79], a[40:43], a[68:71], v[76:79]
  ds_read_b128 a[24:27], v194 offset:40960
  v_mfma_f32_16x16x32_bf16 v[80:83], a[44:47], a[52:55], v[80:83]
  ds_read_b128 a[28:31], v194 offset:43008
  v_mfma_f32_16x16x32_bf16 v[84:87], a[44:47], a[56:59], v[84:87]
  ds_read_b128 a[32:35], v194 offset:45056
  v_mfma_f32_16x16x32_bf16 v[88:91], a[44:47], a[60:63], v[88:91]
  v_mfma_f32_16x16x32_bf16 v[92:95], a[44:47], a[64:67], v[92:95]
  ds_read_b64_tr_b16 a[4:5], v191 offset:36864
  v_mfma_f32_16x16x32_bf16 v[96:99], a[44:47], a[68:71], v[96:99]
  ds_read_b64_tr_b16 a[6:7], v191 offset:37888
  v_mfma_f32_16x16x32_bf16 v[100:103], a[48:51], a[52:55], v[100:103]
  ds_read_b64_tr_b16 a[8:9], v192 offset:36864
  v_mfma_f32_16x16x32_bf16 v[104:107], a[48:51], a[56:59], v[104:107]
  ds_read_b64_tr_b16 a[10:11], v192 offset:37888
  v_mfma_f32_16x16x32_bf16 v[108:111], a[48:51], a[60:63], v[108:111]
  ds_read_b64_tr_b16 a[12:13], v193 offset:36864
  v_mfma_f32_16x16x32_bf16 v[112:115], a[48:51], a[64:67], v[112:115]
  ds_read_b64_tr_b16 a[14:15], v193 offset:37888
  v_mfma_f32_16x16x32_bf16 v[116:119], a[48:51], a[68:71], v[116:119]
  s_waitcnt lgkmcnt(6)
  v_mfma_f32_16x16x32_bf16 v[40:43], a[0:3], a[16:19], v[40:43]
  ds_read_b128 a[52:55], v195 offset:36864
  v_mfma_f32_16x16x32_bf16 v[44:47], a[0:3], a[20:23], v[44:47]
  ds_read_b64_tr_b16 a[36:37], v190 offset:45056
  v_mfma_f32_16x16x32_bf16 v[48:51], a[0:3], a[24:27], v[48:51]
  ds_read_b64_tr_b16 a[38:39], v190 offset:46080
  v_mfma_f32_16x16x32_bf16 v[52:55], a[0:3], a[28:31], v[52:55]
  ds_read_b128 a[56:59], v195 offset:38912
  v_mfma_f32_16x16x32_bf16 v[56:59], a[0:3], a[32:35], v[56:59]
  ds_read_b128 a[60:63], v195 offset:40960
  s_waitcnt lgkmcnt(5)
  v_mfma_f32_16x16x32_bf16 v[60:63], a[4:7], a[16:19], v[60:63]
  ds_read_b128 a[64:67], v195 offset:43008
  v_mfma_f32_16x16x32_bf16 v[64:67], a[4:7], a[20:23], v[64:67]
  ds_read_b128 a[68:71], v195 offset:45056
  v_mfma_f32_16x16x32_bf16 v[68:71], a[4:7], a[24:27], v[68:71]
  ds_read_b64_tr_b16 a[40:41], v191 offset:45056
  v_mfma_f32_16x16x32_bf16 v[72:75], a[4:7], a[28:31], v[72:75]
  ds_read_b64_tr_b16 a[42:43], v191 offset:46080
  v_mfma_f32_16x16x32_bf16 v[76:79], a[4:7], a[32:35], v[76:79]
  ds_read_b64_tr_b16 a[44:45], v192 offset:45056
  v_mfma_f32_16x16x32_bf16 v[80:83], a[8:11], a[16:19], v[80:83]
  ds_read_b64_tr_b16 a[46:47], v192 offset:46080
  v_mfma_f32_16x16x32_bf16 v[84:87], a[8:11], a[20:23], v[84:87]
  ds_read_b64_tr_b16 a[48:49], v193 offset:45056
  v_mfma_f32_16x16x32_bf16 v[88:91], a[8:11], a[24:27], v[88:91]
  ds_read_b64_tr_b16 a[50:51], v193 offset:46080
  v_mfma_f32_16x16x32_bf16 v[92:95], a[8:11], a[28:31], v[92:95]
  v_mfma_f32_16x16x32_bf16 v[96:99], a[8:11], a[32:35], v[96:99]
  v_mfma_f32_16x16x32_bf16 v[100:103], a[12:15], a[16:19], v[100:103]
  v_mfma_f32_16x16x32_bf16 v[104:107], a[12:15], a[20:23], v[104:107]
  v_mfma_f32_16x16x32_bf16 v[108:111], a[12:15], a[24:27], v[108:111]
  v_mfma_f32_16x16x32_bf16 v[112:115], a[12:15], a[28:31], v[112:115]
  v_mfma_f32_16x16x32_bf16 v[116:119], a[12:15], a[32:35], v[116:119]
  s_waitcnt lgkmcnt(0)
  v_mfma_f32_16x16x32_bf16 v[40:43], a[36:39], a[52:55], v[40:43]
  v_mfma_f32_16x16x32_bf16 v[44:47], a[36:39], a[56:59], v[44:47]
  v_mfma_f32_16x16x32_bf16 v[48:51], a[36:39], a[60:63], v[48:51]
  v_mfma_f32_16x16x32_bf16 v[52:55], a[36:39], a[64:67], v[52:55]
  v_mfma_f32_16x16x32_bf16 v[56:59], a[36:39], a[68:71], v[56:59]
  v_mfma_f32_16x16x32_bf16 v[60:63], a[40:43], a[52:55], v[60:63]
  s_waitcnt vmcnt(8)
  s_barrier
  ds_read_b128 a[16:19], v200
  v_mfma_f32_16x16x32_bf16 v[64:67], a[40:43], a[56:59], v[64:67]
  ds_read_b64_tr_b16 a[0:1], v196
  v_mfma_f32_16x16x32_bf16 v[68:71], a[40:43], a[60:63], v[68:71]
  ds_read_b64_tr_b16 a[2:3], v196 offset:1024
  v_mfma_f32_16x16x32_bf16 v[72:75], a[40:43], a[64:67], v[72:75]
  ds_read_b128 a[20:23], v200 offset:2048
  v_mfma_f32_16x16x32_bf16 v[76:79], a[40:43], a[68:71], v[76:79]
  ds_read_b128 a[24:27], v200 offset:4096
  v_mfma_f32_16x16x32_bf16 v[80:83], a[44:47], a[52:55], v[80:83]
  ds_read_b128 a[28:31], v200 offset:6144
  v_mfma_f32_16x16x32_bf16 v[84:87], a[44:47], a[56:59], v[84:87]
  ds_read_b128 a[32:35], v200 offset:8192
  v_mfma_f32_16x16x32_bf16 v[88:91], a[44:47], a[60:63], v[88:91]
  v_mfma_f32_16x16x32_bf16 v[92:95], a[44:47], a[64:67], v[92:95]
  ds_read_b64_tr_b16 a[4:5], v197
  v_mfma_f32_16x16x32_bf16 v[96:99], a[44:47], a[68:71], v[96:99]
  ds_read_b64_tr_b16 a[6:7], v197 offset:1024
  v_mfma_f32_16x16x32_bf16 v[100:103], a[48:51], a[52:55], v[100:103]
  ds_read_b64_tr_b16 a[8:9], v198
  v_mfma_f32_16x16x32_bf16 v[104:107], a[48:51], a[56:59], v[104:107]
  ds_read_b64_tr_b16 a[10:11], v198 offset:1024
  v_mfma_f32_16x16x32_bf16 v[108:111], a[48:51], a[60:63], v[108:111]
  ds_read_b64_tr_b16 a[12:13], v199
  v_mfma_f32_16x16x32_bf16 v[112:115], a[48:51], a[64:67], v[112:115]
  ds_read_b64_tr_b16 a[14:15], v199 offset:1024
  v_mfma_f32_16x16x32_bf16 v[116:119], a[48:51], a[68:71], v[116:119]
  s_waitcnt lgkmcnt(6)
  v_mfma_f32_16x16x32_bf16 v[40:43], a[0:3], a[16:19], v[40:43]
  ds_read_b128 a[52:55], v201
  s_add_u32 m0, s47, 65536
  s_add_u32 s46, s47, 0
  buffer_load_dwordx4 v8, s[32:35], s46 offen nt lds
  s_mul_i32 s48, s58, 20480
  v_mfma_f32_16x16x32_bf16 v[44:47], a[0:3], a[20:23], v[44:47]
  ds_read_b64_tr_b16 a[36:37], v196 offset:8192
  s_add_u32 s48, s48, 86016
  v_mfma_f32_16x16x32_bf16 v[48:51], a[0:3], a[24:27], v[48:51]
  ds_read_b64_tr_b16 a[38:39], v196 offset:9216
  buffer_load_dwordx4 v9, s[32:35], s46 offen offset:1024 nt lds
  s_lshl_b32 s50, s59, 14
  v_mfma_f32_16x16x32_bf16 v[52:55], a[0:3], a[28:31], v[52:55]
  ds_read_b128 a[56:59], v201 offset:2048
  s_add_u32 s50, s50, s48
  v_mfma_f32_16x16x32_bf16 v[56:59], a[0:3], a[32:35], v[56:59]
  ds_read_b128 a[60:63], v201 offset:4096
  buffer_load_dwordx4 v8, s[32:35], s46 offen offset:2048 nt lds
  v_add_u32 v32, s50, v2
  s_waitcnt lgkmcnt(5)
  v_mfma_f32_16x16x32_bf16 v[60:63], a[4:7], a[16:19], v[60:63]
  ds_read_b128 a[64:67], v201 offset:6144
  s_mul_i32 s50, s59, -8192
  v_mfma_f32_16x16x32_bf16 v[64:67], a[4:7], a[20:23], v[64:67]
  ds_read_b128 a[68:71], v201 offset:8192
  buffer_load_dwordx4 v9, s[32:35], s46 offen offset:3072 nt lds
  s_add_u32 s50, s50, 4096
  v_mfma_f32_16x16x32_bf16 v[68:71], a[4:7], a[24:27], v[68:71]
  ds_read_b64_tr_b16 a[40:41], v197 offset:8192
  v_add_u32 v33, s50, v32
  v_mfma_f32_16x16x32_bf16 v[72:75], a[4:7], a[28:31], v[72:75]
  ds_read_b64_tr_b16 a[42:43], v197 offset:9216
  v_add_u32 v34, s50, v33
  v_mfma_f32_16x16x32_bf16 v[76:79], a[4:7], a[32:35], v[76:79]
  ds_read_b64_tr_b16 a[44:45], v198 offset:8192
  v_add_u32 v35, s50, v34
  v_mfma_f32_16x16x32_bf16 v[80:83], a[8:11], a[16:19], v[80:83]
  ds_read_b64_tr_b16 a[46:47], v198 offset:9216
  v_add_u32 v213, s50, v35
  v_mfma_f32_16x16x32_bf16 v[84:87], a[8:11], a[20:23], v[84:87]
  ds_read_b64_tr_b16 a[48:49], v199 offset:8192
  s_lshl_b32 s50, s59, 11
  v_mfma_f32_16x16x32_bf16 v[88:91], a[8:11], a[24:27], v[88:91]
  ds_read_b64_tr_b16 a[50:51], v199 offset:9216
  s_add_u32 s48, s48, s50
  v_mfma_f32_16x16x32_bf16 v[92:95], a[8:11], a[28:31], v[92:95]
  v_lshrrev_b32 v208, 1, v204
  v_mfma_f32_16x16x32_bf16 v[96:99], a[8:11], a[32:35], v[96:99]
  v_lshlrev_b32 v212, 8, v208
  v_mfma_f32_16x16x32_bf16 v[100:103], a[12:15], a[16:19], v[100:103]
  v_lshl_add_u32 v212, v207, 4, v212
  v_mfma_f32_16x16x32_bf16 v[104:107], a[12:15], a[20:23], v[104:107]
  v_and_b32 v208, 1, v204
  v_mfma_f32_16x16x32_bf16 v[108:111], a[12:15], a[24:27], v[108:111]
  v_lshl_add_u32 v212, v208, 3, v212
  v_mfma_f32_16x16x32_bf16 v[112:115], a[12:15], a[28:31], v[112:115]
  v_add_u32 v212, s48, v212
  v_mfma_f32_16x16x32_bf16 v[116:119], a[12:15], a[32:35], v[116:119]
  s_waitcnt lgkmcnt(0)
  v_mfma_f32_16x16x32_bf16 v[40:43], a[36:39], a[52:55], v[40:43]
  v_mfma_f32_16x16x32_bf16 v[44:47], a[36:39], a[56:59], v[44:47]
  v_mfma_f32_16x16x32_bf16 v[48:51], a[36:39], a[60:63], v[48:51]
  v_mfma_f32_16x16x32_bf16 v[52:55], a[36:39], a[64:67], v[52:55]
  v_mfma_f32_16x16x32_bf16 v[56:59], a[36:39], a[68:71], v[56:59]
  v_mfma_f32_16x16x32_bf16 v[60:63], a[40:43], a[52:55], v[60:63]
  s_nop 2
  v_pk_mul_f32 v[40:41], v[40:41], s[54:55]
  v_pk_mul_f32 v[42:43], v[42:43], s[54:55]
  v_cvt_pk_bf16_f32 v216, v40, v41
  v_cvt_pk_bf16_f32 v217, v42, v43
  ds_write_b64 v212, v[216:217]
  v_mfma_f32_16x16x32_bf16 v[64:67], a[40:43], a[56:59], v[64:67]
  v_pk_mul_f32 v[44:45], v[44:45], s[54:55]
  v_pk_mul_f32 v[46:47], v[46:47], s[54:55]
  v_cvt_pk_bf16_f32 v218, v44, v45
  v_cvt_pk_bf16_f32 v219, v46, v47
  ds_write_b64 v212, v[218:219] offset:4096
  v_mfma_f32_16x16x32_bf16 v[68:71], a[40:43], a[60:63], v[68:71]
  v_pk_mul_f32 v[48:49], v[48:49], s[54:55]
  v_pk_mul_f32 v[50:51], v[50:51], s[54:55]
  v_cvt_pk_bf16_f32 v220, v48, v49
  v_cvt_pk_bf16_f32 v221, v50, v51
  ds_write_b64 v212, v[220:221] offset:8192
  v_mfma_f32_16x16x32_bf16 v[72:75], a[40:43], a[64:67], v[72:75]
  v_pk_mul_f32 v[52:53], v[52:53], s[54:55]
  v_pk_mul_f32 v[54:55], v[54:55], s[54:55]
  v_cvt_pk_bf16_f32 v216, v52, v53
  v_cvt_pk_bf16_f32 v217, v54, v55
  ds_write_b64 v212, v[216:217] offset:12288
  v_mfma_f32_16x16x32_bf16 v[76:79], a[40:43], a[68:71], v[76:79]
  v_pk_mul_f32 v[56:57], v[56:57], s[54:55]
  v_pk_mul_f32 v[58:59], v[58:59], s[54:55]
  v_cvt_pk_bf16_f32 v218, v56, v57
  v_cvt_pk_bf16_f32 v219, v58, v59
  ds_write_b64 v212, v[218:219] offset:16384
  v_mfma_f32_16x16x32_bf16 v[80:83], a[44:47], a[52:55], v[80:83]
  v_pk_mul_f32 v[60:61], v[60:61], s[54:55]
  v_pk_mul_f32 v[62:63], v[62:63], s[54:55]
  v_cvt_pk_bf16_f32 v220, v60, v61
  v_cvt_pk_bf16_f32 v221, v62, v63
  ds_write_b64 v212, v[220:221] offset:512
  v_mfma_f32_16x16x32_bf16 v[84:87], a[44:47], a[56:59], v[84:87]
  v_pk_mul_f32 v[64:65], v[64:65], s[54:55]
  v_pk_mul_f32 v[66:67], v[66:67], s[54:55]
  v_cvt_pk_bf16_f32 v216, v64, v65
  v_cvt_pk_bf16_f32 v217, v66, v67
  ds_write_b64 v212, v[216:217] offset:4608
  v_mfma_f32_16x16x32_bf16 v[88:91], a[44:47], a[60:63], v[88:91]
  v_pk_mul_f32 v[68:69], v[68:69], s[54:55]
  v_pk_mul_f32 v[70:71], v[70:71], s[54:55]
  v_cvt_pk_bf16_f32 v218, v68, v69
  v_cvt_pk_bf16_f32 v219, v70, v71
  ds_write_b64 v212, v[218:219] offset:8704
  v_mfma_f32_16x16x32_bf16 v[92:95], a[44:47], a[64:67], v[92:95]
  v_pk_mul_f32 v[72:73], v[72:73], s[54:55]
  v_pk_mul_f32 v[74:75], v[74:75], s[54:55]
  v_cvt_pk_bf16_f32 v220, v72, v73
  v_cvt_pk_bf16_f32 v221, v74, v75
  ds_write_b64 v212, v[220:221] offset:12800
  v_mfma_f32_16x16x32_bf16 v[96:99], a[44:47], a[68:71], v[96:99]
  v_pk_mul_f32 v[76:77], v[76:77], s[54:55]
  v_pk_mul_f32 v[78:79], v[78:79], s[54:55]
  v_cvt_pk_bf16_f32 v216, v76, v77
  v_cvt_pk_bf16_f32 v217, v78, v79
  ds_write_b64 v212, v[216:217] offset:16896
  v_mfma_f32_16x16x32_bf16 v[100:103], a[48:51], a[52:55], v[100:103]
  v_pk_mul_f32 v[80:81], v[80:81], s[54:55]
  v_pk_mul_f32 v[82:83], v[82:83], s[54:55]
  v_cvt_pk_bf16_f32 v218, v80, v81
  v_cvt_pk_bf16_f32 v219, v82, v83
  ds_write_b64 v212, v[218:219] offset:1024
  v_mfma_f32_16x16x32_bf16 v[104:107], a[48:51], a[56:59], v[104:107]
  v_pk_mul_f32 v[84:85], v[84:85], s[54:55]
  v_pk_mul_f32 v[86:87], v[86:87], s[54:55]
  v_cvt_pk_bf16_f32 v220, v84, v85
  v_cvt_pk_bf16_f32 v221, v86, v87
  ds_write_b64 v212, v[220:221] offset:5120
  v_mfma_f32_16x16x32_bf16 v[108:111], a[48:51], a[60:63], v[108:111]
  v_pk_mul_f32 v[88:89], v[88:89], s[54:55]
  v_pk_mul_f32 v[90:91], v[90:91], s[54:55]
  v_cvt_pk_bf16_f32 v216, v88, v89
  v_cvt_pk_bf16_f32 v217, v90, v91
  ds_write_b64 v212, v[216:217] offset:9216
  v_mfma_f32_16x16x32_bf16 v[112:115], a[48:51], a[64:67], v[112:115]
  v_pk_mul_f32 v[92:93], v[92:93], s[54:55]
  v_pk_mul_f32 v[94:95], v[94:95], s[54:55]
  v_cvt_pk_bf16_f32 v218, v92, v93
  v_cvt_pk_bf16_f32 v219, v94, v95
  ds_write_b64 v212, v[218:219] offset:13312
  v_mfma_f32_16x16x32_bf16 v[116:119], a[48:51], a[68:71], v[116:119]
  v_pk_mul_f32 v[96:97], v[96:97], s[54:55]
  v_pk_mul_f32 v[98:99], v[98:99], s[54:55]
  v_cvt_pk_bf16_f32 v220, v96, v97
  v_cvt_pk_bf16_f32 v221, v98, v99
  ds_write_b64 v212, v[220:221] offset:17408
  v_pk_mul_f32 v[100:101], v[100:101], s[54:55]
  v_pk_mul_f32 v[102:103], v[102:103], s[54:55]
  v_cvt_pk_bf16_f32 v216, v100, v101
  v_cvt_pk_bf16_f32 v217, v102, v103
  ds_write_b64 v212, v[216:217] offset:1536
  v_pk_mul_f32 v[104:105], v[104:105], s[54:55]
  v_pk_mul_f32 v[106:107], v[106:107], s[54:55]
  v_cvt_pk_bf16_f32 v218, v104, v105
  v_cvt_pk_bf16_f32 v219, v106, v107
  ds_write_b64 v212, v[218:219] offset:5632
  v_pk_mul_f32 v[108:109], v[108:109], s[54:55]
  v_pk_mul_f32 v[110:111], v[110:111], s[54:55]
  v_cvt_pk_bf16_f32 v220, v108, v109
  v_cvt_pk_bf16_f32 v221, v110, v111
  ds_write_b64 v212, v[220:221] offset:9728
  v_pk_mul_f32 v[112:113], v[112:113], s[54:55]
  v_pk_mul_f32 v[114:115], v[114:115], s[54:55]
  v_cvt_pk_bf16_f32 v216, v112, v113
  v_cvt_pk_bf16_f32 v217, v114, v115
  ds_write_b64 v212, v[216:217] offset:13824
  v_pk_mul_f32 v[116:117], v[116:117], s[54:55]
  v_pk_mul_f32 v[118:119], v[118:119], s[54:55]
  v_cvt_pk_bf16_f32 v218, v116, v117
  v_cvt_pk_bf16_f32 v219, v118, v119
  ds_write_b64 v212, v[218:219] offset:17920
  s_add_u32 m0, s47, 49152
  s_add_u32 s46, s47, 49152
  buffer_load_dwordx4 v4, s[28:31], s46 offen nt lds
  buffer_load_dwordx4 v5, s[28:31], s46 offen offset:1024 nt lds
  buffer_load_dwordx4 v6, s[28:31], s46 offen offset:2048 nt lds
  buffer_load_dwordx4 v7, s[28:31], s46 offen offset:3072 nt lds
  s_waitcnt lgkmcnt(0)
  s_barrier
Ljoin:
  ds_read_b128 a[176:179], v32
  ds_read_b128 a[192:195], v33
  ds_read_b128 a[208:211], v34
  ds_read_b128 a[224:227], v35
  ds_read_b128 a[240:243], v213
  ds_read_b128 a[160:163], v10
  ds_read_b128 a[164:167], v11
  ds_read_b128 a[180:183], v32 offset:1024
  ds_read_b128 a[196:199], v33 offset:1024
  ds_read_b128 a[212:215], v34 offset:1024
  ds_read_b128 a[228:231], v35 offset:1024
  ds_read_b128 a[244:247], v213 offset:1024
  ds_read_b128 a[184:187], v32 offset:2048
  ds_read_b128 a[200:203], v33 offset:2048
  ds_read_b128 a[216:219], v34 offset:2048
  ds_read_b128 a[232:235], v35 offset:2048
  ds_read_b128 a[248:251], v213 offset:2048
  ds_read_b128 a[188:191], v32 offset:3072
  ds_read_b128 a[204:207], v33 offset:3072
  ds_read_b128 a[220:223], v34 offset:3072
  ds_read_b128 a[236:239], v35 offset:3072
  ds_read_b128 a[252:255], v213 offset:3072
  s_waitcnt lgkmcnt(15)
  v_mfma_f32_16x16x32_bf16 v[40:43], a[160:163], a[176:179], 0
  v_mfma_f32_16x16x32_bf16 v[48:51], a[160:163], a[192:195], 0
  ds_read_b128 a[168:171], v12
  v_mfma_f32_16x16x32_bf16 v[56:59], a[160:163], a[208:211], 0
  v_mfma_f32_16x16x32_bf16 v[64:67], a[160:163], a[224:227], 0
  v_mfma_f32_16x16x32_bf16 v[72:75], a[160:163], a[240:243], 0
  s_waitcnt lgkmcnt(15)
  v_mfma_f32_16x16x32_bf16 v[40:43], a[164:167], a[180:183], v[40:43]
  s_waitcnt lgkmcnt(14)
  v_mfma_f32_16x16x32_bf16 v[48:51], a[164:167], a[196:199], v[48:51]
  ds_read_b128 a[172:175], v13
  s_waitcnt lgkmcnt(14)
  v_mfma_f32_16x16x32_bf16 v[56:59], a[164:167], a[212:215], v[56:59]
  s_waitcnt lgkmcnt(13)
  v_mfma_f32_16x16x32_bf16 v[64:67], a[164:167], a[228:231], v[64:67]
  s_waitcnt lgkmcnt(12)
  v_mfma_f32_16x16x32_bf16 v[72:75], a[164:167], a[244:247], v[72:75]
  s_waitcnt lgkmcnt(1)
  v_mfma_f32_16x16x32_bf16 v[40:43], a[168:171], a[184:187], v[40:43]
  v_mfma_f32_16x16x32_bf16 v[48:51], a[168:171], a[200:203], v[48:51]
  ds_read_b128 a[160:163], v10 offset:4096
  v_mfma_f32_16x16x32_bf16 v[56:59], a[168:171], a[216:219], v[56:59]
  v_mfma_f32_16x16x32_bf16 v[64:67], a[168:171], a[232:235], v[64:67]
  v_mfma_f32_16x16x32_bf16 v[72:75], a[168:171], a[248:251], v[72:75]
  s_waitcnt lgkmcnt(1)
  v_mfma_f32_16x16x32_bf16 v[40:43], a[172:175], a[188:191], v[40:43]
  v_mfma_f32_16x16x32_bf16 v[48:51], a[172:175], a[204:207], v[48:51]
  ds_read_b128 a[164:167], v11 offset:4096
  v_mfma_f32_16x16x32_bf16 v[56:59], a[172:175], a[220:223], v[56:59]
  v_mfma_f32_16x16x32_bf16 v[64:67], a[172:175], a[236:239], v[64:67]
  v_mfma_f32_16x16x32_bf16 v[72:75], a[172:175], a[252:255], v[72:75]
  s_waitcnt lgkmcnt(1)
  v_mfma_f32_16x16x32_bf16 v[44:47], a[160:163], a[176:179], 0
  v_mfma_f32_16x16x32_bf16 v[52:55], a[160:163], a[192:195], 0
  ds_read_b128 a[168:171], v12 offset:4096
  v_mfma_f32_16x16x32_bf16 v[60:63], a[160:163], a[208:211], 0
  v_mfma_f32_16x16x32_bf16 v[68:71], a[160:163], a[224:227], 0
  v_mfma_f32_16x16x32_bf16 v[76:79], a[160:163], a[240:243], 0
  s_waitcnt lgkmcnt(1)
  v_mfma_f32_16x16x32_bf16 v[44:47], a[164:167], a[180:183], v[44:47]
  v_mfma_f32_16x16x32_bf16 v[52:55], a[164:167], a[196:199], v[52:55]
  ds_read_b128 a[172:175], v13 offset:4096
  v_mfma_f32_16x16x32_bf16 v[60:63], a[164:167], a[212:215], v[60:63]
  v_mfma_f32_16x16x32_bf16 v[68:71], a[164:167], a[228:231], v[68:71]
  v_mfma_f32_16x16x32_bf16 v[76:79], a[164:167], a[244:247], v[76:79]
  s_waitcnt lgkmcnt(1)
  v_mfma_f32_16x16x32_bf16 v[44:47], a[168:171], a[184:187], v[44:47]
  v_mfma_f32_16x16x32_bf16 v[52:55], a[168:171], a[200:203], v[52:55]
  s_waitcnt lgkmcnt(0) vmcnt(12)
  s_barrier
  ds_read_b128 a[160:163], v10 offset:16384
  v_mfma_f32_16x16x32_bf16 v[60:63], a[168:171], a[216:219], v[60:63]
  v_mfma_f32_16x16x32_bf16 v[68:71], a[168:171], a[232:235], v[68:71]
  v_mfma_f32_16x16x32_bf16 v[76:79], a[168:171], a[248:251], v[76:79]
  s_add_u32 m0, s47, 81920
  s_add_u32 s46, s47, 16384
  s_waitcnt vmcnt(5)
  buffer_load_dwordx4 v8, s[32:35], s46 offen nt lds
  v_mfma_f32_16x16x32_bf16 v[44:47], a[172:175], a[188:191], v[44:47]
  v_mfma_f32_16x16x32_bf16 v[52:55], a[172:175], a[204:207], v[52:55]
  s_waitcnt vmcnt(5)
  buffer_load_dwordx4 v9, s[32:35], s46 offen offset:1024 nt lds
  ds_read_b128 a[164:167], v11 offset:16384
  v_mfma_f32_16x16x32_bf16 v[60:63], a[172:175], a[220:223], v[60:63]
  v_mfma_f32_16x16x32_bf16 v[68:71], a[172:175], a[236:239], v[68:71]
  s_waitcnt vmcnt(5)
  buffer_load_dwordx4 v8, s[32:35], s46 offen offset:2048 nt lds
  v_mfma_f32_16x16x32_bf16 v[76:79], a[172:175], a[252:255], v[76:79]
  v_max3_f32 v204, v40, v41, v42
  v_max3_f32 v204, v204, v43, v44
  v_max3_f32 v204, v204, v45, v46
  v_max_f32 v204, v204, v47
  v_max3_f32 v205, v48, v49, v50
  v_max3_f32 v205, v205, v51, v52
  v_max3_f32 v205, v205, v53, v54
  v_max_f32 v205, v205, v55
  v_max3_f32 v206, v56, v57, v58
  v_max3_f32 v206, v206, v59, v60
  v_max3_f32 v206, v206, v61, v62
  v_max_f32 v206, v206, v63
  v_max3_f32 v207, v64, v65, v66
  v_max3_f32 v207, v207, v67, v68
  v_max3_f32 v207, v207, v69, v70
  v_max_f32 v207, v207, v71
  v_max3_f32 v208, v72, v73, v74
  v_max3_f32 v208, v208, v75, v76
  v_max3_f32 v208, v208, v77, v78
  v_max_f32 v208, v208, v79
  v_mov_b32 v209, v204
  v_mov_b32 v210, v205
  v_mov_b32 v211, v206
  v_mov_b32 v212, v207
  v_mov_b32 v213, v208
  v_permlane32_swap_b32 v204, v209
  v_permlane32_swap_b32 v205, v210
  v_permlane32_swap_b32 v206, v211
  v_permlane32_swap_b32 v207, v212
  v_permlane32_swap_b32 v208, v213
  v_max_f32 v204, v204, v209
  v_max_f32 v205, v205, v210
  v_max_f32 v206, v206, v211
  v_max_f32 v207, v207, v212
  v_max_f32 v208, v208, v213
  v_mov_b32 v209, v204
  v_mov_b32 v210, v205
  v_mov_b32 v211, v206
  v_mov_b32 v212, v207
  v_mov_b32 v213, v208
  v_permlane16_swap_b32 v204, v209
  v_permlane16_swap_b32 v205, v210
  v_permlane16_swap_b32 v206, v211
  v_permlane16_swap_b32 v207, v212
  v_permlane16_swap_b32 v208, v213
  v_max_f32 v204, v204, v209
  v_max_f32 v205, v205, v210
  v_max_f32 v206, v206, v211
  v_max_f32 v207, v207, v212
  v_max_f32 v208, v208, v213
  v_sub_f32 v160, 0, v204
  v_sub_f32 v161, 0, v204
  v_sub_f32 v162, 0, v204
  v_sub_f32 v163, 0, v204
  v_sub_f32 v164, 0, v205
  v_sub_f32 v165, 0, v205
  v_sub_f32 v166, 0, v205
  v_sub_f32 v167, 0, v205
  v_sub_f32 v168, 0, v206
  v_sub_f32 v169, 0, v206
  v_sub_f32 v170, 0, v206
  v_sub_f32 v171, 0, v206
  v_sub_f32 v172, 0, v207
  v_sub_f32 v173, 0, v207
  v_sub_f32 v174, 0, v207
  v_sub_f32 v175, 0, v207
  v_sub_f32 v176, 0, v208
  v_sub_f32 v177, 0, v208
  v_sub_f32 v178, 0, v208
  v_sub_f32 v179, 0, v208
  v_sub_f32 v40, v40, v204
  v_sub_f32 v41, v41, v204
  v_sub_f32 v42, v42, v204
  v_sub_f32 v43, v43, v204
  v_sub_f32 v44, v44, v204
  v_sub_f32 v45, v45, v204
  v_sub_f32 v46, v46, v204
  v_sub_f32 v47, v47, v204
  v_sub_f32 v48, v48, v205
  v_sub_f32 v49, v49, v205
  v_sub_f32 v50, v50, v205
  v_sub_f32 v51, v51, v205
  v_sub_f32 v52, v52, v205
  v_sub_f32 v53, v53, v205
  v_sub_f32 v54, v54, v205
  v_sub_f32 v55, v55, v205
  v_sub_f32 v56, v56, v206
  v_sub_f32 v57, v57, v206
  v_sub_f32 v58, v58, v206
  v_sub_f32 v59, v59, v206
  v_sub_f32 v60, v60, v206
  v_sub_f32 v61, v61, v206
  v_sub_f32 v62, v62, v206
  v_sub_f32 v63, v63, v206
  v_sub_f32 v64, v64, v207
  v_sub_f32 v65, v65, v207
  v_sub_f32 v66, v66, v207
  v_sub_f32 v67, v67, v207
  v_sub_f32 v68, v68, v207
  v_sub_f32 v69, v69, v207
  v_sub_f32 v70, v70, v207
  v_sub_f32 v71, v71, v207
  v_sub_f32 v72, v72, v208
  v_sub_f32 v73, v73, v208
  v_sub_f32 v74, v74, v208
  v_sub_f32 v75, v75, v208
  v_sub_f32 v76, v76, v208
  v_sub_f32 v77, v77, v208
  v_sub_f32 v78, v78, v208
  v_sub_f32 v79, v79, v208
  s_waitcnt lgkmcnt(1)
  v_mfma_f32_16x16x32_bf16 v[80:83], a[160:163], a[176:179], v[160:163]
  s_waitcnt vmcnt(5)
  buffer_load_dwordx4 v9, s[32:35], s46 offen offset:3072 nt lds
  v_exp_f32 v32, v40
  v_exp_f32 v33, v41
  v_mfma_f32_16x16x32_bf16 v[88:91], a[160:163], a[192:195], v[164:167]
  ds_read_b128 a[168:171], v12 offset:16384
  v_exp_f32 v34, v42
  v_add_f32 v27, v32, v33
  v_cvt_pk_bf16_f32 v120, v32, v33
  v_mfma_f32_16x16x32_bf16 v[96:99], a[160:163], a[208:211], v[168:171]
  v_exp_f32 v35, v43
  v_add_f32 v27, v27, v34
  v_exp_f32 v32, v44
  v_mfma_f32_16x16x32_bf16 v[104:107], a[160:163], a[224:227], v[172:175]
  v_add_f32 v27, v27, v35
  v_cvt_pk_bf16_f32 v121, v34, v35
  v_mfma_f32_16x16x32_bf16 v[112:115], a[160:163], a[240:243], v[176:179]
  v_exp_f32 v33, v45
  v_add_f32 v27, v27, v32
  v_exp_f32 v34, v46
  s_waitcnt lgkmcnt(1)
  v_mfma_f32_16x16x32_bf16 v[80:83], a[164:167], a[180:183], v[80:83]
  v_add_f32 v27, v27, v33
  v_cvt_pk_bf16_f32 v122, v32, v33
  v_exp_f32 v35, v47
  v_mfma_f32_16x16x32_bf16 v[88:91], a[164:167], a[196:199], v[88:91]
  ds_read_b128 a[172:175], v13 offset:16384
  v_add_f32 v27, v27, v34
  v_exp_f32 v32, v48
  v_mfma_f32_16x16x32_bf16 v[96:99], a[164:167], a[212:215], v[96:99]
  v_add_f32 v27, v27, v35
  v_cvt_pk_bf16_f32 v123, v34, v35
  v_exp_f32 v33, v49
  v_mfma_f32_16x16x32_bf16 v[104:107], a[164:167], a[228:231], v[104:107]
  v_exp_f32 v34, v50
  v_add_f32 v28, v32, v33
  v_mfma_f32_16x16x32_bf16 v[112:115], a[164:167], a[244:247], v[112:115]
  v_cvt_pk_bf16_f32 v124, v32, v33
  v_exp_f32 v35, v51
  v_add_f32 v28, v28, v34
  s_waitcnt lgkmcnt(1)
  v_mfma_f32_16x16x32_bf16 v[80:83], a[168:171], a[184:187], v[80:83]
  v_exp_f32 v32, v52
  v_add_f32 v28, v28, v35
  v_cvt_pk_bf16_f32 v125, v34, v35
  v_mfma_f32_16x16x32_bf16 v[88:91], a[168:171], a[200:203], v[88:91]
  ds_read_b128 a[160:163], v10 offset:20480
  v_exp_f32 v33, v53
  v_add_f32 v28, v28, v32
  v_mfma_f32_16x16x32_bf16 v[96:99], a[168:171], a[216:219], v[96:99]
  v_exp_f32 v34, v54
  v_add_f32 v28, v28, v33
  v_cvt_pk_bf16_f32 v126, v32, v33
  v_mfma_f32_16x16x32_bf16 v[104:107], a[168:171], a[232:235], v[104:107]
  v_exp_f32 v35, v55
  v_add_f32 v28, v28, v34
  v_exp_f32 v32, v56
  v_mfma_f32_16x16x32_bf16 v[112:115], a[168:171], a[248:251], v[112:115]
  v_add_f32 v28, v28, v35
  v_cvt_pk_bf16_f32 v127, v34, v35
  v_exp_f32 v33, v57
  s_waitcnt lgkmcnt(1)
  v_mfma_f32_16x16x32_bf16 v[80:83], a[172:175], a[188:191], v[80:83]
  v_exp_f32 v34, v58
  v_mfma_f32_16x16x32_bf16 v[88:91], a[172:175], a[204:207], v[88:91]
  ds_read_b128 a[164:167], v11 offset:20480
  v_add_f32 v29, v32, v33
  v_cvt_pk_bf16_f32 v128, v32, v33
  v_exp_f32 v35, v59
  v_mfma_f32_16x16x32_bf16 v[96:99], a[172:175], a[220:223], v[96:99]
  v_add_f32 v29, v29, v34
  v_exp_f32 v32, v60
  v_add_f32 v29, v29, v35
  v_mfma_f32_16x16x32_bf16 v[104:107], a[172:175], a[236:239], v[104:107]
  v_cvt_pk_bf16_f32 v129, v34, v35
  v_exp_f32 v33, v61
  v_add_f32 v29, v29, v32
  v_mfma_f32_16x16x32_bf16 v[112:115], a[172:175], a[252:255], v[112:115]
  v_exp_f32 v34, v62
  v_add_f32 v29, v29, v33
  s_waitcnt lgkmcnt(1)
  v_mfma_f32_16x16x32_bf16 v[84:87], a[160:163], a[176:179], v[160:163]
  v_cvt_pk_bf16_f32 v130, v32, v33
  v_exp_f32 v35, v63
  v_add_f32 v29, v29, v34
  v_mfma_f32_16x16x32_bf16 v[92:95], a[160:163], a[192:195], v[164:167]
  ds_read_b128 a[168:171], v12 offset:20480
  v_exp_f32 v32, v64
  v_add_f32 v29, v29, v35
  v_cvt_pk_bf16_f32 v131, v34, v35
  v_mfma_f32_16x16x32_bf16 v[100:103], a[160:163], a[208:211], v[168:171]
  v_exp_f32 v33, v65
  v_exp_f32 v34, v66
  v_mfma_f32_16x16x32_bf16 v[108:111], a[160:163], a[224:227], v[172:175]
  v_add_f32 v30, v32, v33
  v_cvt_pk_bf16_f32 v132, v32, v33
  v_exp_f32 v35, v67
  v_mfma_f32_16x16x32_bf16 v[116:119], a[160:163], a[240:243], v[176:179]
  v_add_f32 v30, v30, v34
  v_exp_f32 v32, v68
  s_waitcnt lgkmcnt(1)
  v_mfma_f32_16x16x32_bf16 v[84:87], a[164:167], a[180:183], v[84:87]
  v_add_f32 v30, v30, v35
  v_cvt_pk_bf16_f32 v133, v34, v35
  v_exp_f32 v33, v69
  v_mfma_f32_16x16x32_bf16 v[92:95], a[164:167], a[196:199], v[92:95]
  ds_read_b128 a[172:175], v13 offset:20480
  v_add_f32 v30, v30, v32
  v_exp_f32 v34, v70
  v_add_f32 v30, v30, v33
  v_mfma_f32_16x16x32_bf16 v[100:103], a[164:167], a[212:215], v[100:103]
  v_cvt_pk_bf16_f32 v134, v32, v33
  v_exp_f32 v35, v71
  v_mfma_f32_16x16x32_bf16 v[108:111], a[164:167], a[228:231], v[108:111]
  v_add_f32 v30, v30, v34
  v_exp_f32 v32, v72
  v_add_f32 v30, v30, v35
  v_mfma_f32_16x16x32_bf16 v[116:119], a[164:167], a[244:247], v[116:119]
  v_cvt_pk_bf16_f32 v135, v34, v35
  v_exp_f32 v33, v73
  v_exp_f32 v34, v74
  s_waitcnt lgkmcnt(1)
  v_mfma_f32_16x16x32_bf16 v[84:87], a[168:171], a[184:187], v[84:87]
  v_add_f32 v31, v32, v33
  v_cvt_pk_bf16_f32 v136, v32, v33
  v_exp_f32 v35, v75
  v_mfma_f32_16x16x32_bf16 v[92:95], a[168:171], a[200:203], v[92:95]
  s_waitcnt lgkmcnt(0)
  s_barrier
  ds_read_b128 a[160:163], v10 offset:32768
  v_add_f32 v31, v31, v34
  v_exp_f32 v32, v76
  v_mfma_f32_16x16x32_bf16 v[100:103], a[168:171], a[216:219], v[100:103]
  v_add_f32 v31, v31, v35
  v_cvt_pk_bf16_f32 v137, v34, v35
  v_exp_f32 v33, v77
  v_mfma_f32_16x16x32_bf16 v[108:111], a[168:171], a[232:235], v[108:111]
  v_add_f32 v31, v31, v32
  v_exp_f32 v34, v78
  v_mfma_f32_16x16x32_bf16 v[116:119], a[168:171], a[248:251], v[116:119]
  s_add_u32 m0, s47, 0
  s_add_u32 s46, s47, 65536
  s_waitcnt vmcnt(5)
  buffer_load_dwordx4 v4, s[28:31], s46 offen nt lds
  v_add_f32 v31, v31, v33
  v_cvt_pk_bf16_f32 v138, v32, v33
  v_exp_f32 v35, v79
  v_mfma_f32_16x16x32_bf16 v[84:87], a[172:175], a[188:191], v[84:87]
  v_add_f32 v31, v31, v34
  v_add_f32 v31, v31, v35
  v_cvt_pk_bf16_f32 v139, v34, v35
  v_mfma_f32_16x16x32_bf16 v[92:95], a[172:175], a[204:207], v[92:95]
  ds_read_b128 a[164:167], v11 offset:32768
  v_mfma_f32_16x16x32_bf16 v[100:103], a[172:175], a[220:223], v[100:103]
  v_mfma_f32_16x16x32_bf16 v[108:111], a[172:175], a[236:239], v[108:111]
  v_mfma_f32_16x16x32_bf16 v[116:119], a[172:175], a[252:255], v[116:119]
  v_add_f32 v22, v22, v27
  v_add_f32 v23, v23, v28
  v_add_f32 v24, v24, v29
  v_add_f32 v25, v25, v30
  v_add_f32 v26, v26, v31
  s_waitcnt lgkmcnt(1)
  v_mfma_f32_16x16x32_bf16 v[40:43], a[160:163], a[176:179], v[160:163]
  v_exp_f32 v32, v80
  v_mfma_f32_16x16x32_bf16 v[48:51], a[160:163], a[192:195], v[164:167]
  ds_read_b128 a[168:171], v12 offset:32768
  v_exp_f32 v33, v81
  v_mfma_f32_16x16x32_bf16 v[56:59], a[160:163], a[208:211], v[168:171]
  s_waitcnt vmcnt(5)
  buffer_load_dwordx4 v5, s[28:31], s46 offen offset:1024 nt lds
  v_exp_f32 v34, v82
  v_mfma_f32_16x16x32_bf16 v[64:67], a[160:163], a[224:227], v[172:175]
  v_add_f32 v27, v32, v33
  v_cvt_pk_bf16_f32 v140, v32, v33
  v_mfma_f32_16x16x32_bf16 v[72:75], a[160:163], a[240:243], v[176:179]
  v_exp_f32 v35, v83
  s_waitcnt lgkmcnt(1)
  v_mfma_f32_16x16x32_bf16 v[40:43], a[164:167], a[180:183], v[40:43]
  v_add_f32 v27, v27, v34
  v_mfma_f32_16x16x32_bf16 v[48:51], a[164:167], a[196:199], v[48:51]
  ds_read_b128 a[172:175], v13 offset:32768
  v_exp_f32 v32, v84
  v_mfma_f32_16x16x32_bf16 v[56:59], a[164:167], a[212:215], v[56:59]
  v_add_f32 v27, v27, v35
  v_cvt_pk_bf16_f32 v141, v34, v35
  v_mfma_f32_16x16x32_bf16 v[64:67], a[164:167], a[228:231], v[64:67]
  v_exp_f32 v33, v85
  v_mfma_f32_16x16x32_bf16 v[72:75], a[164:167], a[244:247], v[72:75]
  v_add_f32 v27, v27, v32
  s_waitcnt lgkmcnt(1)
  v_mfma_f32_16x16x32_bf16 v[40:43], a[168:171], a[184:187], v[40:43]
  v_exp_f32 v34, v86
  v_mfma_f32_16x16x32_bf16 v[48:51], a[168:171], a[200:203], v[48:51]
  s_waitcnt vmcnt(5)
  buffer_load_dwordx4 v6, s[28:31], s46 offen offset:2048 nt lds
  ds_read_b128 a[160:163], v10 offset:36864
  v_add_f32 v27, v27, v33
  v_cvt_pk_bf16_f32 v142, v32, v33
  v_mfma_f32_16x16x32_bf16 v[56:59], a[168:171], a[216:219], v[56:59]
  v_exp_f32 v35, v87
  v_mfma_f32_16x16x32_bf16 v[64:67], a[168:171], a[232:235], v[64:67]
  v_add_f32 v27, v27, v34
  v_mfma_f32_16x16x32_bf16 v[72:75], a[168:171], a[248:251], v[72:75]
  v_exp_f32 v32, v88
  s_waitcnt lgkmcnt(1)
  v_mfma_f32_16x16x32_bf16 v[40:43], a[172:175], a[188:191], v[40:43]
  v_add_f32 v27, v27, v35
  v_cvt_pk_bf16_f32 v143, v34, v35
  v_mfma_f32_16x16x32_bf16 v[48:51], a[172:175], a[204:207], v[48:51]
  ds_read_b128 a[164:167], v11 offset:36864
  v_exp_f32 v33, v89
  v_mfma_f32_16x16x32_bf16 v[56:59], a[172:175], a[220:223], v[56:59]
  v_exp_f32 v34, v90
  v_mfma_f32_16x16x32_bf16 v[64:67], a[172:175], a[236:239], v[64:67]
  v_add_f32 v28, v32, v33
  v_mfma_f32_16x16x32_bf16 v[72:75], a[172:175], a[252:255], v[72:75]
  v_cvt_pk_bf16_f32 v144, v32, v33
  v_exp_f32 v35, v91
  s_waitcnt lgkmcnt(1)
  v_mfma_f32_16x16x32_bf16 v[44:47], a[160:163], a[176:179], v[160:163]
  s_waitcnt vmcnt(5)
  buffer_load_dwordx4 v7, s[28:31], s46 offen offset:3072 nt lds
  v_add_f32 v28, v28, v34
  v_mfma_f32_16x16x32_bf16 v[52:55], a[160:163], a[192:195], v[164:167]
  ds_read_b128 a[168:171], v12 offset:36864
  v_exp_f32 v32, v92
  v_mfma_f32_16x16x32_bf16 v[60:63], a[160:163], a[208:211], v[168:171]
  v_add_f32 v28, v28, v35
  v_mfma_f32_16x16x32_bf16 v[68:71], a[160:163], a[224:227], v[172:175]
  v_cvt_pk_bf16_f32 v145, v34, v35
  v_exp_f32 v33, v93
  v_mfma_f32_16x16x32_bf16 v[76:79], a[160:163], a[240:243], v[176:179]
  v_add_f32 v28, v28, v32
  s_waitcnt lgkmcnt(1)
  v_mfma_f32_16x16x32_bf16 v[44:47], a[164:167], a[180:183], v[44:47]
  v_exp_f32 v34, v94
  v_mfma_f32_16x16x32_bf16 v[52:55], a[164:167], a[196:199], v[52:55]
  ds_read_b128 a[172:175], v13 offset:36864
  v_add_f32 v28, v28, v33
  v_mfma_f32_16x16x32_bf16 v[60:63], a[164:167], a[212:215], v[60:63]
  v_cvt_pk_bf16_f32 v146, v32, v33
  v_exp_f32 v35, v95
  v_mfma_f32_16x16x32_bf16 v[68:71], a[164:167], a[228:231], v[68:71]
  v_add_f32 v28, v28, v34
  v_mfma_f32_16x16x32_bf16 v[76:79], a[164:167], a[244:247], v[76:79]
  s_add_u32 m0, s47, 98304
  s_add_u32 s46, s47, 32768
  s_waitcnt vmcnt(5)
  buffer_load_dwordx4 v8, s[32:35], s46 offen nt lds
  v_exp_f32 v32, v96
  s_waitcnt lgkmcnt(1)
  v_mfma_f32_16x16x32_bf16 v[44:47], a[168:171], a[184:187], v[44:47]
  v_add_f32 v28, v28, v35
  v_cvt_pk_bf16_f32 v147, v34, v35
  v_mfma_f32_16x16x32_bf16 v[52:55], a[168:171], a[200:203], v[52:55]
  ds_read_b64_tr_b16 a[160:161], v18
  v_exp_f32 v33, v97
  v_mfma_f32_16x16x32_bf16 v[60:63], a[168:171], a[216:219], v[60:63]
  v_exp_f32 v34, v98
  v_mfma_f32_16x16x32_bf16 v[68:71], a[168:171], a[232:235], v[68:71]
  ds_read_b64_tr_b16 a[162:163], v18 offset:4096
  v_add_f32 v29, v32, v33
  v_mfma_f32_16x16x32_bf16 v[76:79], a[168:171], a[248:251], v[76:79]
  v_cvt_pk_bf16_f32 v148, v32, v33
  v_exp_f32 v35, v99
  s_waitcnt lgkmcnt(2)
  v_mfma_f32_16x16x32_bf16 v[44:47], a[172:175], a[188:191], v[44:47]
  v_mfma_f32_16x16x32_bf16 v[52:55], a[172:175], a[204:207], v[52:55]
  ds_read_b64_tr_b16 a[164:165], v19
  v_add_f32 v29, v29, v34
  v_exp_f32 v32, v100
  v_mfma_f32_16x16x32_bf16 v[60:63], a[172:175], a[220:223], v[60:63]
  v_add_f32 v29, v29, v35
  v_mfma_f32_16x16x32_bf16 v[68:71], a[172:175], a[236:239], v[68:71]
  s_waitcnt vmcnt(5)
  buffer_load_dwordx4 v9, s[32:35], s46 offen offset:1024 nt lds
  ds_read_b64_tr_b16 a[166:167], v19 offset:4096
  v_cvt_pk_bf16_f32 v149, v34, v35
  v_exp_f32 v33, v101
  v_mfma_f32_16x16x32_bf16 v[76:79], a[172:175], a[252:255], v[76:79]
  v_add_f32 v29, v29, v32
  s_waitcnt lgkmcnt(2)
  v_mfma_f32_16x16x32_bf16 a[80:83], a[160:163], v[120:123], 0
  v_exp_f32 v34, v102
  v_mfma_f32_16x16x32_bf16 a[84:87], a[160:163], v[124:127], 0
  ds_read_b64_tr_b16 a[168:169], v20
  v_add_f32 v29, v29, v33
  v_mfma_f32_16x16x32_bf16 a[88:91], a[160:163], v[128:131], 0
  v_cvt_pk_bf16_f32 v150, v32, v33
  v_exp_f32 v35, v103
  v_mfma_f32_16x16x32_bf16 a[92:95], a[160:163], v[132:135], 0
  ds_read_b64_tr_b16 a[170:171], v20 offset:4096
  v_add_f32 v29, v29, v34
  v_mfma_f32_16x16x32_bf16 a[96:99], a[160:163], v[136:139], 0
  v_exp_f32 v32, v104
  s_waitcnt lgkmcnt(2)
  v_mfma_f32_16x16x32_bf16 a[100:103], a[164:167], v[120:123], 0
  v_add_f32 v29, v29, v35
  v_mfma_f32_16x16x32_bf16 a[104:107], a[164:167], v[124:127], 0
  ds_read_b64_tr_b16 a[172:173], v21
  v_cvt_pk_bf16_f32 v151, v34, v35
  v_exp_f32 v33, v105
  v_mfma_f32_16x16x32_bf16 a[108:111], a[164:167], v[128:131], 0
  s_waitcnt vmcnt(5)
  buffer_load_dwordx4 v8, s[32:35], s46 offen offset:2048 nt lds
  v_exp_f32 v34, v106
  v_mfma_f32_16x16x32_bf16 a[112:115], a[164:167], v[132:135], 0
  ds_read_b64_tr_b16 a[174:175], v21 offset:4096
  v_add_f32 v30, v32, v33
  v_mfma_f32_16x16x32_bf16 a[116:119], a[164:167], v[136:139], 0
  v_cvt_pk_bf16_f32 v152, v32, v33
  s_waitcnt lgkmcnt(2)
  v_mfma_f32_16x16x32_bf16 a[120:123], a[168:171], v[120:123], 0
  v_exp_f32 v35, v107
  v_mfma_f32_16x16x32_bf16 a[124:127], a[168:171], v[124:127], 0
  ds_read_b64_tr_b16 a[160:161], v14
  v_add_f32 v30, v30, v34
  v_exp_f32 v32, v108
  v_mfma_f32_16x16x32_bf16 a[128:131], a[168:171], v[128:131], 0
  v_add_f32 v30, v30, v35
  v_mfma_f32_16x16x32_bf16 a[132:135], a[168:171], v[132:135], 0
  ds_read_b64_tr_b16 a[162:163], v14 offset:4096
  v_cvt_pk_bf16_f32 v153, v34, v35
  v_mfma_f32_16x16x32_bf16 a[136:139], a[168:171], v[136:139], 0
  v_exp_f32 v33, v109
  s_waitcnt lgkmcnt(2)
  v_mfma_f32_16x16x32_bf16 a[140:143], a[172:175], v[120:123], 0
  v_add_f32 v30, v30, v32
  v_exp_f32 v34, v110
  v_mfma_f32_16x16x32_bf16 a[144:147], a[172:175], v[124:127], 0
  s_waitcnt vmcnt(5)
  buffer_load_dwordx4 v9, s[32:35], s46 offen offset:3072 nt lds
  ds_read_b64_tr_b16 a[164:165], v15
  v_add_f32 v30, v30, v33
  v_mfma_f32_16x16x32_bf16 a[148:151], a[172:175], v[128:131], 0
  v_cvt_pk_bf16_f32 v154, v32, v33
  v_exp_f32 v35, v111
  v_mfma_f32_16x16x32_bf16 a[152:155], a[172:175], v[132:135], 0
  ds_read_b64_tr_b16 a[166:167], v15 offset:4096
  v_mfma_f32_16x16x32_bf16 a[156:159], a[172:175], v[136:139], 0
  v_add_f32 v30, v30, v34
  v_exp_f32 v32, v112
  s_waitcnt lgkmcnt(2)
  v_mfma_f32_16x16x32_bf16 a[0:3], a[160:163], v[120:123], 0
  v_add_f32 v30, v30, v35
  v_mfma_f32_16x16x32_bf16 a[4:7], a[160:163], v[124:127], 0
  ds_read_b64_tr_b16 a[168:169], v16
  v_cvt_pk_bf16_f32 v155, v34, v35
  v_exp_f32 v33, v113
  v_mfma_f32_16x16x32_bf16 a[8:11], a[160:163], v[128:131], 0
  v_mfma_f32_16x16x32_bf16 a[12:15], a[160:163], v[132:135], 0
  ds_read_b64_tr_b16 a[170:171], v16 offset:4096
  v_exp_f32 v34, v114
  v_mfma_f32_16x16x32_bf16 a[16:19], a[160:163], v[136:139], 0
  v_add_f32 v31, v32, v33
  v_cvt_pk_bf16_f32 v156, v32, v33
  s_waitcnt lgkmcnt(2)
  v_mfma_f32_16x16x32_bf16 a[20:23], a[164:167], v[120:123], 0
  s_min_u32 s48, s41, 1
  s_lshl_b32 s48, s48, 30
  v_lshrrev_b32 v254, 5, v0
  v_min_u32 v254, 1, v254
  v_lshlrev_b32 v254, 30, v254
  v_lshl_add_u32 v254, v1, 7, v254
  v_add_u32 v254, s48, v254
  v_mov_b32 v3, 0
  s_lshl_b32 s48, s40, 12
  s_add_u32 s48, s48, 29360128
  buffer_store_dword v3, v254, s[36:39], s48 offen sc1
  v_exp_f32 v35, v115
  v_mfma_f32_16x16x32_bf16 a[24:27], a[164:167], v[124:127], 0
  ds_read_b64_tr_b16 a[172:173], v17
  v_add_f32 v31, v31, v34
  v_exp_f32 v32, v116
  v_mfma_f32_16x16x32_bf16 a[28:31], a[164:167], v[128:131], 0
  v_mfma_f32_16x16x32_bf16 a[32:35], a[164:167], v[132:135], 0
  ds_read_b64_tr_b16 a[174:175], v17 offset:4096
  v_add_f32 v31, v31, v35
  v_cvt_pk_bf16_f32 v157, v34, v35
  v_mfma_f32_16x16x32_bf16 a[36:39], a[164:167], v[136:139], 0
  v_exp_f32 v33, v117
  s_waitcnt lgkmcnt(2)
  v_mfma_f32_16x16x32_bf16 a[40:43], a[168:171], v[120:123], 0
  v_add_f32 v31, v31, v32
  v_exp_f32 v34, v118
  v_mfma_f32_16x16x32_bf16 a[44:47], a[168:171], v[124:127], 0
  s_waitcnt lgkmcnt(0)
  s_barrier
  ds_read_b128 a[160:163], v10 offset:49152
  v_mfma_f32_16x16x32_bf16 a[48:51], a[168:171], v[128:131], 0
  v_add_f32 v31, v31, v33
  v_cvt_pk_bf16_f32 v158, v32, v33
  v_mfma_f32_16x16x32_bf16 a[52:55], a[168:171], v[132:135], 0
  v_exp_f32 v35, v119
  v_mfma_f32_16x16x32_bf16 a[56:59], a[168:171], v[136:139], 0
  s_add_u32 m0, s47, 16384
  s_add_u32 s46, s47, 81920
  s_waitcnt vmcnt(5)
  buffer_load_dwordx4 v4, s[28:31], s46 offen nt lds
  v_add_f32 v31, v31, v34
  v_add_f32 v31, v31, v35
  v_mfma_f32_16x16x32_bf16 a[60:63], a[172:175], v[120:123], 0
  v_cvt_pk_bf16_f32 v159, v34, v35
  v_mfma_f32_16x16x32_bf16 a[64:67], a[172:175], v[124:127], 0
  ds_read_b128 a[164:167], v11 offset:49152
  v_max3_f32 v36, v27, v28, v29
  v_mfma_f32_16x16x32_bf16 a[68:71], a[172:175], v[128:131], 0
  v_max3_f32 v36, v36, v30, v31
  v_mfma_f32_16x16x32_bf16 a[72:75], a[172:175], v[132:135], 0
  v_cmp_nge_f32 vcc, s49, v36
  v_mfma_f32_16x16x32_bf16 a[76:79], a[172:175], v[136:139], 0
  s_cbranch_vccnz Lstub1
Lret1:
  v_add_f32 v22, v22, v27
  v_add_f32 v23, v23, v28
  v_add_f32 v24, v24, v29
  v_add_f32 v25, v25, v30
  v_add_f32 v26, v26, v31
  s_waitcnt lgkmcnt(1)
  v_mfma_f32_16x16x32_bf16 v[80:83], a[160:163], a[176:179], v[160:163]
  v_exp_f32 v32, v40
  v_mfma_f32_16x16x32_bf16 v[88:91], a[160:163], a[192:195], v[164:167]
  ds_read_b128 a[168:171], v12 offset:49152
  v_exp_f32 v33, v41
  v_mfma_f32_16x16x32_bf16 v[96:99], a[160:163], a[208:211], v[168:171]
  v_exp_f32 v34, v42
  v_mfma_f32_16x16x32_bf16 v[104:107], a[160:163], a[224:227], v[172:175]
  s_waitcnt vmcnt(5)
  buffer_load_dwordx4 v5, s[28:31], s46 offen offset:1024 nt lds
  v_add_f32 v27, v32, v33
  v_cvt_pk_bf16_f32 v120, v32, v33
  v_mfma_f32_16x16x32_bf16 v[112:115], a[160:163], a[240:243], v[176:179]
  v_exp_f32 v35, v43
  s_waitcnt lgkmcnt(1)
  v_mfma_f32_16x16x32_bf16 v[80:83], a[164:167], a[180:183], v[80:83]
  v_add_f32 v27, v27, v34
  v_mfma_f32_16x16x32_bf16 v[88:91], a[164:167], a[196:199], v[88:91]
  ds_read_b128 a[172:175], v13 offset:49152
  v_exp_f32 v32, v44
  v_mfma_f32_16x16x32_bf16 v[96:99], a[164:167], a[212:215], v[96:99]
  v_add_f32 v27, v27, v35
  v_cvt_pk_bf16_f32 v121, v34, v35
  v_mfma_f32_16x16x32_bf16 v[104:107], a[164:167], a[228:231], v[104:107]
  v_exp_f32 v33, v45
  v_mfma_f32_16x16x32_bf16 v[112:115], a[164:167], a[244:247], v[112:115]
  v_add_f32 v27, v27, v32
  s_waitcnt lgkmcnt(1)
  v_mfma_f32_16x16x32_bf16 v[80:83], a[168:171], a[184:187], v[80:83]
  v_exp_f32 v34, v46
  v_mfma_f32_16x16x32_bf16 v[88:91], a[168:171], a[200:203], v[88:91]
  ds_read_b128 a[160:163], v10 offset:53248
  v_add_f32 v27, v27, v33
  v_cvt_pk_bf16_f32 v122, v32, v33
  v_mfma_f32_16x16x32_bf16 v[96:99], a[168:171], a[216:219], v[96:99]
  v_exp_f32 v35, v47
  v_mfma_f32_16x16x32_bf16 v[104:107], a[168:171], a[232:235], v[104:107]
  s_waitcnt vmcnt(5)
  buffer_load_dwordx4 v6, s[28:31], s46 offen offset:2048 nt lds
  v_add_f32 v27, v27, v34
  v_mfma_f32_16x16x32_bf16 v[112:115], a[168:171], a[248:251], v[112:115]
  v_exp_f32 v32, v48
  s_waitcnt lgkmcnt(1)
  v_mfma_f32_16x16x32_bf16 v[80:83], a[172:175], a[188:191], v[80:83]
  v_add_f32 v27, v27, v35
  v_cvt_pk_bf16_f32 v123, v34, v35
  v_mfma_f32_16x16x32_bf16 v[88:91], a[172:175], a[204:207], v[88:91]
  ds_read_b128 a[164:167], v11 offset:53248
  v_exp_f32 v33, v49
  v_mfma_f32_16x16x32_bf16 v[96:99], a[172:175], a[220:223], v[96:99]
  v_exp_f32 v34, v50
  v_mfma_f32_16x16x32_bf16 v[104:107], a[172:175], a[236:239], v[104:107]
  v_add_f32 v28, v32, v33
  v_mfma_f32_16x16x32_bf16 v[112:115], a[172:175], a[252:255], v[112:115]
  v_cvt_pk_bf16_f32 v124, v32, v33
  v_exp_f32 v35, v51
  s_waitcnt lgkmcnt(1)
  v_mfma_f32_16x16x32_bf16 v[84:87], a[160:163], a[176:179], v[160:163]
  v_add_f32 v28, v28, v34
  v_mfma_f32_16x16x32_bf16 v[92:95], a[160:163], a[192:195], v[164:167]
  ds_read_b128 a[168:171], v12 offset:53248
  v_exp_f32 v32, v52
  v_mfma_f32_16x16x32_bf16 v[100:103], a[160:163], a[208:211], v[168:171]
  v_add_f32 v28, v28, v35
  v_mfma_f32_16x16x32_bf16 v[108:111], a[160:163], a[224:227], v[172:175]
  s_waitcnt vmcnt(5)
  buffer_load_dwordx4 v7, s[28:31], s46 offen offset:3072 nt lds
  v_cvt_pk_bf16_f32 v125, v34, v35
  v_exp_f32 v33, v53
  v_mfma_f32_16x16x32_bf16 v[116:119], a[160:163], a[240:243], v[176:179]
  v_add_f32 v28, v28, v32
  s_waitcnt lgkmcnt(1)
  v_mfma_f32_16x16x32_bf16 v[84:87], a[164:167], a[180:183], v[84:87]
  v_exp_f32 v34, v54
  v_mfma_f32_16x16x32_bf16 v[92:95], a[164:167], a[196:199], v[92:95]
  ds_read_b128 a[172:175], v13 offset:53248
  v_add_f32 v28, v28, v33
  v_mfma_f32_16x16x32_bf16 v[100:103], a[164:167], a[212:215], v[100:103]
  v_cvt_pk_bf16_f32 v126, v32, v33
  v_exp_f32 v35, v55
  v_mfma_f32_16x16x32_bf16 v[108:111], a[164:167], a[228:231], v[108:111]
  v_add_f32 v28, v28, v34
  v_mfma_f32_16x16x32_bf16 v[116:119], a[164:167], a[244:247], v[116:119]
  v_exp_f32 v32, v56
  s_waitcnt lgkmcnt(1)
  v_mfma_f32_16x16x32_bf16 v[84:87], a[168:171], a[184:187], v[84:87]
  v_add_f32 v28, v28, v35
  v_cvt_pk_bf16_f32 v127, v34, v35
  v_mfma_f32_16x16x32_bf16 v[92:95], a[168:171], a[200:203], v[92:95]
  ds_read_b64_tr_b16 a[160:161], v18 offset:16384
  v_exp_f32 v33, v57
  v_mfma_f32_16x16x32_bf16 v[100:103], a[168:171], a[216:219], v[100:103]
  s_add_u32 m0, s47, 114688
  s_add_u32 s46, s47, 49152
  s_waitcnt vmcnt(5)
  buffer_load_dwordx4 v8, s[32:35], s46 offen nt lds
  v_exp_f32 v34, v58
  v_mfma_f32_16x16x32_bf16 v[108:111], a[168:171], a[232:235], v[108:111]
  ds_read_b64_tr_b16 a[162:163], v18 offset:20480
  v_add_f32 v29, v32, v33
  v_mfma_f32_16x16x32_bf16 v[116:119], a[168:171], a[248:251], v[116:119]
  v_cvt_pk_bf16_f32 v128, v32, v33
  v_exp_f32 v35, v59
  s_waitcnt lgkmcnt(2)
  v_mfma_f32_16x16x32_bf16 v[84:87], a[172:175], a[188:191], v[84:87]
  v_mfma_f32_16x16x32_bf16 v[92:95], a[172:175], a[204:207], v[92:95]
  ds_read_b64_tr_b16 a[164:165], v19 offset:16384
  v_add_f32 v29, v29, v34
  v_exp_f32 v32, v60
  v_mfma_f32_16x16x32_bf16 v[100:103], a[172:175], a[220:223], v[100:103]
  v_add_f32 v29, v29, v35
  v_mfma_f32_16x16x32_bf16 v[108:111], a[172:175], a[236:239], v[108:111]
  ds_read_b64_tr_b16 a[166:167], v19 offset:20480
  v_cvt_pk_bf16_f32 v129, v34, v35
  v_exp_f32 v33, v61
  v_mfma_f32_16x16x32_bf16 v[116:119], a[172:175], a[252:255], v[116:119]
  v_add_f32 v29, v29, v32
  s_waitcnt lgkmcnt(2)
  v_mfma_f32_16x16x32_bf16 a[80:83], a[160:163], v[140:143], a[80:83]
  v_exp_f32 v34, v62
  v_mfma_f32_16x16x32_bf16 a[84:87], a[160:163], v[144:147], a[84:87]
  ds_read_b64_tr_b16 a[168:169], v20 offset:16384
  v_add_f32 v29, v29, v33
  v_mfma_f32_16x16x32_bf16 a[88:91], a[160:163], v[148:151], a[88:91]
  s_waitcnt vmcnt(5)
  buffer_load_dwordx4 v9, s[32:35], s46 offen offset:1024 nt lds
  v_cvt_pk_bf16_f32 v130, v32, v33
  v_exp_f32 v35, v63
  v_mfma_f32_16x16x32_bf16 a[92:95], a[160:163], v[152:155], a[92:95]
  ds_read_b64_tr_b16 a[170:171], v20 offset:20480
  v_add_f32 v29, v29, v34
  v_mfma_f32_16x16x32_bf16 a[96:99], a[160:163], v[156:159], a[96:99]
  v_exp_f32 v32, v64
  s_waitcnt lgkmcnt(2)
  v_mfma_f32_16x16x32_bf16 a[100:103], a[164:167], v[140:143], a[100:103]
  v_add_f32 v29, v29, v35
  v_mfma_f32_16x16x32_bf16 a[104:107], a[164:167], v[144:147], a[104:107]
  ds_read_b64_tr_b16 a[172:173], v21 offset:16384
  v_cvt_pk_bf16_f32 v131, v34, v35
  v_exp_f32 v33, v65
  v_mfma_f32_16x16x32_bf16 a[108:111], a[164:167], v[148:151], a[108:111]
  v_exp_f32 v34, v66
  v_mfma_f32_16x16x32_bf16 a[112:115], a[164:167], v[152:155], a[112:115]
  ds_read_b64_tr_b16 a[174:175], v21 offset:20480
  v_add_f32 v30, v32, v33
  v_mfma_f32_16x16x32_bf16 a[116:119], a[164:167], v[156:159], a[116:119]
  v_cvt_pk_bf16_f32 v132, v32, v33
  s_waitcnt lgkmcnt(2)
  v_mfma_f32_16x16x32_bf16 a[120:123], a[168:171], v[140:143], a[120:123]
  v_exp_f32 v35, v67
  v_mfma_f32_16x16x32_bf16 a[124:127], a[168:171], v[144:147], a[124:127]
  ds_read_b64_tr_b16 a[160:161], v14 offset:16384
  v_add_f32 v30, v30, v34
  v_exp_f32 v32, v68
  v_mfma_f32_16x16x32_bf16 a[128:131], a[168:171], v[148:151], a[128:131]
  s_waitcnt vmcnt(5)
  buffer_load_dwordx4 v8, s[32:35], s46 offen offset:2048 nt lds
  v_add_f32 v30, v30, v35
  v_mfma_f32_16x16x32_bf16 a[132:135], a[168:171], v[152:155], a[132:135]
  ds_read_b64_tr_b16 a[162:163], v14 offset:20480
  v_cvt_pk_bf16_f32 v133, v34, v35
  v_mfma_f32_16x16x32_bf16 a[136:139], a[168:171], v[156:159], a[136:139]
  v_exp_f32 v33, v69
  s_waitcnt lgkmcnt(2)
  v_mfma_f32_16x16x32_bf16 a[140:143], a[172:175], v[140:143], a[140:143]
  v_add_f32 v30, v30, v32
  v_exp_f32 v34, v70
  v_mfma_f32_16x16x32_bf16 a[144:147], a[172:175], v[144:147], a[144:147]
  ds_read_b64_tr_b16 a[164:165], v15 offset:16384
  v_add_f32 v30, v30, v33
  v_mfma_f32_16x16x32_bf16 a[148:151], a[172:175], v[148:151], a[148:151]
  v_cvt_pk_bf16_f32 v134, v32, v33
  v_exp_f32 v35, v71
  v_mfma_f32_16x16x32_bf16 a[152:155], a[172:175], v[152:155], a[152:155]
  ds_read_b64_tr_b16 a[166:167], v15 offset:20480
  v_mfma_f32_16x16x32_bf16 a[156:159], a[172:175], v[156:159], a[156:159]
  v_add_f32 v30, v30, v34
  v_exp_f32 v32, v72
  s_waitcnt lgkmcnt(2)
  v_mfma_f32_16x16x32_bf16 a[0:3], a[160:163], v[140:143], a[0:3]
  v_add_f32 v30, v30, v35
  v_mfma_f32_16x16x32_bf16 a[4:7], a[160:163], v[144:147], a[4:7]
  s_waitcnt vmcnt(5)
  buffer_load_dwordx4 v9, s[32:35], s46 offen offset:3072 nt lds
  ds_read_b64_tr_b16 a[168:169], v16 offset:16384
  v_cvt_pk_bf16_f32 v135, v34, v35
  v_exp_f32 v33, v73
  v_mfma_f32_16x16x32_bf16 a[8:11], a[160:163], v[148:151], a[8:11]
  v_mfma_f32_16x16x32_bf16 a[12:15], a[160:163], v[152:155], a[12:15]
  ds_read_b64_tr_b16 a[170:171], v16 offset:20480
  v_exp_f32 v34, v74
  v_mfma_f32_16x16x32_bf16 a[16:19], a[160:163], v[156:159], a[16:19]
  v_add_f32 v31, v32, v33
  v_cvt_pk_bf16_f32 v136, v32, v33
  s_waitcnt lgkmcnt(2)
  v_mfma_f32_16x16x32_bf16 a[20:23], a[164:167], v[140:143], a[20:23]
  v_exp_f32 v35, v75
  v_mfma_f32_16x16x32_bf16 a[24:27], a[164:167], v[144:147], a[24:27]
  ds_read_b64_tr_b16 a[172:173], v17 offset:16384
  v_add_f32 v31, v31, v34
  v_exp_f32 v32, v76
  v_mfma_f32_16x16x32_bf16 a[28:31], a[164:167], v[148:151], a[28:31]
  v_mfma_f32_16x16x32_bf16 a[32:35], a[164:167], v[152:155], a[32:35]
  ds_read_b64_tr_b16 a[174:175], v17 offset:20480
  v_add_f32 v31, v31, v35
  v_cvt_pk_bf16_f32 v137, v34, v35
  v_mfma_f32_16x16x32_bf16 a[36:39], a[164:167], v[156:159], a[36:39]
  v_exp_f32 v33, v77
  s_waitcnt lgkmcnt(2)
  v_mfma_f32_16x16x32_bf16 a[40:43], a[168:171], v[140:143], a[40:43]
  v_add_f32 v31, v31, v32
  v_exp_f32 v34, v78
  v_mfma_f32_16x16x32_bf16 a[44:47], a[168:171], v[144:147], a[44:47]
  s_waitcnt lgkmcnt(0)
  s_barrier
  ds_read_b128 a[160:163], v10
  v_mfma_f32_16x16x32_bf16 a[48:51], a[168:171], v[148:151], a[48:51]
  v_add_f32 v31, v31, v33
  v_cvt_pk_bf16_f32 v138, v32, v33
  v_mfma_f32_16x16x32_bf16 a[52:55], a[168:171], v[152:155], a[52:55]
  v_exp_f32 v35, v79
  v_mfma_f32_16x16x32_bf16 a[56:59], a[168:171], v[156:159], a[56:59]
  s_add_u32 m0, s47, 32768
  s_add_u32 s46, s47, 98304
  s_waitcnt vmcnt(5)
  buffer_load_dwordx4 v4, s[28:31], s46 offen nt lds
  v_add_f32 v31, v31, v34
  v_add_f32 v31, v31, v35
  v_mfma_f32_16x16x32_bf16 a[60:63], a[172:175], v[140:143], a[60:63]
  v_cvt_pk_bf16_f32 v139, v34, v35
  v_mfma_f32_16x16x32_bf16 a[64:67], a[172:175], v[144:147], a[64:67]
  ds_read_b128 a[164:167], v11
  v_max3_f32 v36, v27, v28, v29
  v_mfma_f32_16x16x32_bf16 a[68:71], a[172:175], v[148:151], a[68:71]
  v_max3_f32 v36, v36, v30, v31
  v_mfma_f32_16x16x32_bf16 a[72:75], a[172:175], v[152:155], a[72:75]
  v_cmp_nge_f32 vcc, s49, v36
  v_mfma_f32_16x16x32_bf16 a[76:79], a[172:175], v[156:159], a[76:79]
  s_cbranch_vccnz Lstub2
Lret2:
  v_add_f32 v22, v22, v27
  v_add_f32 v23, v23, v28
  v_add_f32 v24, v24, v29
  v_add_f32 v25, v25, v30
  v_add_f32 v26, v26, v31
  s_waitcnt lgkmcnt(1)
  v_mfma_f32_16x16x32_bf16 v[40:43], a[160:163], a[176:179], v[160:163]
  v_exp_f32 v32, v80
  v_mfma_f32_16x16x32_bf16 v[48:51], a[160:163], a[192:195], v[164:167]
  ds_read_b128 a[168:171], v12
  v_exp_f32 v33, v81
  v_mfma_f32_16x16x32_bf16 v[56:59], a[160:163], a[208:211], v[168:171]
  v_exp_f32 v34, v82
  v_mfma_f32_16x16x32_bf16 v[64:67], a[160:163], a[224:227], v[172:175]
  s_waitcnt vmcnt(5)
  buffer_load_dwordx4 v5, s[28:31], s46 offen offset:1024 nt lds
  v_add_f32 v27, v32, v33
  v_cvt_pk_bf16_f32 v140, v32, v33
  v_mfma_f32_16x16x32_bf16 v[72:75], a[160:163], a[240:243], v[176:179]
  v_exp_f32 v35, v83
  s_waitcnt lgkmcnt(1)
  v_mfma_f32_16x16x32_bf16 v[40:43], a[164:167], a[180:183], v[40:43]
  v_add_f32 v27, v27, v34
  v_mfma_f32_16x16x32_bf16 v[48:51], a[164:167], a[196:199], v[48:51]
  ds_read_b128 a[172:175], v13
  v_exp_f32 v32, v84
  v_mfma_f32_16x16x32_bf16 v[56:59], a[164:167], a[212:215], v[56:59]
  v_add_f32 v27, v27, v35
  v_cvt_pk_bf16_f32 v141, v34, v35
  v_mfma_f32_16x16x32_bf16 v[64:67], a[164:167], a[228:231], v[64:67]
  v_exp_f32 v33, v85
  v_mfma_f32_16x16x32_bf16 v[72:75], a[164:167], a[244:247], v[72:75]
  v_add_f32 v27, v27, v32
  s_waitcnt lgkmcnt(1)
  v_mfma_f32_16x16x32_bf16 v[40:43], a[168:171], a[184:187], v[40:43]
  v_exp_f32 v34, v86
  v_mfma_f32_16x16x32_bf16 v[48:51], a[168:171], a[200:203], v[48:51]
  ds_read_b128 a[160:163], v10 offset:4096
  v_add_f32 v27, v27, v33
  v_cvt_pk_bf16_f32 v142, v32, v33
  v_mfma_f32_16x16x32_bf16 v[56:59], a[168:171], a[216:219], v[56:59]
  v_exp_f32 v35, v87
  v_mfma_f32_16x16x32_bf16 v[64:67], a[168:171], a[232:235], v[64:67]
  s_waitcnt vmcnt(5)
  buffer_load_dwordx4 v6, s[28:31], s46 offen offset:2048 nt lds
  v_add_f32 v27, v27, v34
  v_mfma_f32_16x16x32_bf16 v[72:75], a[168:171], a[248:251], v[72:75]
  v_exp_f32 v32, v88
  s_waitcnt lgkmcnt(1)
  v_mfma_f32_16x16x32_bf16 v[40:43], a[172:175], a[188:191], v[40:43]
  v_add_f32 v27, v27, v35
  v_cvt_pk_bf16_f32 v143, v34, v35
  v_mfma_f32_16x16x32_bf16 v[48:51], a[172:175], a[204:207], v[48:51]
  ds_read_b128 a[164:167], v11 offset:4096
  v_exp_f32 v33, v89
  v_mfma_f32_16x16x32_bf16 v[56:59], a[172:175], a[220:223], v[56:59]
  v_exp_f32 v34, v90
  v_mfma_f32_16x16x32_bf16 v[64:67], a[172:175], a[236:239], v[64:67]
  v_add_f32 v28, v32, v33
  v_mfma_f32_16x16x32_bf16 v[72:75], a[172:175], a[252:255], v[72:75]
  v_cvt_pk_bf16_f32 v144, v32, v33
  v_exp_f32 v35, v91
  s_waitcnt lgkmcnt(1)
  v_mfma_f32_16x16x32_bf16 v[44:47], a[160:163], a[176:179], v[160:163]
  v_add_f32 v28, v28, v34
  v_mfma_f32_16x16x32_bf16 v[52:55], a[160:163], a[192:195], v[164:167]
  ds_read_b128 a[168:171], v12 offset:4096
  v_exp_f32 v32, v92
  v_mfma_f32_16x16x32_bf16 v[60:63], a[160:163], a[208:211], v[168:171]
  v_add_f32 v28, v28, v35
  v_mfma_f32_16x16x32_bf16 v[68:71], a[160:163], a[224:227], v[172:175]
  s_waitcnt vmcnt(5)
  buffer_load_dwordx4 v7, s[28:31], s46 offen offset:3072 nt lds
  v_cvt_pk_bf16_f32 v145, v34, v35
  v_exp_f32 v33, v93
  v_mfma_f32_16x16x32_bf16 v[76:79], a[160:163], a[240:243], v[176:179]
  v_add_f32 v28, v28, v32
  s_waitcnt lgkmcnt(1)
  v_mfma_f32_16x16x32_bf16 v[44:47], a[164:167], a[180:183], v[44:47]
  v_exp_f32 v34, v94
  v_mfma_f32_16x16x32_bf16 v[52:55], a[164:167], a[196:199], v[52:55]
  ds_read_b128 a[172:175], v13 offset:4096
  v_add_f32 v28, v28, v33
  v_mfma_f32_16x16x32_bf16 v[60:63], a[164:167], a[212:215], v[60:63]
  v_cvt_pk_bf16_f32 v146, v32, v33
  v_exp_f32 v35, v95
  v_mfma_f32_16x16x32_bf16 v[68:71], a[164:167], a[228:231], v[68:71]
  v_add_f32 v28, v28, v34
  v_mfma_f32_16x16x32_bf16 v[76:79], a[164:167], a[244:247], v[76:79]
  v_exp_f32 v32, v96
  s_waitcnt lgkmcnt(1)
  v_mfma_f32_16x16x32_bf16 v[44:47], a[168:171], a[184:187], v[44:47]
  v_add_f32 v28, v28, v35
  v_cvt_pk_bf16_f32 v147, v34, v35
  v_mfma_f32_16x16x32_bf16 v[52:55], a[168:171], a[200:203], v[52:55]
  ds_read_b64_tr_b16 a[160:161], v18 offset:32768
  v_exp_f32 v33, v97
  v_mfma_f32_16x16x32_bf16 v[60:63], a[168:171], a[216:219], v[60:63]
  s_add_u32 m0, s47, 65536
  s_add_u32 s46, s47, 65536
  s_waitcnt vmcnt(5)
  buffer_load_dwordx4 v8, s[32:35], s46 offen nt lds
  v_exp_f32 v34, v98
  v_mfma_f32_16x16x32_bf16 v[68:71], a[168:171], a[232:235], v[68:71]
  ds_read_b64_tr_b16 a[162:163], v18 offset:36864
  v_add_f32 v29, v32, v33
  v_mfma_f32_16x16x32_bf16 v[76:79], a[168:171], a[248:251], v[76:79]
  v_cvt_pk_bf16_f32 v148, v32, v33
  v_exp_f32 v35, v99
  s_waitcnt lgkmcnt(2)
  v_mfma_f32_16x16x32_bf16 v[44:47], a[172:175], a[188:191], v[44:47]
  v_mfma_f32_16x16x32_bf16 v[52:55], a[172:175], a[204:207], v[52:55]
  ds_read_b64_tr_b16 a[164:165], v19 offset:32768
  v_add_f32 v29, v29, v34
  v_exp_f32 v32, v100
  v_mfma_f32_16x16x32_bf16 v[60:63], a[172:175], a[220:223], v[60:63]
  v_add_f32 v29, v29, v35
  v_mfma_f32_16x16x32_bf16 v[68:71], a[172:175], a[236:239], v[68:71]
  ds_read_b64_tr_b16 a[166:167], v19 offset:36864
  v_cvt_pk_bf16_f32 v149, v34, v35
  v_exp_f32 v33, v101
  v_mfma_f32_16x16x32_bf16 v[76:79], a[172:175], a[252:255], v[76:79]
  v_add_f32 v29, v29, v32
  s_waitcnt lgkmcnt(2)
  v_mfma_f32_16x16x32_bf16 a[80:83], a[160:163], v[120:123], a[80:83]
  v_exp_f32 v34, v102
  v_mfma_f32_16x16x32_bf16 a[84:87], a[160:163], v[124:127], a[84:87]
  ds_read_b64_tr_b16 a[168:169], v20 offset:32768
  v_add_f32 v29, v29, v33
  v_mfma_f32_16x16x32_bf16 a[88:91], a[160:163], v[128:131], a[88:91]
  s_waitcnt vmcnt(5)
  buffer_load_dwordx4 v9, s[32:35], s46 offen offset:1024 nt lds
  v_cvt_pk_bf16_f32 v150, v32, v33
  v_exp_f32 v35, v103
  v_mfma_f32_16x16x32_bf16 a[92:95], a[160:163], v[132:135], a[92:95]
  ds_read_b64_tr_b16 a[170:171], v20 offset:36864
  v_add_f32 v29, v29, v34
  v_mfma_f32_16x16x32_bf16 a[96:99], a[160:163], v[136:139], a[96:99]
  v_exp_f32 v32, v104
  s_waitcnt lgkmcnt(2)
  v_mfma_f32_16x16x32_bf16 a[100:103], a[164:167], v[120:123], a[100:103]
  v_add_f32 v29, v29, v35
  v_mfma_f32_16x16x32_bf16 a[104:107], a[164:167], v[124:127], a[104:107]
  ds_read_b64_tr_b16 a[172:173], v21 offset:32768
  v_cvt_pk_bf16_f32 v151, v34, v35
  v_exp_f32 v33, v105
  v_mfma_f32_16x16x32_bf16 a[108:111], a[164:167], v[128:131], a[108:111]
  v_exp_f32 v34, v106
  v_mfma_f32_16x16x32_bf16 a[112:115], a[164:167], v[132:135], a[112:115]
  ds_read_b64_tr_b16 a[174:175], v21 offset:36864
  v_add_f32 v30, v32, v33
  v_mfma_f32_16x16x32_bf16 a[116:119], a[164:167], v[136:139], a[116:119]
  v_cvt_pk_bf16_f32 v152, v32, v33
  s_waitcnt lgkmcnt(2)
  v_mfma_f32_16x16x32_bf16 a[120:123], a[168:171], v[120:123], a[120:123]
  v_exp_f32 v35, v107
  v_mfma_f32_16x16x32_bf16 a[124:127], a[168:171], v[124:127], a[124:127]
  ds_read_b64_tr_b16 a[160:161], v14 offset:32768
  v_add_f32 v30, v30, v34
  v_exp_f32 v32, v108
  v_mfma_f32_16x16x32_bf16 a[128:131], a[168:171], v[128:131], a[128:131]
  s_waitcnt vmcnt(5)
  buffer_load_dwordx4 v8, s[32:35], s46 offen offset:2048 nt lds
  v_add_f32 v30, v30, v35
  v_mfma_f32_16x16x32_bf16 a[132:135], a[168:171], v[132:135], a[132:135]
  ds_read_b64_tr_b16 a[162:163], v14 offset:36864
  v_cvt_pk_bf16_f32 v153, v34, v35
  v_mfma_f32_16x16x32_bf16 a[136:139], a[168:171], v[136:139], a[136:139]
  v_exp_f32 v33, v109
  s_waitcnt lgkmcnt(2)
  v_mfma_f32_16x16x32_bf16 a[140:143], a[172:175], v[120:123], a[140:143]
  v_add_f32 v30, v30, v32
  v_exp_f32 v34, v110
  v_mfma_f32_16x16x32_bf16 a[144:147], a[172:175], v[124:127], a[144:147]
  ds_read_b64_tr_b16 a[164:165], v15 offset:32768
  v_add_f32 v30, v30, v33
  v_mfma_f32_16x16x32_bf16 a[148:151], a[172:175], v[128:131], a[148:151]
  v_cvt_pk_bf16_f32 v154, v32, v33
  v_exp_f32 v35, v111
  v_mfma_f32_16x16x32_bf16 a[152:155], a[172:175], v[132:135], a[152:155]
  ds_read_b64_tr_b16 a[166:167], v15 offset:36864
  v_mfma_f32_16x16x32_bf16 a[156:159], a[172:175], v[136:139], a[156:159]
  v_add_f32 v30, v30, v34
  v_exp_f32 v32, v112
  s_waitcnt lgkmcnt(2)
  v_mfma_f32_16x16x32_bf16 a[0:3], a[160:163], v[120:123], a[0:3]
  v_add_f32 v30, v30, v35
  v_mfma_f32_16x16x32_bf16 a[4:7], a[160:163], v[124:127], a[4:7]
  s_waitcnt vmcnt(5)
  buffer_load_dwordx4 v9, s[32:35], s46 offen offset:3072 nt lds
  ds_read_b64_tr_b16 a[168:169], v16 offset:32768
  v_cvt_pk_bf16_f32 v155, v34, v35
  v_exp_f32 v33, v113
  v_mfma_f32_16x16x32_bf16 a[8:11], a[160:163], v[128:131], a[8:11]
  v_mfma_f32_16x16x32_bf16 a[12:15], a[160:163], v[132:135], a[12:15]
  ds_read_b64_tr_b16 a[170:171], v16 offset:36864
  v_exp_f32 v34, v114
  v_mfma_f32_16x16x32_bf16 a[16:19], a[160:163], v[136:139], a[16:19]
  v_add_f32 v31, v32, v33
  v_cvt_pk_bf16_f32 v156, v32, v33
  s_waitcnt lgkmcnt(2)
  v_mfma_f32_16x16x32_bf16 a[20:23], a[164:167], v[120:123], a[20:23]
  v_exp_f32 v35, v115
  v_mfma_f32_16x16x32_bf16 a[24:27], a[164:167], v[124:127], a[24:27]
  ds_read_b64_tr_b16 a[172:173], v17 offset:32768
  v_add_f32 v31, v31, v34
  v_exp_f32 v32, v116
  v_mfma_f32_16x16x32_bf16 a[28:31], a[164:167], v[128:131], a[28:31]
  v_mfma_f32_16x16x32_bf16 a[32:35], a[164:167], v[132:135], a[32:35]
  ds_read_b64_tr_b16 a[174:175], v17 offset:36864
  v_add_f32 v31, v31, v35
  v_cvt_pk_bf16_f32 v157, v34, v35
  v_mfma_f32_16x16x32_bf16 a[36:39], a[164:167], v[136:139], a[36:39]
  v_exp_f32 v33, v117
  s_waitcnt lgkmcnt(2)
  v_mfma_f32_16x16x32_bf16 a[40:43], a[168:171], v[120:123], a[40:43]
  v_add_f32 v31, v31, v32
  v_exp_f32 v34, v118
  v_mfma_f32_16x16x32_bf16 a[44:47], a[168:171], v[124:127], a[44:47]
  s_waitcnt lgkmcnt(0)
  s_barrier
  ds_read_b128 a[160:163], v10 offset:16384
  v_mfma_f32_16x16x32_bf16 a[48:51], a[168:171], v[128:131], a[48:51]
  v_add_f32 v31, v31, v33
  v_cvt_pk_bf16_f32 v158, v32, v33
  v_mfma_f32_16x16x32_bf16 a[52:55], a[168:171], v[132:135], a[52:55]
  v_exp_f32 v35, v119
  v_mfma_f32_16x16x32_bf16 a[56:59], a[168:171], v[136:139], a[56:59]
  s_add_u32 m0, s47, 49152
  s_add_u32 s46, s47, 114688
  s_waitcnt vmcnt(5)
  buffer_load_dwordx4 v4, s[28:31], s46 offen nt lds
  v_add_f32 v31, v31, v34
  v_add_f32 v31, v31, v35
  v_mfma_f32_16x16x32_bf16 a[60:63], a[172:175], v[120:123], a[60:63]
  v_cvt_pk_bf16_f32 v159, v34, v35
  v_mfma_f32_16x16x32_bf16 a[64:67], a[172:175], v[124:127], a[64:67]
  ds_read_b128 a[164:167], v11 offset:16384
  v_max3_f32 v36, v27, v28, v29
  v_mfma_f32_16x16x32_bf16 a[68:71], a[172:175], v[128:131], a[68:71]
  v_max3_f32 v36, v36, v30, v31
  v_mfma_f32_16x16x32_bf16 a[72:75], a[172:175], v[132:135], a[72:75]
  v_cmp_nge_f32 vcc, s49, v36
  v_mfma_f32_16x16x32_bf16 a[76:79], a[172:175], v[136:139], a[76:79]
  s_cbranch_vccnz Lstub3
Lret3:
  v_add_f32 v22, v22, v27
  v_add_f32 v23, v23, v28
  v_add_f32 v24, v24, v29
  v_add_f32 v25, v25, v30
  v_add_f32 v26, v26, v31
  s_waitcnt lgkmcnt(1)
  v_mfma_f32_16x16x32_bf16 v[80:83], a[160:163], a[176:179], v[160:163]
  v_exp_f32 v32, v40
  v_mfma_f32_16x16x32_bf16 v[88:91], a[160:163], a[192:195], v[164:167]
  ds_read_b128 a[168:171], v12 offset:16384
  v_exp_f32 v33, v41
  v_mfma_f32_16x16x32_bf16 v[96:99], a[160:163], a[208:211], v[168:171]
  v_exp_f32 v34, v42
  v_mfma_f32_16x16x32_bf16 v[104:107], a[160:163], a[224:227], v[172:175]
  s_waitcnt vmcnt(5)
  buffer_load_dwordx4 v5, s[28:31], s46 offen offset:1024 nt lds
  v_add_f32 v27, v32, v33
  v_cvt_pk_bf16_f32 v120, v32, v33
  v_mfma_f32_16x16x32_bf16 v[112:115], a[160:163], a[240:243], v[176:179]
  v_exp_f32 v35, v43
  s_waitcnt lgkmcnt(1)
  v_mfma_f32_16x16x32_bf16 v[80:83], a[164:167], a[180:183], v[80:83]
  v_add_f32 v27, v27, v34
  v_mfma_f32_16x16x32_bf16 v[88:91], a[164:167], a[196:199], v[88:91]
  ds_read_b128 a[172:175], v13 offset:16384
  v_exp_f32 v32, v44
  v_mfma_f32_16x16x32_bf16 v[96:99], a[164:167], a[212:215], v[96:99]
  v_add_f32 v27, v27, v35
  v_cvt_pk_bf16_f32 v121, v34, v35
  v_mfma_f32_16x16x32_bf16 v[104:107], a[164:167], a[228:231], v[104:107]
  v_exp_f32 v33, v45
  v_mfma_f32_16x16x32_bf16 v[112:115], a[164:167], a[244:247], v[112:115]
  v_add_f32 v27, v27, v32
  s_waitcnt lgkmcnt(1)
  v_mfma_f32_16x16x32_bf16 v[80:83], a[168:171], a[184:187], v[80:83]
  v_exp_f32 v34, v46
  v_mfma_f32_16x16x32_bf16 v[88:91], a[168:171], a[200:203], v[88:91]
  ds_read_b128 a[160:163], v10 offset:20480
  v_add_f32 v27, v27, v33
  v_cvt_pk_bf16_f32 v122, v32, v33
  v_mfma_f32_16x16x32_bf16 v[96:99], a[168:171], a[216:219], v[96:99]
  v_exp_f32 v35, v47
  v_mfma_f32_16x16x32_bf16 v[104:107], a[168:171], a[232:235], v[104:107]
  s_waitcnt vmcnt(5)
  buffer_load_dwordx4 v6, s[28:31], s46 offen offset:2048 nt lds
  v_add_f32 v27, v27, v34
  v_mfma_f32_16x16x32_bf16 v[112:115], a[168:171], a[248:251], v[112:115]
  v_exp_f32 v32, v48
  s_waitcnt lgkmcnt(1)
  v_mfma_f32_16x16x32_bf16 v[80:83], a[172:175], a[188:191], v[80:83]
  v_add_f32 v27, v27, v35
  v_cvt_pk_bf16_f32 v123, v34, v35
  v_mfma_f32_16x16x32_bf16 v[88:91], a[172:175], a[204:207], v[88:91]
  ds_read_b128 a[164:167], v11 offset:20480
  v_exp_f32 v33, v49
  v_mfma_f32_16x16x32_bf16 v[96:99], a[172:175], a[220:223], v[96:99]
  v_exp_f32 v34, v50
  v_mfma_f32_16x16x32_bf16 v[104:107], a[172:175], a[236:239], v[104:107]
  v_add_f32 v28, v32, v33
  v_mfma_f32_16x16x32_bf16 v[112:115], a[172:175], a[252:255], v[112:115]
  v_cvt_pk_bf16_f32 v124, v32, v33
  v_exp_f32 v35, v51
  s_waitcnt lgkmcnt(1)
  v_mfma_f32_16x16x32_bf16 v[84:87], a[160:163], a[176:179], v[160:163]
  v_add_f32 v28, v28, v34
  v_mfma_f32_16x16x32_bf16 v[92:95], a[160:163], a[192:195], v[164:167]
  ds_read_b128 a[168:171], v12 offset:20480
  v_exp_f32 v32, v52
  v_mfma_f32_16x16x32_bf16 v[100:103], a[160:163], a[208:211], v[168:171]
  v_add_f32 v28, v28, v35
  v_mfma_f32_16x16x32_bf16 v[108:111], a[160:163], a[224:227], v[172:175]
  s_waitcnt vmcnt(5)
  buffer_load_dwordx4 v7, s[28:31], s46 offen offset:3072 nt lds
  v_cvt_pk_bf16_f32 v125, v34, v35
  v_exp_f32 v33, v53
  v_mfma_f32_16x16x32_bf16 v[116:119], a[160:163], a[240:243], v[176:179]
  v_add_f32 v28, v28, v32
  s_waitcnt lgkmcnt(1)
  v_mfma_f32_16x16x32_bf16 v[84:87], a[164:167], a[180:183], v[84:87]
  v_exp_f32 v34, v54
  v_mfma_f32_16x16x32_bf16 v[92:95], a[164:167], a[196:199], v[92:95]
  ds_read_b128 a[172:175], v13 offset:20480
  v_add_f32 v28, v28, v33
  v_mfma_f32_16x16x32_bf16 v[100:103], a[164:167], a[212:215], v[100:103]
  v_cvt_pk_bf16_f32 v126, v32, v33
  v_exp_f32 v35, v55
  v_mfma_f32_16x16x32_bf16 v[108:111], a[164:167], a[228:231], v[108:111]
  v_add_f32 v28, v28, v34
  v_mfma_f32_16x16x32_bf16 v[116:119], a[164:167], a[244:247], v[116:119]
  v_exp_f32 v32, v56
  s_waitcnt lgkmcnt(1)
  v_mfma_f32_16x16x32_bf16 v[84:87], a[168:171], a[184:187], v[84:87]
  v_add_f32 v28, v28, v35
  v_cvt_pk_bf16_f32 v127, v34, v35
  v_mfma_f32_16x16x32_bf16 v[92:95], a[168:171], a[200:203], v[92:95]
  ds_read_b64_tr_b16 a[160:161], v18 offset:49152
  v_exp_f32 v33, v57
  v_mfma_f32_16x16x32_bf16 v[100:103], a[168:171], a[216:219], v[100:103]
  s_add_u32 m0, s47, 81920
  s_add_u32 s46, s47, 81920
  s_waitcnt vmcnt(5)
  buffer_load_dwordx4 v8, s[32:35], s46 offen nt lds
  v_exp_f32 v34, v58
  v_mfma_f32_16x16x32_bf16 v[108:111], a[168:171], a[232:235], v[108:111]
  ds_read_b64_tr_b16 a[162:163], v18 offset:53248
  v_add_f32 v29, v32, v33
  v_mfma_f32_16x16x32_bf16 v[116:119], a[168:171], a[248:251], v[116:119]
  v_cvt_pk_bf16_f32 v128, v32, v33
  v_exp_f32 v35, v59
  s_waitcnt lgkmcnt(2)
  v_mfma_f32_16x16x32_bf16 v[84:87], a[172:175], a[188:191], v[84:87]
  v_mfma_f32_16x16x32_bf16 v[92:95], a[172:175], a[204:207], v[92:95]
  ds_read_b64_tr_b16 a[164:165], v19 offset:49152
  v_add_f32 v29, v29, v34
  v_exp_f32 v32, v60
  v_mfma_f32_16x16x32_bf16 v[100:103], a[172:175], a[220:223], v[100:103]
  v_add_f32 v29, v29, v35
  v_mfma_f32_16x16x32_bf16 v[108:111], a[172:175], a[236:239], v[108:111]
  ds_read_b64_tr_b16 a[166:167], v19 offset:53248
  v_cvt_pk_bf16_f32 v129, v34, v35
  v_exp_f32 v33, v61
  v_mfma_f32_16x16x32_bf16 v[116:119], a[172:175], a[252:255], v[116:119]
  v_add_f32 v29, v29, v32
  s_waitcnt lgkmcnt(2)
  v_mfma_f32_16x16x32_bf16 a[80:83], a[160:163], v[140:143], a[80:83]
  v_exp_f32 v34, v62
  v_mfma_f32_16x16x32_bf16 a[84:87], a[160:163], v[144:147], a[84:87]
  ds_read_b64_tr_b16 a[168:169], v20 offset:49152
  v_add_f32 v29, v29, v33
  v_mfma_f32_16x16x32_bf16 a[88:91], a[160:163], v[148:151], a[88:91]
  s_waitcnt vmcnt(5)
  buffer_load_dwordx4 v9, s[32:35], s46 offen offset:1024 nt lds
  v_cvt_pk_bf16_f32 v130, v32, v33
  v_exp_f32 v35, v63
  v_mfma_f32_16x16x32_bf16 a[92:95], a[160:163], v[152:155], a[92:95]
  ds_read_b64_tr_b16 a[170:171], v20 offset:53248
  v_add_f32 v29, v29, v34
  v_mfma_f32_16x16x32_bf16 a[96:99], a[160:163], v[156:159], a[96:99]
  v_exp_f32 v32, v64
  s_waitcnt lgkmcnt(2)
  v_mfma_f32_16x16x32_bf16 a[100:103], a[164:167], v[140:143], a[100:103]
  v_add_f32 v29, v29, v35
  v_mfma_f32_16x16x32_bf16 a[104:107], a[164:167], v[144:147], a[104:107]
  ds_read_b64_tr_b16 a[172:173], v21 offset:49152
  v_cvt_pk_bf16_f32 v131, v34, v35
  v_exp_f32 v33, v65
  v_mfma_f32_16x16x32_bf16 a[108:111], a[164:167], v[148:151], a[108:111]
  v_exp_f32 v34, v66
  v_mfma_f32_16x16x32_bf16 a[112:115], a[164:167], v[152:155], a[112:115]
  ds_read_b64_tr_b16 a[174:175], v21 offset:53248
  v_add_f32 v30, v32, v33
  v_mfma_f32_16x16x32_bf16 a[116:119], a[164:167], v[156:159], a[116:119]
  v_cvt_pk_bf16_f32 v132, v32, v33
  s_waitcnt lgkmcnt(2)
  v_mfma_f32_16x16x32_bf16 a[120:123], a[168:171], v[140:143], a[120:123]
  v_exp_f32 v35, v67
  v_mfma_f32_16x16x32_bf16 a[124:127], a[168:171], v[144:147], a[124:127]
  ds_read_b64_tr_b16 a[160:161], v14 offset:49152
  v_add_f32 v30, v30, v34
  v_exp_f32 v32, v68
  v_mfma_f32_16x16x32_bf16 a[128:131], a[168:171], v[148:151], a[128:131]
  s_waitcnt vmcnt(5)
  buffer_load_dwordx4 v8, s[32:35], s46 offen offset:2048 nt lds
  v_add_f32 v30, v30, v35
  v_mfma_f32_16x16x32_bf16 a[132:135], a[168:171], v[152:155], a[132:135]
  ds_read_b64_tr_b16 a[162:163], v14 offset:53248
  v_cvt_pk_bf16_f32 v133, v34, v35
  v_mfma_f32_16x16x32_bf16 a[136:139], a[168:171], v[156:159], a[136:139]
  v_exp_f32 v33, v69
  s_waitcnt lgkmcnt(2)
  v_mfma_f32_16x16x32_bf16 a[140:143], a[172:175], v[140:143], a[140:143]
  v_add_f32 v30, v30, v32
  v_exp_f32 v34, v70
  v_mfma_f32_16x16x32_bf16 a[144:147], a[172:175], v[144:147], a[144:147]
  ds_read_b64_tr_b16 a[164:165], v15 offset:49152
  v_add_f32 v30, v30, v33
  v_mfma_f32_16x16x32_bf16 a[148:151], a[172:175], v[148:151], a[148:151]
  v_cvt_pk_bf16_f32 v134, v32, v33
  v_exp_f32 v35, v71
  v_mfma_f32_16x16x32_bf16 a[152:155], a[172:175], v[152:155], a[152:155]
  ds_read_b64_tr_b16 a[166:167], v15 offset:53248
  v_mfma_f32_16x16x32_bf16 a[156:159], a[172:175], v[156:159], a[156:159]
  v_add_f32 v30, v30, v34
  v_exp_f32 v32, v72
  s_waitcnt lgkmcnt(2)
  v_mfma_f32_16x16x32_bf16 a[0:3], a[160:163], v[140:143], a[0:3]
  v_add_f32 v30, v30, v35
  v_mfma_f32_16x16x32_bf16 a[4:7], a[160:163], v[144:147], a[4:7]
  s_waitcnt vmcnt(5)
  buffer_load_dwordx4 v9, s[32:35], s46 offen offset:3072 nt lds
  ds_read_b64_tr_b16 a[168:169], v16 offset:49152
  v_cvt_pk_bf16_f32 v135, v34, v35
  v_exp_f32 v33, v73
  v_mfma_f32_16x16x32_bf16 a[8:11], a[160:163], v[148:151], a[8:11]
  v_mfma_f32_16x16x32_bf16 a[12:15], a[160:163], v[152:155], a[12:15]
  ds_read_b64_tr_b16 a[170:171], v16 offset:53248
  v_exp_f32 v34, v74
  v_mfma_f32_16x16x32_bf16 a[16:19], a[160:163], v[156:159], a[16:19]
  v_add_f32 v31, v32, v33
  v_cvt_pk_bf16_f32 v136, v32, v33
  s_waitcnt lgkmcnt(2)
  v_mfma_f32_16x16x32_bf16 a[20:23], a[164:167], v[140:143], a[20:23]
  v_exp_f32 v35, v75
  v_mfma_f32_16x16x32_bf16 a[24:27], a[164:167], v[144:147], a[24:27]
  ds_read_b64_tr_b16 a[172:173], v17 offset:49152
  v_add_f32 v31, v31, v34
  v_exp_f32 v32, v76
  v_mfma_f32_16x16x32_bf16 a[28:31], a[164:167], v[148:151], a[28:31]
  v_mfma_f32_16x16x32_bf16 a[32:35], a[164:167], v[152:155], a[32:35]
  ds_read_b64_tr_b16 a[174:175], v17 offset:53248
  v_add_f32 v31, v31, v35
  v_cvt_pk_bf16_f32 v137, v34, v35
  v_mfma_f32_16x16x32_bf16 a[36:39], a[164:167], v[156:159], a[36:39]
  v_exp_f32 v33, v77
  s_waitcnt lgkmcnt(2)
  v_mfma_f32_16x16x32_bf16 a[40:43], a[168:171], v[140:143], a[40:43]
  v_add_f32 v31, v31, v32
  v_exp_f32 v34, v78
  v_mfma_f32_16x16x32_bf16 a[44:47], a[168:171], v[144:147], a[44:47]
  s_waitcnt lgkmcnt(0)
  s_barrier
  ds_read_b128 a[160:163], v10 offset:32768
  v_mfma_f32_16x16x32_bf16 a[48:51], a[168:171], v[148:151], a[48:51]
  v_add_f32 v31, v31, v33
  v_cvt_pk_bf16_f32 v138, v32, v33
  v_mfma_f32_16x16x32_bf16 a[52:55], a[168:171], v[152:155], a[52:55]
  v_exp_f32 v35, v79
  v_mfma_f32_16x16x32_bf16 a[56:59], a[168:171], v[156:159], a[56:59]
  s_add_u32 m0, s47, 0
  s_add_u32 s46, s47, 131072
  s_waitcnt vmcnt(5)
  buffer_load_dwordx4 v4, s[28:31], s46 offen nt lds
  v_add_f32 v31, v31, v34
  v_add_f32 v31, v31, v35
  v_mfma_f32_16x16x32_bf16 a[60:63], a[172:175], v[140:143], a[60:63]
  v_cvt_pk_bf16_f32 v139, v34, v35
  v_mfma_f32_16x16x32_bf16 a[64:67], a[172:175], v[144:147], a[64:67]
  ds_read_b128 a[164:167], v11 offset:32768
  v_max3_f32 v36, v27, v28, v29
  v_mfma_f32_16x16x32_bf16 a[68:71], a[172:175], v[148:151], a[68:71]
  v_max3_f32 v36, v36, v30, v31
  v_mfma_f32_16x16x32_bf16 a[72:75], a[172:175], v[152:155], a[72:75]
  v_cmp_nge_f32 vcc, s49, v36
  v_mfma_f32_16x16x32_bf16 a[76:79], a[172:175], v[156:159], a[76:79]
  s_cbranch_vccnz Lstub4
Lret4:
  v_add_f32 v22, v22, v27
  v_add_f32 v23, v23, v28
  v_add_f32 v24, v24, v29
  v_add_f32 v25, v25, v30
  v_add_f32 v26, v26, v31
  s_waitcnt lgkmcnt(1)
  v_mfma_f32_16x16x32_bf16 v[40:43], a[160:163], a[176:179], v[160:163]
  v_exp_f32 v32, v80
  v_mfma_f32_16x16x32_bf16 v[48:51], a[160:163], a[192:195], v[164:167]
  ds_read_b128 a[168:171], v12 offset:32768
  v_exp_f32 v33, v81
  v_mfma_f32_16x16x32_bf16 v[56:59], a[160:163], a[208:211], v[168:171]
  s_waitcnt vmcnt(5)
  buffer_load_dwordx4 v5, s[28:31], s46 offen offset:1024 nt lds
  v_exp_f32 v34, v82
  v_mfma_f32_16x16x32_bf16 v[64:67], a[160:163], a[224:227], v[172:175]
  v_add_f32 v27, v32, v33
  v_cvt_pk_bf16_f32 v140, v32, v33
  v_mfma_f32_16x16x32_bf16 v[72:75], a[160:163], a[240:243], v[176:179]
  v_exp_f32 v35, v83
  s_waitcnt lgkmcnt(1)
  v_mfma_f32_16x16x32_bf16 v[40:43], a[164:167], a[180:183], v[40:43]
  v_add_f32 v27, v27, v34
  v_mfma_f32_16x16x32_bf16 v[48:51], a[164:167], a[196:199], v[48:51]
  ds_read_b128 a[172:175], v13 offset:32768
  v_exp_f32 v32, v84
  v_mfma_f32_16x16x32_bf16 v[56:59], a[164:167], a[212:215], v[56:59]
  v_add_f32 v27, v27, v35
  v_cvt_pk_bf16_f32 v141, v34, v35
  v_mfma_f32_16x16x32_bf16 v[64:67], a[164:167], a[228:231], v[64:67]
  v_exp_f32 v33, v85
  v_mfma_f32_16x16x32_bf16 v[72:75], a[164:167], a[244:247], v[72:75]
  v_add_f32 v27, v27, v32
  s_waitcnt lgkmcnt(1)
  v_mfma_f32_16x16x32_bf16 v[40:43], a[168:171], a[184:187], v[40:43]
  v_exp_f32 v34, v86
  v_mfma_f32_16x16x32_bf16 v[48:51], a[168:171], a[200:203], v[48:51]
  s_waitcnt vmcnt(5)
  buffer_load_dwordx4 v6, s[28:31], s46 offen offset:2048 nt lds
  ds_read_b128 a[160:163], v10 offset:36864
  v_add_f32 v27, v27, v33
  v_cvt_pk_bf16_f32 v142, v32, v33
  v_mfma_f32_16x16x32_bf16 v[56:59], a[168:171], a[216:219], v[56:59]
  v_exp_f32 v35, v87
  v_mfma_f32_16x16x32_bf16 v[64:67], a[168:171], a[232:235], v[64:67]
  v_add_f32 v27, v27, v34
  v_mfma_f32_16x16x32_bf16 v[72:75], a[168:171], a[248:251], v[72:75]
  v_exp_f32 v32, v88
  s_waitcnt lgkmcnt(1)
  v_mfma_f32_16x16x32_bf16 v[40:43], a[172:175], a[188:191], v[40:43]
  v_add_f32 v27, v27, v35
  v_cvt_pk_bf16_f32 v143, v34, v35
  v_mfma_f32_16x16x32_bf16 v[48:51], a[172:175], a[204:207], v[48:51]
  ds_read_b128 a[164:167], v11 offset:36864
  v_exp_f32 v33, v89
  v_mfma_f32_16x16x32_bf16 v[56:59], a[172:175], a[220:223], v[56:59]
  v_exp_f32 v34, v90
  v_mfma_f32_16x16x32_bf16 v[64:67], a[172:175], a[236:239], v[64:67]
  v_add_f32 v28, v32, v33
  v_mfma_f32_16x16x32_bf16 v[72:75], a[172:175], a[252:255], v[72:75]
  v_cvt_pk_bf16_f32 v144, v32, v33
  v_exp_f32 v35, v91
  s_waitcnt lgkmcnt(1)
  v_mfma_f32_16x16x32_bf16 v[44:47], a[160:163], a[176:179], v[160:163]
  s_waitcnt vmcnt(5)
  buffer_load_dwordx4 v7, s[28:31], s46 offen offset:3072 nt lds
  v_add_f32 v28, v28, v34
  v_mfma_f32_16x16x32_bf16 v[52:55], a[160:163], a[192:195], v[164:167]
  ds_read_b128 a[168:171], v12 offset:36864
  v_exp_f32 v32, v92
  v_mfma_f32_16x16x32_bf16 v[60:63], a[160:163], a[208:211], v[168:171]
  v_add_f32 v28, v28, v35
  v_mfma_f32_16x16x32_bf16 v[68:71], a[160:163], a[224:227], v[172:175]
  v_cvt_pk_bf16_f32 v145, v34, v35
  v_exp_f32 v33, v93
  v_mfma_f32_16x16x32_bf16 v[76:79], a[160:163], a[240:243], v[176:179]
  v_add_f32 v28, v28, v32
  s_waitcnt lgkmcnt(1)
  v_mfma_f32_16x16x32_bf16 v[44:47], a[164:167], a[180:183], v[44:47]
  v_exp_f32 v34, v94
  v_mfma_f32_16x16x32_bf16 v[52:55], a[164:167], a[196:199], v[52:55]
  ds_read_b128 a[172:175], v13 offset:36864
  v_add_f32 v28, v28, v33
  v_mfma_f32_16x16x32_bf16 v[60:63], a[164:167], a[212:215], v[60:63]
  v_cvt_pk_bf16_f32 v146, v32, v33
  v_exp_f32 v35, v95
  v_mfma_f32_16x16x32_bf16 v[68:71], a[164:167], a[228:231], v[68:71]
  v_add_f32 v28, v28, v34
  v_mfma_f32_16x16x32_bf16 v[76:79], a[164:167], a[244:247], v[76:79]
  s_add_u32 m0, s47, 98304
  s_add_u32 s46, s47, 98304
  s_waitcnt vmcnt(5)
  buffer_load_dwordx4 v8, s[32:35], s46 offen nt lds
  v_exp_f32 v32, v96
  s_waitcnt lgkmcnt(1)
  v_mfma_f32_16x16x32_bf16 v[44:47], a[168:171], a[184:187], v[44:47]
  v_add_f32 v28, v28, v35
  v_cvt_pk_bf16_f32 v147, v34, v35
  v_mfma_f32_16x16x32_bf16 v[52:55], a[168:171], a[200:203], v[52:55]
  ds_read_b64_tr_b16 a[160:161], v18
  v_exp_f32 v33, v97
  v_mfma_f32_16x16x32_bf16 v[60:63], a[168:171], a[216:219], v[60:63]
  v_exp_f32 v34, v98
  v_mfma_f32_16x16x32_bf16 v[68:71], a[168:171], a[232:235], v[68:71]
  ds_read_b64_tr_b16 a[162:163], v18 offset:4096
  v_add_f32 v29, v32, v33
  v_mfma_f32_16x16x32_bf16 v[76:79], a[168:171], a[248:251], v[76:79]
  v_cvt_pk_bf16_f32 v148, v32, v33
  v_exp_f32 v35, v99
  s_waitcnt lgkmcnt(2)
  v_mfma_f32_16x16x32_bf16 v[44:47], a[172:175], a[188:191], v[44:47]
  v_mfma_f32_16x16x32_bf16 v[52:55], a[172:175], a[204:207], v[52:55]
  ds_read_b64_tr_b16 a[164:165], v19
  v_add_f32 v29, v29, v34
  v_exp_f32 v32, v100
  v_mfma_f32_16x16x32_bf16 v[60:63], a[172:175], a[220:223], v[60:63]
  v_add_f32 v29, v29, v35
  v_mfma_f32_16x16x32_bf16 v[68:71], a[172:175], a[236:239], v[68:71]
  s_waitcnt vmcnt(5)
  buffer_load_dwordx4 v9, s[32:35], s46 offen offset:1024 nt lds
  ds_read_b64_tr_b16 a[166:167], v19 offset:4096
  v_cvt_pk_bf16_f32 v149, v34, v35
  v_exp_f32 v33, v101
  v_mfma_f32_16x16x32_bf16 v[76:79], a[172:175], a[252:255], v[76:79]
  v_add_f32 v29, v29, v32
  s_waitcnt lgkmcnt(2)
  v_mfma_f32_16x16x32_bf16 a[80:83], a[160:163], v[120:123], a[80:83]
  v_exp_f32 v34, v102
  v_mfma_f32_16x16x32_bf16 a[84:87], a[160:163], v[124:127], a[84:87]
  ds_read_b64_tr_b16 a[168:169], v20
  v_add_f32 v29, v29, v33
  v_mfma_f32_16x16x32_bf16 a[88:91], a[160:163], v[128:131], a[88:91]
  v_cvt_pk_bf16_f32 v150, v32, v33
  v_exp_f32 v35, v103
  v_mfma_f32_16x16x32_bf16 a[92:95], a[160:163], v[132:135], a[92:95]
  ds_read_b64_tr_b16 a[170:171], v20 offset:4096
  v_add_f32 v29, v29, v34
  v_mfma_f32_16x16x32_bf16 a[96:99], a[160:163], v[136:139], a[96:99]
  v_exp_f32 v32, v104
  s_waitcnt lgkmcnt(2)
  v_mfma_f32_16x16x32_bf16 a[100:103], a[164:167], v[120:123], a[100:103]
  v_add_f32 v29, v29, v35
  v_mfma_f32_16x16x32_bf16 a[104:107], a[164:167], v[124:127], a[104:107]
  ds_read_b64_tr_b16 a[172:173], v21
  v_cvt_pk_bf16_f32 v151, v34, v35
  v_exp_f32 v33, v105
  v_mfma_f32_16x16x32_bf16 a[108:111], a[164:167], v[128:131], a[108:111]
  s_waitcnt vmcnt(5)
  buffer_load_dwordx4 v8, s[32:35], s46 offen offset:2048 nt lds
  v_exp_f32 v34, v106
  v_mfma_f32_16x16x32_bf16 a[112:115], a[164:167], v[132:135], a[112:115]
  ds_read_b64_tr_b16 a[174:175], v21 offset:4096
  v_add_f32 v30, v32, v33
  v_mfma_f32_16x16x32_bf16 a[116:119], a[164:167], v[136:139], a[116:119]
  v_cvt_pk_bf16_f32 v152, v32, v33
  s_waitcnt lgkmcnt(2)
  v_mfma_f32_16x16x32_bf16 a[120:123], a[168:171], v[120:123], a[120:123]
  v_exp_f32 v35, v107
  v_mfma_f32_16x16x32_bf16 a[124:127], a[168:171], v[124:127], a[124:127]
  ds_read_b64_tr_b16 a[160:161], v14
  v_add_f32 v30, v30, v34
  v_exp_f32 v32, v108
  v_mfma_f32_16x16x32_bf16 a[128:131], a[168:171], v[128:131], a[128:131]
  v_add_f32 v30, v30, v35
  v_mfma_f32_16x16x32_bf16 a[132:135], a[168:171], v[132:135], a[132:135]
  ds_read_b64_tr_b16 a[162:163], v14 offset:4096
  v_cvt_pk_bf16_f32 v153, v34, v35
  v_mfma_f32_16x16x32_bf16 a[136:139], a[168:171], v[136:139], a[136:139]
  v_exp_f32 v33, v109
  s_waitcnt lgkmcnt(2)
  v_mfma_f32_16x16x32_bf16 a[140:143], a[172:175], v[120:123], a[140:143]
  v_add_f32 v30, v30, v32
  v_exp_f32 v34, v110
  v_mfma_f32_16x16x32_bf16 a[144:147], a[172:175], v[124:127], a[144:147]
  s_waitcnt vmcnt(5)
  buffer_load_dwordx4 v9, s[32:35], s46 offen offset:3072 nt lds
  ds_read_b64_tr_b16 a[164:165], v15
  v_add_f32 v30, v30, v33
  v_mfma_f32_16x16x32_bf16 a[148:151], a[172:175], v[128:131], a[148:151]
  v_cvt_pk_bf16_f32 v154, v32, v33
  v_exp_f32 v35, v111
  v_mfma_f32_16x16x32_bf16 a[152:155], a[172:175], v[132:135], a[152:155]
  ds_read_b64_tr_b16 a[166:167], v15 offset:4096
  v_mfma_f32_16x16x32_bf16 a[156:159], a[172:175], v[136:139], a[156:159]
  v_add_f32 v30, v30, v34
  v_exp_f32 v32, v112
  s_waitcnt lgkmcnt(2)
  v_mfma_f32_16x16x32_bf16 a[0:3], a[160:163], v[120:123], a[0:3]
  v_add_f32 v30, v30, v35
  v_mfma_f32_16x16x32_bf16 a[4:7], a[160:163], v[124:127], a[4:7]
  ds_read_b64_tr_b16 a[168:169], v16
  v_cvt_pk_bf16_f32 v155, v34, v35
  v_exp_f32 v33, v113
  v_mfma_f32_16x16x32_bf16 a[8:11], a[160:163], v[128:131], a[8:11]
  v_mfma_f32_16x16x32_bf16 a[12:15], a[160:163], v[132:135], a[12:15]
  ds_read_b64_tr_b16 a[170:171], v16 offset:4096
  v_exp_f32 v34, v114
  v_mfma_f32_16x16x32_bf16 a[16:19], a[160:163], v[136:139], a[16:19]
  v_add_f32 v31, v32, v33
  v_cvt_pk_bf16_f32 v156, v32, v33
  s_waitcnt lgkmcnt(2)
  v_mfma_f32_16x16x32_bf16 a[20:23], a[164:167], v[120:123], a[20:23]
  s_min_u32 s48, s41, 1
  s_lshl_b32 s48, s48, 30
  v_mov_b32 v3, 1
  v_min_u32 v254, 1, v0
  v_lshlrev_b32 v254, 30, v254
  v_add_u32 v254, s48, v254
  s_lshl_b32 s48, s40, 2
  buffer_store_dword v3, v254, s[84:87], s48 offen sc1
  v_exp_f32 v35, v115
  v_mfma_f32_16x16x32_bf16 a[24:27], a[164:167], v[124:127], a[24:27]
  ds_read_b64_tr_b16 a[172:173], v17
  v_add_f32 v31, v31, v34
  v_exp_f32 v32, v116
  v_mfma_f32_16x16x32_bf16 a[28:31], a[164:167], v[128:131], a[28:31]
  v_mfma_f32_16x16x32_bf16 a[32:35], a[164:167], v[132:135], a[32:35]
  ds_read_b64_tr_b16 a[174:175], v17 offset:4096
  v_add_f32 v31, v31, v35
  v_cvt_pk_bf16_f32 v157, v34, v35
  v_mfma_f32_16x16x32_bf16 a[36:39], a[164:167], v[136:139], a[36:39]
  v_exp_f32 v33, v117
  s_waitcnt lgkmcnt(2)
  v_mfma_f32_16x16x32_bf16 a[40:43], a[168:171], v[120:123], a[40:43]
  v_add_f32 v31, v31, v32
  v_exp_f32 v34, v118
  v_mfma_f32_16x16x32_bf16 a[44:47], a[168:171], v[124:127], a[44:47]
  s_waitcnt lgkmcnt(0)
  s_barrier
  ds_read_b128 a[160:163], v10 offset:49152
  v_mfma_f32_16x16x32_bf16 a[48:51], a[168:171], v[128:131], a[48:51]
  v_add_f32 v31, v31, v33
  v_cvt_pk_bf16_f32 v158, v32, v33
  v_mfma_f32_16x16x32_bf16 a[52:55], a[168:171], v[132:135], a[52:55]
  v_exp_f32 v35, v119
  v_mfma_f32_16x16x32_bf16 a[56:59], a[168:171], v[136:139], a[56:59]
  s_add_u32 m0, s47, 16384
  s_add_u32 s46, s47, 147456
  s_waitcnt vmcnt(5)
  buffer_load_dwordx4 v4, s[28:31], s46 offen nt lds
  v_add_f32 v31, v31, v34
  v_add_f32 v31, v31, v35
  v_mfma_f32_16x16x32_bf16 a[60:63], a[172:175], v[120:123], a[60:63]
  v_cvt_pk_bf16_f32 v159, v34, v35
  v_mfma_f32_16x16x32_bf16 a[64:67], a[172:175], v[124:127], a[64:67]
  ds_read_b128 a[164:167], v11 offset:49152
  v_max3_f32 v36, v27, v28, v29
  v_mfma_f32_16x16x32_bf16 a[68:71], a[172:175], v[128:131], a[68:71]
  v_max3_f32 v36, v36, v30, v31
  v_mfma_f32_16x16x32_bf16 a[72:75], a[172:175], v[132:135], a[72:75]
  v_cmp_nge_f32 vcc, s49, v36
  v_mfma_f32_16x16x32_bf16 a[76:79], a[172:175], v[136:139], a[76:79]
  s_cbranch_vccnz Lstub5
Lret5:
  v_add_f32 v22, v22, v27
  v_add_f32 v23, v23, v28
  v_add_f32 v24, v24, v29
  v_add_f32 v25, v25, v30
  v_add_f32 v26, v26, v31
  s_waitcnt lgkmcnt(1)
  v_mfma_f32_16x16x32_bf16 v[80:83], a[160:163], a[176:179], v[160:163]
  v_exp_f32 v32, v40
  v_mfma_f32_16x16x32_bf16 v[88:91], a[160:163], a[192:195], v[164:167]
  ds_read_b128 a[168:171], v12 offset:49152
  v_exp_f32 v33, v41
  v_mfma_f32_16x16x32_bf16 v[96:99], a[160:163], a[208:211], v[168:171]
  v_exp_f32 v34, v42
  v_mfma_f32_16x16x32_bf16 v[104:107], a[160:163], a[224:227], v[172:175]
  s_waitcnt vmcnt(5)
  buffer_load_dwordx4 v5, s[28:31], s46 offen offset:1024 nt lds
  v_add_f32 v27, v32, v33
  v_cvt_pk_bf16_f32 v120, v32, v33
  v_mfma_f32_16x16x32_bf16 v[112:115], a[160:163], a[240:243], v[176:179]
  v_exp_f32 v35, v43
  s_waitcnt lgkmcnt(1)
  v_mfma_f32_16x16x32_bf16 v[80:83], a[164:167], a[180:183], v[80:83]
  v_add_f32 v27, v27, v34
  v_mfma_f32_16x16x32_bf16 v[88:91], a[164:167], a[196:199], v[88:91]
  ds_read_b128 a[172:175], v13 offset:49152
  v_exp_f32 v32, v44
  v_mfma_f32_16x16x32_bf16 v[96:99], a[164:167], a[212:215], v[96:99]
  v_add_f32 v27, v27, v35
  v_cvt_pk_bf16_f32 v121, v34, v35
  v_mfma_f32_16x16x32_bf16 v[104:107], a[164:167], a[228:231], v[104:107]
  v_exp_f32 v33, v45
  v_mfma_f32_16x16x32_bf16 v[112:115], a[164:167], a[244:247], v[112:115]
  v_add_f32 v27, v27, v32
  s_waitcnt lgkmcnt(1)
  v_mfma_f32_16x16x32_bf16 v[80:83], a[168:171], a[184:187], v[80:83]
  v_exp_f32 v34, v46
  v_mfma_f32_16x16x32_bf16 v[88:91], a[168:171], a[200:203], v[88:91]
  ds_read_b128 a[160:163], v10 offset:53248
  v_add_f32 v27, v27, v33
  v_cvt_pk_bf16_f32 v122, v32, v33
  v_mfma_f32_16x16x32_bf16 v[96:99], a[168:171], a[216:219], v[96:99]
  v_exp_f32 v35, v47
  v_mfma_f32_16x16x32_bf16 v[104:107], a[168:171], a[232:235], v[104:107]
  s_waitcnt vmcnt(5)
  buffer_load_dwordx4 v6, s[28:31], s46 offen offset:2048 nt lds
  v_add_f32 v27, v27, v34
  v_mfma_f32_16x16x32_bf16 v[112:115], a[168:171], a[248:251], v[112:115]
  v_exp_f32 v32, v48
  s_waitcnt lgkmcnt(1)
  v_mfma_f32_16x16x32_bf16 v[80:83], a[172:175], a[188:191], v[80:83]
  v_add_f32 v27, v27, v35
  v_cvt_pk_bf16_f32 v123, v34, v35
  v_mfma_f32_16x16x32_bf16 v[88:91], a[172:175], a[204:207], v[88:91]
  ds_read_b128 a[164:167], v11 offset:53248
  v_exp_f32 v33, v49
  v_mfma_f32_16x16x32_bf16 v[96:99], a[172:175], a[220:223], v[96:99]
  v_exp_f32 v34, v50
  v_mfma_f32_16x16x32_bf16 v[104:107], a[172:175], a[236:239], v[104:107]
  v_add_f32 v28, v32, v33
  v_mfma_f32_16x16x32_bf16 v[112:115], a[172:175], a[252:255], v[112:115]
  v_cvt_pk_bf16_f32 v124, v32, v33
  v_exp_f32 v35, v51
  s_waitcnt lgkmcnt(1)
  v_mfma_f32_16x16x32_bf16 v[84:87], a[160:163], a[176:179], v[160:163]
  v_add_f32 v28, v28, v34
  v_mfma_f32_16x16x32_bf16 v[92:95], a[160:163], a[192:195], v[164:167]
  ds_read_b128 a[168:171], v12 offset:53248
  v_exp_f32 v32, v52
  v_mfma_f32_16x16x32_bf16 v[100:103], a[160:163], a[208:211], v[168:171]
  v_add_f32 v28, v28, v35
  v_mfma_f32_16x16x32_bf16 v[108:111], a[160:163], a[224:227], v[172:175]
  s_waitcnt vmcnt(5)
  buffer_load_dwordx4 v7, s[28:31], s46 offen offset:3072 nt lds
  v_cvt_pk_bf16_f32 v125, v34, v35
  v_exp_f32 v33, v53
  v_mfma_f32_16x16x32_bf16 v[116:119], a[160:163], a[240:243], v[176:179]
  v_add_f32 v28, v28, v32
  s_waitcnt lgkmcnt(1)
  v_mfma_f32_16x16x32_bf16 v[84:87], a[164:167], a[180:183], v[84:87]
  v_exp_f32 v34, v54
  v_mfma_f32_16x16x32_bf16 v[92:95], a[164:167], a[196:199], v[92:95]
  ds_read_b128 a[172:175], v13 offset:53248
  v_add_f32 v28, v28, v33
  v_mfma_f32_16x16x32_bf16 v[100:103], a[164:167], a[212:215], v[100:103]
  v_cvt_pk_bf16_f32 v126, v32, v33
  v_exp_f32 v35, v55
  v_mfma_f32_16x16x32_bf16 v[108:111], a[164:167], a[228:231], v[108:111]
  v_add_f32 v28, v28, v34
  v_mfma_f32_16x16x32_bf16 v[116:119], a[164:167], a[244:247], v[116:119]
  v_exp_f32 v32, v56
  s_waitcnt lgkmcnt(1)
  v_mfma_f32_16x16x32_bf16 v[84:87], a[168:171], a[184:187], v[84:87]
  v_add_f32 v28, v28, v35
  v_cvt_pk_bf16_f32 v127, v34, v35
  v_mfma_f32_16x16x32_bf16 v[92:95], a[168:171], a[200:203], v[92:95]
  ds_read_b64_tr_b16 a[160:161], v18 offset:16384
  v_exp_f32 v33, v57
  v_mfma_f32_16x16x32_bf16 v[100:103], a[168:171], a[216:219], v[100:103]
  s_add_u32 m0, s47, 114688
  s_add_u32 s46, s47, 114688
  s_waitcnt vmcnt(5)
  buffer_load_dwordx4 v8, s[32:35], s46 offen nt lds
  v_exp_f32 v34, v58
  v_mfma_f32_16x16x32_bf16 v[108:111], a[168:171], a[232:235], v[108:111]
  ds_read_b64_tr_b16 a[162:163], v18 offset:20480
  v_add_f32 v29, v32, v33
  v_mfma_f32_16x16x32_bf16 v[116:119], a[168:171], a[248:251], v[116:119]
  v_cvt_pk_bf16_f32 v128, v32, v33
  v_exp_f32 v35, v59
  s_waitcnt lgkmcnt(2)
  v_mfma_f32_16x16x32_bf16 v[84:87], a[172:175], a[188:191], v[84:87]
  v_mfma_f32_16x16x32_bf16 v[92:95], a[172:175], a[204:207], v[92:95]
  ds_read_b64_tr_b16 a[164:165], v19 offset:16384
  v_add_f32 v29, v29, v34
  v_exp_f32 v32, v60
  v_mfma_f32_16x16x32_bf16 v[100:103], a[172:175], a[220:223], v[100:103]
  v_add_f32 v29, v29, v35
  v_mfma_f32_16x16x32_bf16 v[108:111], a[172:175], a[236:239], v[108:111]
  ds_read_b64_tr_b16 a[166:167], v19 offset:20480
  v_cvt_pk_bf16_f32 v129, v34, v35
  v_exp_f32 v33, v61
  v_mfma_f32_16x16x32_bf16 v[116:119], a[172:175], a[252:255], v[116:119]
  v_add_f32 v29, v29, v32
  s_waitcnt lgkmcnt(2)
  v_mfma_f32_16x16x32_bf16 a[80:83], a[160:163], v[140:143], a[80:83]
  v_exp_f32 v34, v62
  v_mfma_f32_16x16x32_bf16 a[84:87], a[160:163], v[144:147], a[84:87]
  ds_read_b64_tr_b16 a[168:169], v20 offset:16384
  v_add_f32 v29, v29, v33
  v_mfma_f32_16x16x32_bf16 a[88:91], a[160:163], v[148:151], a[88:91]
  s_waitcnt vmcnt(5)
  buffer_load_dwordx4 v9, s[32:35], s46 offen offset:1024 nt lds
  v_cvt_pk_bf16_f32 v130, v32, v33
  v_exp_f32 v35, v63
  v_mfma_f32_16x16x32_bf16 a[92:95], a[160:163], v[152:155], a[92:95]
  ds_read_b64_tr_b16 a[170:171], v20 offset:20480
  v_add_f32 v29, v29, v34
  v_mfma_f32_16x16x32_bf16 a[96:99], a[160:163], v[156:159], a[96:99]
  v_exp_f32 v32, v64
  s_waitcnt lgkmcnt(2)
  v_mfma_f32_16x16x32_bf16 a[100:103], a[164:167], v[140:143], a[100:103]
  v_add_f32 v29, v29, v35
  v_mfma_f32_16x16x32_bf16 a[104:107], a[164:167], v[144:147], a[104:107]
  ds_read_b64_tr_b16 a[172:173], v21 offset:16384
  v_cvt_pk_bf16_f32 v131, v34, v35
  v_exp_f32 v33, v65
  v_mfma_f32_16x16x32_bf16 a[108:111], a[164:167], v[148:151], a[108:111]
  v_exp_f32 v34, v66
  v_mfma_f32_16x16x32_bf16 a[112:115], a[164:167], v[152:155], a[112:115]
  ds_read_b64_tr_b16 a[174:175], v21 offset:20480
  v_add_f32 v30, v32, v33
  v_mfma_f32_16x16x32_bf16 a[116:119], a[164:167], v[156:159], a[116:119]
  v_cvt_pk_bf16_f32 v132, v32, v33
  s_waitcnt lgkmcnt(2)
  v_mfma_f32_16x16x32_bf16 a[120:123], a[168:171], v[140:143], a[120:123]
  v_exp_f32 v35, v67
  v_mfma_f32_16x16x32_bf16 a[124:127], a[168:171], v[144:147], a[124:127]
  ds_read_b64_tr_b16 a[160:161], v14 offset:16384
  v_add_f32 v30, v30, v34
  v_exp_f32 v32, v68
  v_mfma_f32_16x16x32_bf16 a[128:131], a[168:171], v[148:151], a[128:131]
  s_waitcnt vmcnt(5)
  buffer_load_dwordx4 v8, s[32:35], s46 offen offset:2048 nt lds
  v_add_f32 v30, v30, v35
  v_mfma_f32_16x16x32_bf16 a[132:135], a[168:171], v[152:155], a[132:135]
  ds_read_b64_tr_b16 a[162:163], v14 offset:20480
  v_cvt_pk_bf16_f32 v133, v34, v35
  v_mfma_f32_16x16x32_bf16 a[136:139], a[168:171], v[156:159], a[136:139]
  v_exp_f32 v33, v69
  s_waitcnt lgkmcnt(2)
  v_mfma_f32_16x16x32_bf16 a[140:143], a[172:175], v[140:143], a[140:143]
  v_add_f32 v30, v30, v32
  v_exp_f32 v34, v70
  v_mfma_f32_16x16x32_bf16 a[144:147], a[172:175], v[144:147], a[144:147]
  ds_read_b64_tr_b16 a[164:165], v15 offset:16384
  v_add_f32 v30, v30, v33
  v_mfma_f32_16x16x32_bf16 a[148:151], a[172:175], v[148:151], a[148:151]
  v_cvt_pk_bf16_f32 v134, v32, v33
  v_exp_f32 v35, v71
  v_mfma_f32_16x16x32_bf16 a[152:155], a[172:175], v[152:155], a[152:155]
  ds_read_b64_tr_b16 a[166:167], v15 offset:20480
  v_mfma_f32_16x16x32_bf16 a[156:159], a[172:175], v[156:159], a[156:159]
  v_add_f32 v30, v30, v34
  v_exp_f32 v32, v72
  s_waitcnt lgkmcnt(2)
  v_mfma_f32_16x16x32_bf16 a[0:3], a[160:163], v[140:143], a[0:3]
  v_add_f32 v30, v30, v35
  v_mfma_f32_16x16x32_bf16 a[4:7], a[160:163], v[144:147], a[4:7]
  s_waitcnt vmcnt(5)
  buffer_load_dwordx4 v9, s[32:35], s46 offen offset:3072 nt lds
  ds_read_b64_tr_b16 a[168:169], v16 offset:16384
  v_cvt_pk_bf16_f32 v135, v34, v35
  v_exp_f32 v33, v73
  v_mfma_f32_16x16x32_bf16 a[8:11], a[160:163], v[148:151], a[8:11]
  v_mfma_f32_16x16x32_bf16 a[12:15], a[160:163], v[152:155], a[12:15]
  ds_read_b64_tr_b16 a[170:171], v16 offset:20480
  v_exp_f32 v34, v74
  v_mfma_f32_16x16x32_bf16 a[16:19], a[160:163], v[156:159], a[16:19]
  v_add_f32 v31, v32, v33
  v_cvt_pk_bf16_f32 v136, v32, v33
  s_waitcnt lgkmcnt(2)
  v_mfma_f32_16x16x32_bf16 a[20:23], a[164:167], v[140:143], a[20:23]
  v_exp_f32 v35, v75
  v_mfma_f32_16x16x32_bf16 a[24:27], a[164:167], v[144:147], a[24:27]
  ds_read_b64_tr_b16 a[172:173], v17 offset:16384
  v_add_f32 v31, v31, v34
  v_exp_f32 v32, v76
  v_mfma_f32_16x16x32_bf16 a[28:31], a[164:167], v[148:151], a[28:31]
  v_mfma_f32_16x16x32_bf16 a[32:35], a[164:167], v[152:155], a[32:35]
  ds_read_b64_tr_b16 a[174:175], v17 offset:20480
  v_add_f32 v31, v31, v35
  v_cvt_pk_bf16_f32 v137, v34, v35
  v_mfma_f32_16x16x32_bf16 a[36:39], a[164:167], v[156:159], a[36:39]
  v_exp_f32 v33, v77
  s_waitcnt lgkmcnt(2)
  v_mfma_f32_16x16x32_bf16 a[40:43], a[168:171], v[140:143], a[40:43]
  v_add_f32 v31, v31, v32
  v_exp_f32 v34, v78
  v_mfma_f32_16x16x32_bf16 a[44:47], a[168:171], v[144:147], a[44:47]
  s_waitcnt lgkmcnt(0)
  s_barrier
  ds_read_b128 a[160:163], v10
  v_mfma_f32_16x16x32_bf16 a[48:51], a[168:171], v[148:151], a[48:51]
  v_add_f32 v31, v31, v33
  v_cvt_pk_bf16_f32 v138, v32, v33
  v_mfma_f32_16x16x32_bf16 a[52:55], a[168:171], v[152:155], a[52:55]
  v_exp_f32 v35, v79
  v_mfma_f32_16x16x32_bf16 a[56:59], a[168:171], v[156:159], a[56:59]
  s_add_u32 m0, s47, 32768
  s_add_u32 s46, s47, 163840
  s_waitcnt vmcnt(5)
  buffer_load_dwordx4 v4, s[28:31], s46 offen nt lds
  v_add_f32 v31, v31, v34
  v_add_f32 v31, v31, v35
  v_mfma_f32_16x16x32_bf16 a[60:63], a[172:175], v[140:143], a[60:63]
  v_cvt_pk_bf16_f32 v139, v34, v35
  v_mfma_f32_16x16x32_bf16 a[64:67], a[172:175], v[144:147], a[64:67]
  ds_read_b128 a[164:167], v11
  v_max3_f32 v36, v27, v28, v29
  v_mfma_f32_16x16x32_bf16 a[68:71], a[172:175], v[148:151], a[68:71]
  v_max3_f32 v36, v36, v30, v31
  v_mfma_f32_16x16x32_bf16 a[72:75], a[172:175], v[152:155], a[72:75]
  v_cmp_nge_f32 vcc, s49, v36
  v_mfma_f32_16x16x32_bf16 a[76:79], a[172:175], v[156:159], a[76:79]
  s_cbranch_vccnz Lstub6
Lret6:
  v_add_f32 v22, v22, v27
  v_add_f32 v23, v23, v28
  v_add_f32 v24, v24, v29
  v_add_f32 v25, v25, v30
  v_add_f32 v26, v26, v31
  s_waitcnt lgkmcnt(1)
  v_mfma_f32_16x16x32_bf16 v[40:43], a[160:163], a[176:179], v[160:163]
  v_exp_f32 v32, v80
  v_mfma_f32_16x16x32_bf16 v[48:51], a[160:163], a[192:195], v[164:167]
  ds_read_b128 a[168:171], v12
  v_exp_f32 v33, v81
  v_mfma_f32_16x16x32_bf16 v[56:59], a[160:163], a[208:211], v[168:171]
  v_exp_f32 v34, v82
  v_mfma_f32_16x16x32_bf16 v[64:67], a[160:163], a[224:227], v[172:175]
  s_waitcnt vmcnt(5)
  buffer_load_dwordx4 v5, s[28:31], s46 offen offset:1024 nt lds
  v_add_f32 v27, v32, v33
  v_cvt_pk_bf16_f32 v140, v32, v33
  v_mfma_f32_16x16x32_bf16 v[72:75], a[160:163], a[240:243], v[176:179]
  v_exp_f32 v35, v83
  s_waitcnt lgkmcnt(1)
  v_mfma_f32_16x16x32_bf16 v[40:43], a[164:167], a[180:183], v[40:43]
  v_add_f32 v27, v27, v34
  v_mfma_f32_16x16x32_bf16 v[48:51], a[164:167], a[196:199], v[48:51]
  ds_read_b128 a[172:175], v13
  v_exp_f32 v32, v84
  v_mfma_f32_16x16x32_bf16 v[56:59], a[164:167], a[212:215], v[56:59]
  v_add_f32 v27, v27, v35
  v_cvt_pk_bf16_f32 v141, v34, v35
  v_mfma_f32_16x16x32_bf16 v[64:67], a[164:167], a[228:231], v[64:67]
  v_exp_f32 v33, v85
  v_mfma_f32_16x16x32_bf16 v[72:75], a[164:167], a[244:247], v[72:75]
  v_add_f32 v27, v27, v32
  s_waitcnt lgkmcnt(1)
  v_mfma_f32_16x16x32_bf16 v[40:43], a[168:171], a[184:187], v[40:43]
  v_exp_f32 v34, v86
  v_mfma_f32_16x16x32_bf16 v[48:51], a[168:171], a[200:203], v[48:51]
  ds_read_b128 a[160:163], v10 offset:4096
  v_add_f32 v27, v27, v33
  v_cvt_pk_bf16_f32 v142, v32, v33
  v_mfma_f32_16x16x32_bf16 v[56:59], a[168:171], a[216:219], v[56:59]
  v_exp_f32 v35, v87
  v_mfma_f32_16x16x32_bf16 v[64:67], a[168:171], a[232:235], v[64:67]
  s_waitcnt vmcnt(5)
  buffer_load_dwordx4 v6, s[28:31], s46 offen offset:2048 nt lds
  v_add_f32 v27, v27, v34
  v_mfma_f32_16x16x32_bf16 v[72:75], a[168:171], a[248:251], v[72:75]
  v_exp_f32 v32, v88
  s_waitcnt lgkmcnt(1)
  v_mfma_f32_16x16x32_bf16 v[40:43], a[172:175], a[188:191], v[40:43]
  v_add_f32 v27, v27, v35
  v_cvt_pk_bf16_f32 v143, v34, v35
  v_mfma_f32_16x16x32_bf16 v[48:51], a[172:175], a[204:207], v[48:51]
  ds_read_b128 a[164:167], v11 offset:4096
  v_exp_f32 v33, v89
  v_mfma_f32_16x16x32_bf16 v[56:59], a[172:175], a[220:223], v[56:59]
  v_exp_f32 v34, v90
  v_mfma_f32_16x16x32_bf16 v[64:67], a[172:175], a[236:239], v[64:67]
  v_add_f32 v28, v32, v33
  v_mfma_f32_16x16x32_bf16 v[72:75], a[172:175], a[252:255], v[72:75]
  v_cvt_pk_bf16_f32 v144, v32, v33
  v_exp_f32 v35, v91
  s_waitcnt lgkmcnt(1)
  v_mfma_f32_16x16x32_bf16 v[44:47], a[160:163], a[176:179], v[160:163]
  v_add_f32 v28, v28, v34
  v_mfma_f32_16x16x32_bf16 v[52:55], a[160:163], a[192:195], v[164:167]
  ds_read_b128 a[168:171], v12 offset:4096
  v_exp_f32 v32, v92
  v_mfma_f32_16x16x32_bf16 v[60:63], a[160:163], a[208:211], v[168:171]
  v_add_f32 v28, v28, v35
  v_mfma_f32_16x16x32_bf16 v[68:71], a[160:163], a[224:227], v[172:175]
  s_waitcnt vmcnt(5)
  buffer_load_dwordx4 v7, s[28:31], s46 offen offset:3072 nt lds
  v_cvt_pk_bf16_f32 v145, v34, v35
  v_exp_f32 v33, v93
  v_mfma_f32_16x16x32_bf16 v[76:79], a[160:163], a[240:243], v[176:179]
  v_add_f32 v28, v28, v32
  s_waitcnt lgkmcnt(1)
  v_mfma_f32_16x16x32_bf16 v[44:47], a[164:167], a[180:183], v[44:47]
  v_exp_f32 v34, v94
  v_mfma_f32_16x16x32_bf16 v[52:55], a[164:167], a[196:199], v[52:55]
  ds_read_b128 a[172:175], v13 offset:4096
  v_add_f32 v28, v28, v33
  v_mfma_f32_16x16x32_bf16 v[60:63], a[164:167], a[212:215], v[60:63]
  v_cvt_pk_bf16_f32 v146, v32, v33
  v_exp_f32 v35, v95
  v_mfma_f32_16x16x32_bf16 v[68:71], a[164:167], a[228:231], v[68:71]
  v_add_f32 v28, v28, v34
  v_mfma_f32_16x16x32_bf16 v[76:79], a[164:167], a[244:247], v[76:79]
  v_exp_f32 v32, v96
  s_waitcnt lgkmcnt(1)
  v_mfma_f32_16x16x32_bf16 v[44:47], a[168:171], a[184:187], v[44:47]
  v_add_f32 v28, v28, v35
  v_cvt_pk_bf16_f32 v147, v34, v35
  v_mfma_f32_16x16x32_bf16 v[52:55], a[168:171], a[200:203], v[52:55]
  ds_read_b64_tr_b16 a[160:161], v18 offset:32768
  v_exp_f32 v33, v97
  v_mfma_f32_16x16x32_bf16 v[60:63], a[168:171], a[216:219], v[60:63]
  s_add_u32 m0, s47, 65536
  s_add_u32 s46, s47, 131072
  s_waitcnt vmcnt(5)
  buffer_load_dwordx4 v8, s[32:35], s46 offen nt lds
  v_exp_f32 v34, v98
  v_mfma_f32_16x16x32_bf16 v[68:71], a[168:171], a[232:235], v[68:71]
  ds_read_b64_tr_b16 a[162:163], v18 offset:36864
  v_add_f32 v29, v32, v33
  v_mfma_f32_16x16x32_bf16 v[76:79], a[168:171], a[248:251], v[76:79]
  v_cvt_pk_bf16_f32 v148, v32, v33
  v_exp_f32 v35, v99
  s_waitcnt lgkmcnt(2)
  v_mfma_f32_16x16x32_bf16 v[44:47], a[172:175], a[188:191], v[44:47]
  v_mfma_f32_16x16x32_bf16 v[52:55], a[172:175], a[204:207], v[52:55]
  ds_read_b64_tr_b16 a[164:165], v19 offset:32768
  v_add_f32 v29, v29, v34
  v_exp_f32 v32, v100
  v_mfma_f32_16x16x32_bf16 v[60:63], a[172:175], a[220:223], v[60:63]
  v_add_f32 v29, v29, v35
  v_mfma_f32_16x16x32_bf16 v[68:71], a[172:175], a[236:239], v[68:71]
  ds_read_b64_tr_b16 a[166:167], v19 offset:36864
  v_cvt_pk_bf16_f32 v149, v34, v35
  v_exp_f32 v33, v101
  v_mfma_f32_16x16x32_bf16 v[76:79], a[172:175], a[252:255], v[76:79]
  v_add_f32 v29, v29, v32
  s_waitcnt lgkmcnt(2)
  v_mfma_f32_16x16x32_bf16 a[80:83], a[160:163], v[120:123], a[80:83]
  v_exp_f32 v34, v102
  v_mfma_f32_16x16x32_bf16 a[84:87], a[160:163], v[124:127], a[84:87]
  ds_read_b64_tr_b16 a[168:169], v20 offset:32768
  v_add_f32 v29, v29, v33
  v_mfma_f32_16x16x32_bf16 a[88:91], a[160:163], v[128:131], a[88:91]
  s_waitcnt vmcnt(5)
  buffer_load_dwordx4 v9, s[32:35], s46 offen offset:1024 nt lds
  v_cvt_pk_bf16_f32 v150, v32, v33
  v_exp_f32 v35, v103
  v_mfma_f32_16x16x32_bf16 a[92:95], a[160:163], v[132:135], a[92:95]
  ds_read_b64_tr_b16 a[170:171], v20 offset:36864
  v_add_f32 v29, v29, v34
  v_mfma_f32_16x16x32_bf16 a[96:99], a[160:163], v[136:139], a[96:99]
  v_exp_f32 v32, v104
  s_waitcnt lgkmcnt(2)
  v_mfma_f32_16x16x32_bf16 a[100:103], a[164:167], v[120:123], a[100:103]
  v_add_f32 v29, v29, v35
  v_mfma_f32_16x16x32_bf16 a[104:107], a[164:167], v[124:127], a[104:107]
  ds_read_b64_tr_b16 a[172:173], v21 offset:32768
  v_cvt_pk_bf16_f32 v151, v34, v35
  v_exp_f32 v33, v105
  v_mfma_f32_16x16x32_bf16 a[108:111], a[164:167], v[128:131], a[108:111]
  v_exp_f32 v34, v106
  v_mfma_f32_16x16x32_bf16 a[112:115], a[164:167], v[132:135], a[112:115]
  ds_read_b64_tr_b16 a[174:175], v21 offset:36864
  v_add_f32 v30, v32, v33
  v_mfma_f32_16x16x32_bf16 a[116:119], a[164:167], v[136:139], a[116:119]
  v_cvt_pk_bf16_f32 v152, v32, v33
  s_waitcnt lgkmcnt(2)
  v_mfma_f32_16x16x32_bf16 a[120:123], a[168:171], v[120:123], a[120:123]
  v_exp_f32 v35, v107
  v_mfma_f32_16x16x32_bf16 a[124:127], a[168:171], v[124:127], a[124:127]
  ds_read_b64_tr_b16 a[160:161], v14 offset:32768
  v_add_f32 v30, v30, v34
  v_exp_f32 v32, v108
  v_mfma_f32_16x16x32_bf16 a[128:131], a[168:171], v[128:131], a[128:131]
  s_waitcnt vmcnt(5)
  buffer_load_dwordx4 v8, s[32:35], s46 offen offset:2048 nt lds
  v_add_f32 v30, v30, v35
  v_mfma_f32_16x16x32_bf16 a[132:135], a[168:171], v[132:135], a[132:135]
  ds_read_b64_tr_b16 a[162:163], v14 offset:36864
  v_cvt_pk_bf16_f32 v153, v34, v35
  v_mfma_f32_16x16x32_bf16 a[136:139], a[168:171], v[136:139], a[136:139]
  v_exp_f32 v33, v109
  s_waitcnt lgkmcnt(2)
  v_mfma_f32_16x16x32_bf16 a[140:143], a[172:175], v[120:123], a[140:143]
  v_add_f32 v30, v30, v32
  v_exp_f32 v34, v110
  v_mfma_f32_16x16x32_bf16 a[144:147], a[172:175], v[124:127], a[144:147]
  ds_read_b64_tr_b16 a[164:165], v15 offset:32768
  v_add_f32 v30, v30, v33
  v_mfma_f32_16x16x32_bf16 a[148:151], a[172:175], v[128:131], a[148:151]
  v_cvt_pk_bf16_f32 v154, v32, v33
  v_exp_f32 v35, v111
  v_mfma_f32_16x16x32_bf16 a[152:155], a[172:175], v[132:135], a[152:155]
  ds_read_b64_tr_b16 a[166:167], v15 offset:36864
  v_mfma_f32_16x16x32_bf16 a[156:159], a[172:175], v[136:139], a[156:159]
  v_add_f32 v30, v30, v34
  v_exp_f32 v32, v112
  s_waitcnt lgkmcnt(2)
  v_mfma_f32_16x16x32_bf16 a[0:3], a[160:163], v[120:123], a[0:3]
  v_add_f32 v30, v30, v35
  v_mfma_f32_16x16x32_bf16 a[4:7], a[160:163], v[124:127], a[4:7]
  s_waitcnt vmcnt(5)
  buffer_load_dwordx4 v9, s[32:35], s46 offen offset:3072 nt lds
  ds_read_b64_tr_b16 a[168:169], v16 offset:32768
  v_cvt_pk_bf16_f32 v155, v34, v35
  v_exp_f32 v33, v113
  v_mfma_f32_16x16x32_bf16 a[8:11], a[160:163], v[128:131], a[8:11]
  v_mfma_f32_16x16x32_bf16 a[12:15], a[160:163], v[132:135], a[12:15]
  ds_read_b64_tr_b16 a[170:171], v16 offset:36864
  v_exp_f32 v34, v114
  v_mfma_f32_16x16x32_bf16 a[16:19], a[160:163], v[136:139], a[16:19]
  v_add_f32 v31, v32, v33
  v_cvt_pk_bf16_f32 v156, v32, v33
  s_waitcnt lgkmcnt(2)
  v_mfma_f32_16x16x32_bf16 a[20:23], a[164:167], v[120:123], a[20:23]
  v_exp_f32 v35, v115
  v_mfma_f32_16x16x32_bf16 a[24:27], a[164:167], v[124:127], a[24:27]
  ds_read_b64_tr_b16 a[172:173], v17 offset:32768
  v_add_f32 v31, v31, v34
  v_exp_f32 v32, v116
  v_mfma_f32_16x16x32_bf16 a[28:31], a[164:167], v[128:131], a[28:31]
  v_mfma_f32_16x16x32_bf16 a[32:35], a[164:167], v[132:135], a[32:35]
  ds_read_b64_tr_b16 a[174:175], v17 offset:36864
  v_add_f32 v31, v31, v35
  v_cvt_pk_bf16_f32 v157, v34, v35
  v_mfma_f32_16x16x32_bf16 a[36:39], a[164:167], v[136:139], a[36:39]
  v_exp_f32 v33, v117
  s_waitcnt lgkmcnt(2)
  v_mfma_f32_16x16x32_bf16 a[40:43], a[168:171], v[120:123], a[40:43]
  v_add_f32 v31, v31, v32
  v_exp_f32 v34, v118
  v_mfma_f32_16x16x32_bf16 a[44:47], a[168:171], v[124:127], a[44:47]
  s_waitcnt lgkmcnt(0)
  s_barrier
  ds_read_b128 a[160:163], v10 offset:16384
  v_mfma_f32_16x16x32_bf16 a[48:51], a[168:171], v[128:131], a[48:51]
  v_add_f32 v31, v31, v33
  v_cvt_pk_bf16_f32 v158, v32, v33
  v_mfma_f32_16x16x32_bf16 a[52:55], a[168:171], v[132:135], a[52:55]
  v_exp_f32 v35, v119
  v_mfma_f32_16x16x32_bf16 a[56:59], a[168:171], v[136:139], a[56:59]
  s_add_u32 m0, s47, 49152
  s_add_u32 s46, s47, 180224
  s_waitcnt vmcnt(5)
  buffer_load_dwordx4 v4, s[28:31], s46 offen nt lds
  v_add_f32 v31, v31, v34
  v_add_f32 v31, v31, v35
  v_mfma_f32_16x16x32_bf16 a[60:63], a[172:175], v[120:123], a[60:63]
  v_cvt_pk_bf16_f32 v159, v34, v35
  v_mfma_f32_16x16x32_bf16 a[64:67], a[172:175], v[124:127], a[64:67]
  ds_read_b128 a[164:167], v11 offset:16384
  v_max3_f32 v36, v27, v28, v29
  v_mfma_f32_16x16x32_bf16 a[68:71], a[172:175], v[128:131], a[68:71]
  v_max3_f32 v36, v36, v30, v31
  v_mfma_f32_16x16x32_bf16 a[72:75], a[172:175], v[132:135], a[72:75]
  v_cmp_nge_f32 vcc, s49, v36
  v_mfma_f32_16x16x32_bf16 a[76:79], a[172:175], v[136:139], a[76:79]
  s_cbranch_vccnz Lstub7
Lret7:
  v_add_f32 v22, v22, v27
  v_add_f32 v23, v23, v28
  v_add_f32 v24, v24, v29
  v_add_f32 v25, v25, v30
  v_add_f32 v26, v26, v31
  s_waitcnt lgkmcnt(1)
  v_mfma_f32_16x16x32_bf16 v[80:83], a[160:163], a[176:179], v[160:163]
  v_exp_f32 v32, v40
  v_mfma_f32_16x16x32_bf16 v[88:91], a[160:163], a[192:195], v[164:167]
  ds_read_b128 a[168:171], v12 offset:16384
  v_exp_f32 v33, v41
  v_mfma_f32_16x16x32_bf16 v[96:99], a[160:163], a[208:211], v[168:171]
  v_exp_f32 v34, v42
  v_mfma_f32_16x16x32_bf16 v[104:107], a[160:163], a[224:227], v[172:175]
  s_waitcnt vmcnt(5)
  buffer_load_dwordx4 v5, s[28:31], s46 offen offset:1024 nt lds
  v_add_f32 v27, v32, v33
  v_cvt_pk_bf16_f32 v120, v32, v33
  v_mfma_f32_16x16x32_bf16 v[112:115], a[160:163], a[240:243], v[176:179]
  v_exp_f32 v35, v43
  s_waitcnt lgkmcnt(1)
  v_mfma_f32_16x16x32_bf16 v[80:83], a[164:167], a[180:183], v[80:83]
  v_add_f32 v27, v27, v34
  v_mfma_f32_16x16x32_bf16 v[88:91], a[164:167], a[196:199], v[88:91]
  ds_read_b128 a[172:175], v13 offset:16384
  v_exp_f32 v32, v44
  v_mfma_f32_16x16x32_bf16 v[96:99], a[164:167], a[212:215], v[96:99]
  v_add_f32 v27, v27, v35
  v_cvt_pk_bf16_f32 v121, v34, v35
  v_mfma_f32_16x16x32_bf16 v[104:107], a[164:167], a[228:231], v[104:107]
  v_exp_f32 v33, v45
  v_mfma_f32_16x16x32_bf16 v[112:115], a[164:167], a[244:247], v[112:115]
  v_add_f32 v27, v27, v32
  s_waitcnt lgkmcnt(1)
  v_mfma_f32_16x16x32_bf16 v[80:83], a[168:171], a[184:187], v[80:83]
  v_exp_f32 v34, v46
  v_mfma_f32_16x16x32_bf16 v[88:91], a[168:171], a[200:203], v[88:91]
  ds_read_b128 a[160:163], v10 offset:20480
  v_add_f32 v27, v27, v33
  v_cvt_pk_bf16_f32 v122, v32, v33
  v_mfma_f32_16x16x32_bf16 v[96:99], a[168:171], a[216:219], v[96:99]
  v_exp_f32 v35, v47
  v_mfma_f32_16x16x32_bf16 v[104:107], a[168:171], a[232:235], v[104:107]
  s_waitcnt vmcnt(5)
  buffer_load_dwordx4 v6, s[28:31], s46 offen offset:2048 nt lds
  v_add_f32 v27, v27, v34
  v_mfma_f32_16x16x32_bf16 v[112:115], a[168:171], a[248:251], v[112:115]
  v_exp_f32 v32, v48
  s_waitcnt lgkmcnt(1)
  v_mfma_f32_16x16x32_bf16 v[80:83], a[172:175], a[188:191], v[80:83]
  v_add_f32 v27, v27, v35
  v_cvt_pk_bf16_f32 v123, v34, v35
  v_mfma_f32_16x16x32_bf16 v[88:91], a[172:175], a[204:207], v[88:91]
  ds_read_b128 a[164:167], v11 offset:20480
  v_exp_f32 v33, v49
  v_mfma_f32_16x16x32_bf16 v[96:99], a[172:175], a[220:223], v[96:99]
  v_exp_f32 v34, v50
  v_mfma_f32_16x16x32_bf16 v[104:107], a[172:175], a[236:239], v[104:107]
  v_add_f32 v28, v32, v33
  v_mfma_f32_16x16x32_bf16 v[112:115], a[172:175], a[252:255], v[112:115]
  v_cvt_pk_bf16_f32 v124, v32, v33
  v_exp_f32 v35, v51
  s_waitcnt lgkmcnt(1)
  v_mfma_f32_16x16x32_bf16 v[84:87], a[160:163], a[176:179], v[160:163]
  v_add_f32 v28, v28, v34
  v_mfma_f32_16x16x32_bf16 v[92:95], a[160:163], a[192:195], v[164:167]
  ds_read_b128 a[168:171], v12 offset:20480
  v_exp_f32 v32, v52
  v_mfma_f32_16x16x32_bf16 v[100:103], a[160:163], a[208:211], v[168:171]
  v_add_f32 v28, v28, v35
  v_mfma_f32_16x16x32_bf16 v[108:111], a[160:163], a[224:227], v[172:175]
  s_waitcnt vmcnt(5)
  buffer_load_dwordx4 v7, s[28:31], s46 offen offset:3072 nt lds
  v_cvt_pk_bf16_f32 v125, v34, v35
  v_exp_f32 v33, v53
  v_mfma_f32_16x16x32_bf16 v[116:119], a[160:163], a[240:243], v[176:179]
  v_add_f32 v28, v28, v32
  s_waitcnt lgkmcnt(1)
  v_mfma_f32_16x16x32_bf16 v[84:87], a[164:167], a[180:183], v[84:87]
  v_exp_f32 v34, v54
  v_mfma_f32_16x16x32_bf16 v[92:95], a[164:167], a[196:199], v[92:95]
  ds_read_b128 a[172:175], v13 offset:20480
  v_add_f32 v28, v28, v33
  v_mfma_f32_16x16x32_bf16 v[100:103], a[164:167], a[212:215], v[100:103]
  v_cvt_pk_bf16_f32 v126, v32, v33
  v_exp_f32 v35, v55
  v_mfma_f32_16x16x32_bf16 v[108:111], a[164:167], a[228:231], v[108:111]
  v_add_f32 v28, v28, v34
  v_mfma_f32_16x16x32_bf16 v[116:119], a[164:167], a[244:247], v[116:119]
  v_exp_f32 v32, v56
  s_waitcnt lgkmcnt(1)
  v_mfma_f32_16x16x32_bf16 v[84:87], a[168:171], a[184:187], v[84:87]
  v_add_f32 v28, v28, v35
  v_cvt_pk_bf16_f32 v127, v34, v35
  v_mfma_f32_16x16x32_bf16 v[92:95], a[168:171], a[200:203], v[92:95]
  ds_read_b64_tr_b16 a[160:161], v18 offset:49152
  v_exp_f32 v33, v57
  v_mfma_f32_16x16x32_bf16 v[100:103], a[168:171], a[216:219], v[100:103]
  s_add_u32 m0, s47, 81920
  s_add_u32 s46, s47, 147456
  s_waitcnt vmcnt(5)
  buffer_load_dwordx4 v8, s[32:35], s46 offen nt lds
  v_exp_f32 v34, v58
  v_mfma_f32_16x16x32_bf16 v[108:111], a[168:171], a[232:235], v[108:111]
  ds_read_b64_tr_b16 a[162:163], v18 offset:53248
  v_add_f32 v29, v32, v33
  v_mfma_f32_16x16x32_bf16 v[116:119], a[168:171], a[248:251], v[116:119]
  v_cvt_pk_bf16_f32 v128, v32, v33
  v_exp_f32 v35, v59
  s_waitcnt lgkmcnt(2)
  v_mfma_f32_16x16x32_bf16 v[84:87], a[172:175], a[188:191], v[84:87]
  v_mfma_f32_16x16x32_bf16 v[92:95], a[172:175], a[204:207], v[92:95]
  ds_read_b64_tr_b16 a[164:165], v19 offset:49152
  v_add_f32 v29, v29, v34
  v_exp_f32 v32, v60
  v_mfma_f32_16x16x32_bf16 v[100:103], a[172:175], a[220:223], v[100:103]
  v_add_f32 v29, v29, v35
  v_mfma_f32_16x16x32_bf16 v[108:111], a[172:175], a[236:239], v[108:111]
  ds_read_b64_tr_b16 a[166:167], v19 offset:53248
  v_cvt_pk_bf16_f32 v129, v34, v35
  v_exp_f32 v33, v61
  v_mfma_f32_16x16x32_bf16 v[116:119], a[172:175], a[252:255], v[116:119]
  v_add_f32 v29, v29, v32
  s_waitcnt lgkmcnt(2)
  v_mfma_f32_16x16x32_bf16 a[80:83], a[160:163], v[140:143], a[80:83]
  v_exp_f32 v34, v62
  v_mfma_f32_16x16x32_bf16 a[84:87], a[160:163], v[144:147], a[84:87]
  ds_read_b64_tr_b16 a[168:169], v20 offset:49152
  v_add_f32 v29, v29, v33
  v_mfma_f32_16x16x32_bf16 a[88:91], a[160:163], v[148:151], a[88:91]
  s_waitcnt vmcnt(5)
  buffer_load_dwordx4 v9, s[32:35], s46 offen offset:1024 nt lds
  v_cvt_pk_bf16_f32 v130, v32, v33
  v_exp_f32 v35, v63
  v_mfma_f32_16x16x32_bf16 a[92:95], a[160:163], v[152:155], a[92:95]
  ds_read_b64_tr_b16 a[170:171], v20 offset:53248
  v_add_f32 v29, v29, v34
  v_mfma_f32_16x16x32_bf16 a[96:99], a[160:163], v[156:159], a[96:99]
  v_exp_f32 v32, v64
  s_waitcnt lgkmcnt(2)
  v_mfma_f32_16x16x32_bf16 a[100:103], a[164:167], v[140:143], a[100:103]
  v_add_f32 v29, v29, v35
  v_mfma_f32_16x16x32_bf16 a[104:107], a[164:167], v[144:147], a[104:107]
  ds_read_b64_tr_b16 a[172:173], v21 offset:49152
  v_cvt_pk_bf16_f32 v131, v34, v35
  v_exp_f32 v33, v65
  v_mfma_f32_16x16x32_bf16 a[108:111], a[164:167], v[148:151], a[108:111]
  v_exp_f32 v34, v66
  v_mfma_f32_16x16x32_bf16 a[112:115], a[164:167], v[152:155], a[112:115]
  ds_read_b64_tr_b16 a[174:175], v21 offset:53248
  v_add_f32 v30, v32, v33
  v_mfma_f32_16x16x32_bf16 a[116:119], a[164:167], v[156:159], a[116:119]
  v_cvt_pk_bf16_f32 v132, v32, v33
  s_waitcnt lgkmcnt(2)
  v_mfma_f32_16x16x32_bf16 a[120:123], a[168:171], v[140:143], a[120:123]
  v_exp_f32 v35, v67
  v_mfma_f32_16x16x32_bf16 a[124:127], a[168:171], v[144:147], a[124:127]
  ds_read_b64_tr_b16 a[160:161], v14 offset:49152
  v_add_f32 v30, v30, v34
  v_exp_f32 v32, v68
  v_mfma_f32_16x16x32_bf16 a[128:131], a[168:171], v[148:151], a[128:131]
  s_waitcnt vmcnt(5)
  buffer_load_dwordx4 v8, s[32:35], s46 offen offset:2048 nt lds
  v_add_f32 v30, v30, v35
  v_mfma_f32_16x16x32_bf16 a[132:135], a[168:171], v[152:155], a[132:135]
  ds_read_b64_tr_b16 a[162:163], v14 offset:53248
  v_cvt_pk_bf16_f32 v133, v34, v35
  v_mfma_f32_16x16x32_bf16 a[136:139], a[168:171], v[156:159], a[136:139]
  v_exp_f32 v33, v69
  s_waitcnt lgkmcnt(2)
  v_mfma_f32_16x16x32_bf16 a[140:143], a[172:175], v[140:143], a[140:143]
  v_add_f32 v30, v30, v32
  v_exp_f32 v34, v70
  v_mfma_f32_16x16x32_bf16 a[144:147], a[172:175], v[144:147], a[144:147]
  ds_read_b64_tr_b16 a[164:165], v15 offset:49152
  v_add_f32 v30, v30, v33
  v_mfma_f32_16x16x32_bf16 a[148:151], a[172:175], v[148:151], a[148:151]
  v_cvt_pk_bf16_f32 v134, v32, v33
  v_exp_f32 v35, v71
  v_mfma_f32_16x16x32_bf16 a[152:155], a[172:175], v[152:155], a[152:155]
  ds_read_b64_tr_b16 a[166:167], v15 offset:53248
  v_mfma_f32_16x16x32_bf16 a[156:159], a[172:175], v[156:159], a[156:159]
  v_add_f32 v30, v30, v34
  v_exp_f32 v32, v72
  s_waitcnt lgkmcnt(2)
  v_mfma_f32_16x16x32_bf16 a[0:3], a[160:163], v[140:143], a[0:3]
  v_add_f32 v30, v30, v35
  v_mfma_f32_16x16x32_bf16 a[4:7], a[160:163], v[144:147], a[4:7]
  s_waitcnt vmcnt(5)
  buffer_load_dwordx4 v9, s[32:35], s46 offen offset:3072 nt lds
  ds_read_b64_tr_b16 a[168:169], v16 offset:49152
  v_cvt_pk_bf16_f32 v135, v34, v35
  v_exp_f32 v33, v73
  v_mfma_f32_16x16x32_bf16 a[8:11], a[160:163], v[148:151], a[8:11]
  v_mfma_f32_16x16x32_bf16 a[12:15], a[160:163], v[152:155], a[12:15]
  ds_read_b64_tr_b16 a[170:171], v16 offset:53248
  v_exp_f32 v34, v74
  v_mfma_f32_16x16x32_bf16 a[16:19], a[160:163], v[156:159], a[16:19]
  v_add_f32 v31, v32, v33
  v_cvt_pk_bf16_f32 v136, v32, v33
  s_waitcnt lgkmcnt(2)
  v_mfma_f32_16x16x32_bf16 a[20:23], a[164:167], v[140:143], a[20:23]
  v_exp_f32 v35, v75
  v_mfma_f32_16x16x32_bf16 a[24:27], a[164:167], v[144:147], a[24:27]
  ds_read_b64_tr_b16 a[172:173], v17 offset:49152
  v_add_f32 v31, v31, v34
  v_exp_f32 v32, v76
  v_mfma_f32_16x16x32_bf16 a[28:31], a[164:167], v[148:151], a[28:31]
  v_mfma_f32_16x16x32_bf16 a[32:35], a[164:167], v[152:155], a[32:35]
  ds_read_b64_tr_b16 a[174:175], v17 offset:53248
  v_add_f32 v31, v31, v35
  v_cvt_pk_bf16_f32 v137, v34, v35
  v_mfma_f32_16x16x32_bf16 a[36:39], a[164:167], v[156:159], a[36:39]
  v_exp_f32 v33, v77
  s_waitcnt lgkmcnt(2)
  v_mfma_f32_16x16x32_bf16 a[40:43], a[168:171], v[140:143], a[40:43]
  v_add_f32 v31, v31, v32
  v_exp_f32 v34, v78
  v_mfma_f32_16x16x32_bf16 a[44:47], a[168:171], v[144:147], a[44:47]
  s_waitcnt lgkmcnt(0)
  s_barrier
  ds_read_b128 a[160:163], v10 offset:32768
  v_mfma_f32_16x16x32_bf16 a[48:51], a[168:171], v[148:151], a[48:51]
  v_add_f32 v31, v31, v33
  v_cvt_pk_bf16_f32 v138, v32, v33
  v_mfma_f32_16x16x32_bf16 a[52:55], a[168:171], v[152:155], a[52:55]
  v_exp_f32 v35, v79
  v_mfma_f32_16x16x32_bf16 a[56:59], a[168:171], v[156:159], a[56:59]
  s_add_u32 m0, s47, 0
  s_add_u32 s46, s47, 196608
  s_waitcnt vmcnt(5)
  buffer_load_dwordx4 v4, s[28:31], s46 offen nt lds
  v_add_f32 v31, v31, v34
  v_add_f32 v31, v31, v35
  v_mfma_f32_16x16x32_bf16 a[60:63], a[172:175], v[140:143], a[60:63]
  v_cvt_pk_bf16_f32 v139, v34, v35
  v_mfma_f32_16x16x32_bf16 a[64:67], a[172:175], v[144:147], a[64:67]
  ds_read_b128 a[164:167], v11 offset:32768
  v_max3_f32 v36, v27, v28, v29
  v_mfma_f32_16x16x32_bf16 a[68:71], a[172:175], v[148:151], a[68:71]
  v_max3_f32 v36, v36, v30, v31
  v_mfma_f32_16x16x32_bf16 a[72:75], a[172:175], v[152:155], a[72:75]
  v_cmp_nge_f32 vcc, s49, v36
  v_mfma_f32_16x16x32_bf16 a[76:79], a[172:175], v[156:159], a[76:79]
  s_cbranch_vccnz Lstub8
Lret8:
  v_add_f32 v22, v22, v27
  v_add_f32 v23, v23, v28
  v_add_f32 v24, v24, v29
  v_add_f32 v25, v25, v30
  v_add_f32 v26, v26, v31
  s_waitcnt lgkmcnt(1)
  v_mfma_f32_16x16x32_bf16 v[40:43], a[160:163], a[176:179], v[160:163]
  v_exp_f32 v32, v80
  v_mfma_f32_16x16x32_bf16 v[48:51], a[160:163], a[192:195], v[164:167]
  ds_read_b128 a[168:171], v12 offset:32768
  v_exp_f32 v33, v81
  v_mfma_f32_16x16x32_bf16 v[56:59], a[160:163], a[208:211], v[168:171]
  v_exp_f32 v34, v82
  v_mfma_f32_16x16x32_bf16 v[64:67], a[160:163], a[224:227], v[172:175]
  s_waitcnt vmcnt(5)
  buffer_load_dwordx4 v5, s[28:31], s46 offen offset:1024 nt lds
  v_add_f32 v27, v32, v33
  v_cvt_pk_bf16_f32 v140, v32, v33
  v_mfma_f32_16x16x32_bf16 v[72:75], a[160:163], a[240:243], v[176:179]
  v_exp_f32 v35, v83
  s_waitcnt lgkmcnt(1)
  v_mfma_f32_16x16x32_bf16 v[40:43], a[164:167], a[180:183], v[40:43]
  v_add_f32 v27, v27, v34
  v_mfma_f32_16x16x32_bf16 v[48:51], a[164:167], a[196:199], v[48:51]
  ds_read_b128 a[172:175], v13 offset:32768
  v_exp_f32 v32, v84
  v_mfma_f32_16x16x32_bf16 v[56:59], a[164:167], a[212:215], v[56:59]
  v_add_f32 v27, v27, v35
  v_cvt_pk_bf16_f32 v141, v34, v35
  v_mfma_f32_16x16x32_bf16 v[64:67], a[164:167], a[228:231], v[64:67]
  v_exp_f32 v33, v85
  v_mfma_f32_16x16x32_bf16 v[72:75], a[164:167], a[244:247], v[72:75]
  v_add_f32 v27, v27, v32
  s_waitcnt lgkmcnt(1)
  v_mfma_f32_16x16x32_bf16 v[40:43], a[168:171], a[184:187], v[40:43]
  v_exp_f32 v34, v86
  v_mfma_f32_16x16x32_bf16 v[48:51], a[168:171], a[200:203], v[48:51]
  ds_read_b128 a[160:163], v10 offset:36864
  v_add_f32 v27, v27, v33
  v_cvt_pk_bf16_f32 v142, v32, v33
  v_mfma_f32_16x16x32_bf16 v[56:59], a[168:171], a[216:219], v[56:59]
  v_exp_f32 v35, v87
  v_mfma_f32_16x16x32_bf16 v[64:67], a[168:171], a[232:235], v[64:67]
  s_waitcnt vmcnt(5)
  buffer_load_dwordx4 v6, s[28:31], s46 offen offset:2048 nt lds
  v_add_f32 v27, v27, v34
  v_mfma_f32_16x16x32_bf16 v[72:75], a[168:171], a[248:251], v[72:75]
  v_exp_f32 v32, v88
  s_waitcnt lgkmcnt(1)
  v_mfma_f32_16x16x32_bf16 v[40:43], a[172:175], a[188:191], v[40:43]
  v_add_f32 v27, v27, v35
  v_cvt_pk_bf16_f32 v143, v34, v35
  v_mfma_f32_16x16x32_bf16 v[48:51], a[172:175], a[204:207], v[48:51]
  ds_read_b128 a[164:167], v11 offset:36864
  v_exp_f32 v33, v89
  v_mfma_f32_16x16x32_bf16 v[56:59], a[172:175], a[220:223], v[56:59]
  v_exp_f32 v34, v90
  v_mfma_f32_16x16x32_bf16 v[64:67], a[172:175], a[236:239], v[64:67]
  v_add_f32 v28, v32, v33
  v_mfma_f32_16x16x32_bf16 v[72:75], a[172:175], a[252:255], v[72:75]
  v_cvt_pk_bf16_f32 v144, v32, v33
  v_exp_f32 v35, v91
  s_waitcnt lgkmcnt(1)
  v_mfma_f32_16x16x32_bf16 v[44:47], a[160:163], a[176:179], v[160:163]
  v_add_f32 v28, v28, v34
  v_mfma_f32_16x16x32_bf16 v[52:55], a[160:163], a[192:195], v[164:167]
  ds_read_b128 a[168:171], v12 offset:36864
  v_exp_f32 v32, v92
  v_mfma_f32_16x16x32_bf16 v[60:63], a[160:163], a[208:211], v[168:171]
  v_add_f32 v28, v28, v35
  v_mfma_f32_16x16x32_bf16 v[68:71], a[160:163], a[224:227], v[172:175]
  s_waitcnt vmcnt(5)
  buffer_load_dwordx4 v7, s[28:31], s46 offen offset:3072 nt lds
  v_cvt_pk_bf16_f32 v145, v34, v35
  v_exp_f32 v33, v93
  v_mfma_f32_16x16x32_bf16 v[76:79], a[160:163], a[240:243], v[176:179]
  v_add_f32 v28, v28, v32
  s_waitcnt lgkmcnt(1)
  v_mfma_f32_16x16x32_bf16 v[44:47], a[164:167], a[180:183], v[44:47]
  v_exp_f32 v34, v94
  v_mfma_f32_16x16x32_bf16 v[52:55], a[164:167], a[196:199], v[52:55]
  ds_read_b128 a[172:175], v13 offset:36864
  v_add_f32 v28, v28, v33
  v_mfma_f32_16x16x32_bf16 v[60:63], a[164:167], a[212:215], v[60:63]
  v_cvt_pk_bf16_f32 v146, v32, v33
  v_exp_f32 v35, v95
  v_mfma_f32_16x16x32_bf16 v[68:71], a[164:167], a[228:231], v[68:71]
  v_add_f32 v28, v28, v34
  v_mfma_f32_16x16x32_bf16 v[76:79], a[164:167], a[244:247], v[76:79]
  v_exp_f32 v32, v96
  s_waitcnt lgkmcnt(1)
  v_mfma_f32_16x16x32_bf16 v[44:47], a[168:171], a[184:187], v[44:47]
  v_add_f32 v28, v28, v35
  v_cvt_pk_bf16_f32 v147, v34, v35
  v_mfma_f32_16x16x32_bf16 v[52:55], a[168:171], a[200:203], v[52:55]
  ds_read_b64_tr_b16 a[160:161], v18
  v_exp_f32 v33, v97
  v_mfma_f32_16x16x32_bf16 v[60:63], a[168:171], a[216:219], v[60:63]
  s_add_u32 m0, s47, 98304
  s_add_u32 s46, s47, 163840
  s_waitcnt vmcnt(5)
  buffer_load_dwordx4 v8, s[32:35], s46 offen nt lds
  v_exp_f32 v34, v98
  v_mfma_f32_16x16x32_bf16 v[68:71], a[168:171], a[232:235], v[68:71]
  ds_read_b64_tr_b16 a[162:163], v18 offset:4096
  v_add_f32 v29, v32, v33
  v_mfma_f32_16x16x32_bf16 v[76:79], a[168:171], a[248:251], v[76:79]
  v_cvt_pk_bf16_f32 v148, v32, v33
  v_exp_f32 v35, v99
  s_waitcnt lgkmcnt(2)
  v_mfma_f32_16x16x32_bf16 v[44:47], a[172:175], a[188:191], v[44:47]
  v_mfma_f32_16x16x32_bf16 v[52:55], a[172:175], a[204:207], v[52:55]
  ds_read_b64_tr_b16 a[164:165], v19
  v_add_f32 v29, v29, v34
  v_exp_f32 v32, v100
  v_mfma_f32_16x16x32_bf16 v[60:63], a[172:175], a[220:223], v[60:63]
  v_add_f32 v29, v29, v35
  v_mfma_f32_16x16x32_bf16 v[68:71], a[172:175], a[236:239], v[68:71]
  ds_read_b64_tr_b16 a[166:167], v19 offset:4096
  v_cvt_pk_bf16_f32 v149, v34, v35
  v_exp_f32 v33, v101
  v_mfma_f32_16x16x32_bf16 v[76:79], a[172:175], a[252:255], v[76:79]
  v_add_f32 v29, v29, v32
  s_waitcnt lgkmcnt(2)
  v_mfma_f32_16x16x32_bf16 a[80:83], a[160:163], v[120:123], a[80:83]
  v_exp_f32 v34, v102
  v_mfma_f32_16x16x32_bf16 a[84:87], a[160:163], v[124:127], a[84:87]
  ds_read_b64_tr_b16 a[168:169], v20
  v_add_f32 v29, v29, v33
  v_mfma_f32_16x16x32_bf16 a[88:91], a[160:163], v[128:131], a[88:91]
  s_waitcnt vmcnt(5)
  buffer_load_dwordx4 v9, s[32:35], s46 offen offset:1024 nt lds
  v_cvt_pk_bf16_f32 v150, v32, v33
  v_exp_f32 v35, v103
  v_mfma_f32_16x16x32_bf16 a[92:95], a[160:163], v[132:135], a[92:95]
  ds_read_b64_tr_b16 a[170:171], v20 offset:4096
  v_add_f32 v29, v29, v34
  v_mfma_f32_16x16x32_bf16 a[96:99], a[160:163], v[136:139], a[96:99]
  v_exp_f32 v32, v104
  s_waitcnt lgkmcnt(2)
  v_mfma_f32_16x16x32_bf16 a[100:103], a[164:167], v[120:123], a[100:103]
  v_add_f32 v29, v29, v35
  v_mfma_f32_16x16x32_bf16 a[104:107], a[164:167], v[124:127], a[104:107]
  ds_read_b64_tr_b16 a[172:173], v21
  v_cvt_pk_bf16_f32 v151, v34, v35
  v_exp_f32 v33, v105
  v_mfma_f32_16x16x32_bf16 a[108:111], a[164:167], v[128:131], a[108:111]
  v_exp_f32 v34, v106
  v_mfma_f32_16x16x32_bf16 a[112:115], a[164:167], v[132:135], a[112:115]
  ds_read_b64_tr_b16 a[174:175], v21 offset:4096
  v_add_f32 v30, v32, v33
  v_mfma_f32_16x16x32_bf16 a[116:119], a[164:167], v[136:139], a[116:119]
  v_cvt_pk_bf16_f32 v152, v32, v33
  s_waitcnt lgkmcnt(2)
  v_mfma_f32_16x16x32_bf16 a[120:123], a[168:171], v[120:123], a[120:123]
  v_exp_f32 v35, v107
  v_mfma_f32_16x16x32_bf16 a[124:127], a[168:171], v[124:127], a[124:127]
  ds_read_b64_tr_b16 a[160:161], v14
  v_add_f32 v30, v30, v34
  v_exp_f32 v32, v108
  v_mfma_f32_16x16x32_bf16 a[128:131], a[168:171], v[128:131], a[128:131]
  s_waitcnt vmcnt(5)
  buffer_load_dwordx4 v8, s[32:35], s46 offen offset:2048 nt lds
  v_add_f32 v30, v30, v35
  v_mfma_f32_16x16x32_bf16 a[132:135], a[168:171], v[132:135], a[132:135]
  ds_read_b64_tr_b16 a[162:163], v14 offset:4096
  v_cvt_pk_bf16_f32 v153, v34, v35
  v_mfma_f32_16x16x32_bf16 a[136:139], a[168:171], v[136:139], a[136:139]
  v_exp_f32 v33, v109
  s_waitcnt lgkmcnt(2)
  v_mfma_f32_16x16x32_bf16 a[140:143], a[172:175], v[120:123], a[140:143]
  v_add_f32 v30, v30, v32
  v_exp_f32 v34, v110
  v_mfma_f32_16x16x32_bf16 a[144:147], a[172:175], v[124:127], a[144:147]
  ds_read_b64_tr_b16 a[164:165], v15
  v_add_f32 v30, v30, v33
  v_mfma_f32_16x16x32_bf16 a[148:151], a[172:175], v[128:131], a[148:151]
  v_cvt_pk_bf16_f32 v154, v32, v33
  v_exp_f32 v35, v111
  v_mfma_f32_16x16x32_bf16 a[152:155], a[172:175], v[132:135], a[152:155]
  ds_read_b64_tr_b16 a[166:167], v15 offset:4096
  v_mfma_f32_16x16x32_bf16 a[156:159], a[172:175], v[136:139], a[156:159]
  v_add_f32 v30, v30, v34
  v_exp_f32 v32, v112
  s_waitcnt lgkmcnt(2)
  v_mfma_f32_16x16x32_bf16 a[0:3], a[160:163], v[120:123], a[0:3]
  v_add_f32 v30, v30, v35
  v_mfma_f32_16x16x32_bf16 a[4:7], a[160:163], v[124:127], a[4:7]
  s_waitcnt vmcnt(5)
  buffer_load_dwordx4 v9, s[32:35], s46 offen offset:3072 nt lds
  ds_read_b64_tr_b16 a[168:169], v16
  v_cvt_pk_bf16_f32 v155, v34, v35
  v_exp_f32 v33, v113
  v_mfma_f32_16x16x32_bf16 a[8:11], a[160:163], v[128:131], a[8:11]
  v_mfma_f32_16x16x32_bf16 a[12:15], a[160:163], v[132:135], a[12:15]
  ds_read_b64_tr_b16 a[170:171], v16 offset:4096
  v_exp_f32 v34, v114
  v_mfma_f32_16x16x32_bf16 a[16:19], a[160:163], v[136:139], a[16:19]
  v_add_f32 v31, v32, v33
  v_cvt_pk_bf16_f32 v156, v32, v33
  s_waitcnt lgkmcnt(2)
  v_mfma_f32_16x16x32_bf16 a[20:23], a[164:167], v[120:123], a[20:23]
  v_exp_f32 v35, v115
  v_mfma_f32_16x16x32_bf16 a[24:27], a[164:167], v[124:127], a[24:27]
  ds_read_b64_tr_b16 a[172:173], v17
  v_add_f32 v31, v31, v34
  v_exp_f32 v32, v116
  v_mfma_f32_16x16x32_bf16 a[28:31], a[164:167], v[128:131], a[28:31]
  v_mfma_f32_16x16x32_bf16 a[32:35], a[164:167], v[132:135], a[32:35]
  ds_read_b64_tr_b16 a[174:175], v17 offset:4096
  v_add_f32 v31, v31, v35
  v_cvt_pk_bf16_f32 v157, v34, v35
  v_mfma_f32_16x16x32_bf16 a[36:39], a[164:167], v[136:139], a[36:39]
  v_exp_f32 v33, v117
  s_waitcnt lgkmcnt(2)
  v_mfma_f32_16x16x32_bf16 a[40:43], a[168:171], v[120:123], a[40:43]
  v_add_f32 v31, v31, v32
  v_exp_f32 v34, v118
  v_mfma_f32_16x16x32_bf16 a[44:47], a[168:171], v[124:127], a[44:47]
  s_waitcnt lgkmcnt(0)
  s_barrier
  ds_read_b128 a[160:163], v10 offset:49152
  v_mfma_f32_16x16x32_bf16 a[48:51], a[168:171], v[128:131], a[48:51]
  v_add_f32 v31, v31, v33
  v_cvt_pk_bf16_f32 v158, v32, v33
  v_mfma_f32_16x16x32_bf16 a[52:55], a[168:171], v[132:135], a[52:55]
  v_exp_f32 v35, v119
  v_mfma_f32_16x16x32_bf16 a[56:59], a[168:171], v[136:139], a[56:59]
  s_add_u32 m0, s47, 16384
  s_add_u32 s46, s47, 212992
  s_waitcnt vmcnt(5)
  buffer_load_dwordx4 v4, s[28:31], s46 offen nt lds
  v_add_f32 v31, v31, v34
  v_add_f32 v31, v31, v35
  v_mfma_f32_16x16x32_bf16 a[60:63], a[172:175], v[120:123], a[60:63]
  v_cvt_pk_bf16_f32 v159, v34, v35
  v_mfma_f32_16x16x32_bf16 a[64:67], a[172:175], v[124:127], a[64:67]
  ds_read_b128 a[164:167], v11 offset:49152
  v_max3_f32 v36, v27, v28, v29
  v_mfma_f32_16x16x32_bf16 a[68:71], a[172:175], v[128:131], a[68:71]
  v_max3_f32 v36, v36, v30, v31
  v_mfma_f32_16x16x32_bf16 a[72:75], a[172:175], v[132:135], a[72:75]
  v_cmp_nge_f32 vcc, s49, v36
  v_mfma_f32_16x16x32_bf16 a[76:79], a[172:175], v[136:139], a[76:79]
  s_cbranch_vccnz Lstub9
Lret9:
  v_add_f32 v22, v22, v27
  v_add_f32 v23, v23, v28
  v_add_f32 v24, v24, v29
  v_add_f32 v25, v25, v30
  v_add_f32 v26, v26, v31
  s_waitcnt lgkmcnt(1)
  v_mfma_f32_16x16x32_bf16 v[80:83], a[160:163], a[176:179], v[160:163]
  v_exp_f32 v32, v40
  s_mul_i32 s48, s42, 20480
  v_mfma_f32_16x16x32_bf16 v[88:91], a[160:163], a[192:195], v[164:167]
  ds_read_b128 a[168:171], v12 offset:49152
  v_exp_f32 v33, v41
  v_add_u32 v219, s48, v2
  v_mfma_f32_16x16x32_bf16 v[96:99], a[160:163], a[208:211], v[168:171]
  v_exp_f32 v34, v42
  s_mul_i32 s48, s42, 320
  v_mfma_f32_16x16x32_bf16 v[104:107], a[160:163], a[224:227], v[172:175]
  s_waitcnt vmcnt(5)
  buffer_load_dwordx4 v5, s[28:31], s46 offen offset:1024 nt lds
  v_add_f32 v27, v32, v33
  v_cvt_pk_bf16_f32 v120, v32, v33
  s_add_u32 s48, s48, 30720
  v_mfma_f32_16x16x32_bf16 v[112:115], a[160:163], a[240:243], v[176:179]
  v_exp_f32 v35, v43
  v_and_b32 v222, 15, v1
  s_waitcnt lgkmcnt(1)
  v_mfma_f32_16x16x32_bf16 v[80:83], a[164:167], a[180:183], v[80:83]
  v_add_f32 v27, v27, v34
  v_mfma_f32_16x16x32_bf16 v[88:91], a[164:167], a[196:199], v[88:91]
  ds_read_b128 a[172:175], v13 offset:49152
  v_exp_f32 v32, v44
  v_lshl_add_u32 v220, v222, 2, s48
  v_mfma_f32_16x16x32_bf16 v[96:99], a[164:167], a[212:215], v[96:99]
  v_add_f32 v27, v27, v35
  v_cvt_pk_bf16_f32 v121, v34, v35
  v_add_u32 v221, 100352, v220
  v_mfma_f32_16x16x32_bf16 v[104:107], a[164:167], a[228:231], v[104:107]
  v_exp_f32 v33, v45
  s_xor_b32 s50, s42, 2
  v_mfma_f32_16x16x32_bf16 v[112:115], a[164:167], a[244:247], v[112:115]
  v_add_f32 v27, v27, v32
  s_mul_i32 s48, s50, 320
  s_waitcnt lgkmcnt(1)
  v_mfma_f32_16x16x32_bf16 v[80:83], a[168:171], a[184:187], v[80:83]
  v_exp_f32 v34, v46
  v_mfma_f32_16x16x32_bf16 v[88:91], a[168:171], a[200:203], v[88:91]
  ds_read_b128 a[160:163], v10 offset:53248
  v_add_f32 v27, v27, v33
  v_cvt_pk_bf16_f32 v122, v32, v33
  s_add_u32 s48, s48, 30720
  v_mfma_f32_16x16x32_bf16 v[96:99], a[168:171], a[216:219], v[96:99]
  v_exp_f32 v35, v47
  v_lshl_add_u32 v222, v222, 2, s48
  v_mfma_f32_16x16x32_bf16 v[104:107], a[168:171], a[232:235], v[104:107]
  s_waitcnt vmcnt(5)
  buffer_load_dwordx4 v6, s[28:31], s46 offen offset:2048 nt lds
  v_add_f32 v27, v27, v34
  v_add_u32 v223, 100352, v222
  v_mfma_f32_16x16x32_bf16 v[112:115], a[168:171], a[248:251], v[112:115]
  v_exp_f32 v32, v48
  s_mul_i32 s48, s50, 20480
  s_waitcnt lgkmcnt(1)
  v_mfma_f32_16x16x32_bf16 v[80:83], a[172:175], a[188:191], v[80:83]
  v_add_f32 v27, v27, v35
  v_cvt_pk_bf16_f32 v123, v34, v35
  v_mfma_f32_16x16x32_bf16 v[88:91], a[172:175], a[204:207], v[88:91]
  ds_read_b128 a[164:167], v11 offset:53248
  v_exp_f32 v33, v49
  v_add_u32 v39, s48, v2
  v_mfma_f32_16x16x32_bf16 v[96:99], a[172:175], a[220:223], v[96:99]
  v_exp_f32 v34, v50
  s_lshl_b32 s48, s40, 5
  v_mfma_f32_16x16x32_bf16 v[104:107], a[172:175], a[236:239], v[104:107]
  v_add_f32 v28, v32, v33
  s_add_u32 s48, s48, s41
  v_mfma_f32_16x16x32_bf16 v[112:115], a[172:175], a[252:255], v[112:115]
  v_cvt_pk_bf16_f32 v124, v32, v33
  v_exp_f32 v35, v51
  s_lshl_b32 s48, s48, 1
  s_waitcnt lgkmcnt(1)
  v_mfma_f32_16x16x32_bf16 v[84:87], a[160:163], a[176:179], v[160:163]
  v_add_f32 v28, v28, v34
  s_add_u32 s48, s48, s59
  v_mfma_f32_16x16x32_bf16 v[92:95], a[160:163], a[192:195], v[164:167]
  ds_read_b128 a[168:171], v12 offset:53248
  v_exp_f32 v32, v52
  v_mfma_f32_16x16x32_bf16 v[100:103], a[160:163], a[208:211], v[168:171]
  v_add_f32 v28, v28, v35
  s_mul_i32 s48, s48, 20480
  v_mfma_f32_16x16x32_bf16 v[108:111], a[160:163], a[224:227], v[172:175]
  s_waitcnt vmcnt(5)
  buffer_load_dwordx4 v7, s[28:31], s46 offen offset:3072 nt lds
  v_cvt_pk_bf16_f32 v125, v34, v35
  v_exp_f32 v33, v53
  s_mul_i32 s50, s58, 5120
  v_mfma_f32_16x16x32_bf16 v[116:119], a[160:163], a[240:243], v[176:179]
  v_add_f32 v28, v28, v32
  s_add_u32 s44, s48, s50
  s_waitcnt lgkmcnt(1)
  v_mfma_f32_16x16x32_bf16 v[84:87], a[164:167], a[180:183], v[84:87]
  v_exp_f32 v34, v54
  s_add_u32 s45, s44, 10240
  v_mfma_f32_16x16x32_bf16 v[92:95], a[164:167], a[196:199], v[92:95]
  ds_read_b128 a[172:175], v13 offset:53248
  v_add_f32 v28, v28, v33
  v_mfma_f32_16x16x32_bf16 v[100:103], a[164:167], a[212:215], v[100:103]
  v_cvt_pk_bf16_f32 v126, v32, v33
  v_exp_f32 v35, v55
  s_lshl_b32 s48, s59, 12
  v_mfma_f32_16x16x32_bf16 v[108:111], a[164:167], a[228:231], v[108:111]
  v_add_f32 v28, v28, v34
  s_mul_i32 s51, s59, -2048
  v_mfma_f32_16x16x32_bf16 v[116:119], a[164:167], a[244:247], v[116:119]
  v_exp_f32 v32, v56
  s_add_u32 s51, s51, 1024
  s_waitcnt lgkmcnt(1)
  v_mfma_f32_16x16x32_bf16 v[84:87], a[168:171], a[184:187], v[84:87]
  v_add_f32 v28, v28, v35
  v_cvt_pk_bf16_f32 v127, v34, v35
  v_add_u32 v240, s48, v2
  v_mfma_f32_16x16x32_bf16 v[92:95], a[168:171], a[200:203], v[92:95]
  ds_read_b64_tr_b16 a[160:161], v18 offset:16384
  v_exp_f32 v33, v57
  v_mfma_f32_16x16x32_bf16 v[100:103], a[168:171], a[216:219], v[100:103]
  s_add_u32 m0, s47, 114688
  s_add_u32 s46, s47, 180224
  s_waitcnt vmcnt(5)
  buffer_load_dwordx4 v8, s[32:35], s46 offen nt lds
  v_exp_f32 v34, v58
  v_add_u32 v241, s51, v240
  v_mfma_f32_16x16x32_bf16 v[108:111], a[168:171], a[232:235], v[108:111]
  ds_read_b64_tr_b16 a[162:163], v18 offset:20480
  v_add_f32 v29, v32, v33
  v_add_u32 v242, s51, v241
  v_mfma_f32_16x16x32_bf16 v[116:119], a[168:171], a[248:251], v[116:119]
  v_cvt_pk_bf16_f32 v128, v32, v33
  v_exp_f32 v35, v59
  v_add_u32 v243, s51, v242
  s_waitcnt lgkmcnt(2)
  v_mfma_f32_16x16x32_bf16 v[84:87], a[172:175], a[188:191], v[84:87]
  v_add_u32 v244, s51, v243
  v_mfma_f32_16x16x32_bf16 v[92:95], a[172:175], a[204:207], v[92:95]
  ds_read_b64_tr_b16 a[164:165], v19 offset:16384
  v_add_f32 v29, v29, v34
  v_exp_f32 v32, v60
  v_mfma_f32_16x16x32_bf16 v[100:103], a[172:175], a[220:223], v[100:103]
  v_add_f32 v29, v29, v35
  v_lshrrev_b32 v230, 4, v1
  v_mfma_f32_16x16x32_bf16 v[108:111], a[172:175], a[236:239], v[108:111]
  ds_read_b64_tr_b16 a[166:167], v19 offset:20480
  v_cvt_pk_bf16_f32 v129, v34, v35
  v_exp_f32 v33, v61
  v_bfe_u32 v235, v1, 2, 2
  v_mfma_f32_16x16x32_bf16 v[116:119], a[172:175], a[252:255], v[116:119]
  v_add_f32 v29, v29, v32
  v_lshl_add_u32 v230, v230, 2, v235
  s_waitcnt lgkmcnt(2)
  v_mfma_f32_16x16x32_bf16 a[80:83], a[160:163], v[140:143], a[80:83]
  v_exp_f32 v34, v62
  v_mul_u32_u24 v230, 160, v230
  v_mfma_f32_16x16x32_bf16 a[84:87], a[160:163], v[144:147], a[84:87]
  ds_read_b64_tr_b16 a[168:169], v20 offset:16384
  v_add_f32 v29, v29, v33
  v_and_b32 v235, 3, v1
  v_mfma_f32_16x16x32_bf16 a[88:91], a[160:163], v[148:151], a[88:91]
  s_waitcnt vmcnt(5)
  buffer_load_dwordx4 v9, s[32:35], s46 offen offset:1024 nt lds
  v_cvt_pk_bf16_f32 v130, v32, v33
  v_exp_f32 v35, v63
  v_mfma_f32_16x16x32_bf16 a[92:95], a[160:163], v[152:155], a[92:95]
  ds_read_b64_tr_b16 a[170:171], v20 offset:20480
  v_add_f32 v29, v29, v34
  v_lshl_add_u32 v230, v235, 3, v230
  v_mfma_f32_16x16x32_bf16 a[96:99], a[160:163], v[156:159], a[96:99]
  v_exp_f32 v32, v64
  s_mul_i32 s48, s59, 133248
  s_waitcnt lgkmcnt(2)
  v_mfma_f32_16x16x32_bf16 a[100:103], a[164:167], v[140:143], a[100:103]
  v_add_f32 v29, v29, v35
  s_mul_i32 s50, s59, 51328
  v_mfma_f32_16x16x32_bf16 a[104:107], a[164:167], v[144:147], a[104:107]
  ds_read_b64_tr_b16 a[172:173], v21 offset:16384
  v_cvt_pk_bf16_f32 v131, v34, v35
  v_exp_f32 v33, v65
  s_add_u32 s50, s50, 30720
  v_mfma_f32_16x16x32_bf16 a[108:111], a[164:167], v[148:151], a[108:111]
  v_exp_f32 v34, v66
  v_mfma_f32_16x16x32_bf16 a[112:115], a[164:167], v[152:155], a[112:115]
  ds_read_b64_tr_b16 a[174:175], v21 offset:20480
  v_add_f32 v30, v32, v33
  s_mul_i32 s51, s59, -64
  v_mfma_f32_16x16x32_bf16 a[116:119], a[164:167], v[156:159], a[116:119]
  v_cvt_pk_bf16_f32 v132, v32, v33
  s_add_u32 s51, s51, 32
  s_waitcnt lgkmcnt(2)
  v_mfma_f32_16x16x32_bf16 a[120:123], a[168:171], v[140:143], a[120:123]
  v_exp_f32 v35, v67
  v_add_u32 v235, s50, v230
  v_mfma_f32_16x16x32_bf16 a[124:127], a[168:171], v[144:147], a[124:127]
  ds_read_b64_tr_b16 a[160:161], v14 offset:16384
  v_add_f32 v30, v30, v34
  v_exp_f32 v32, v68
  v_add_u32 v230, s48, v230
  v_mfma_f32_16x16x32_bf16 a[128:131], a[168:171], v[148:151], a[128:131]
  s_waitcnt vmcnt(5)
  buffer_load_dwordx4 v8, s[32:35], s46 offen offset:2048 nt lds
  v_add_f32 v30, v30, v35
  v_mfma_f32_16x16x32_bf16 a[132:135], a[168:171], v[152:155], a[132:135]
  ds_read_b64_tr_b16 a[162:163], v14 offset:20480
  v_cvt_pk_bf16_f32 v133, v34, v35
  v_add_u32 v231, s51, v230
  v_mfma_f32_16x16x32_bf16 a[136:139], a[168:171], v[156:159], a[136:139]
  v_exp_f32 v33, v69
  v_add_u32 v236, s51, v235
  s_waitcnt lgkmcnt(2)
  v_mfma_f32_16x16x32_bf16 a[140:143], a[172:175], v[140:143], a[140:143]
  v_add_f32 v30, v30, v32
  v_exp_f32 v34, v70
  v_add_u32 v232, s51, v231
  v_mfma_f32_16x16x32_bf16 a[144:147], a[172:175], v[144:147], a[144:147]
  ds_read_b64_tr_b16 a[164:165], v15 offset:16384
  v_add_f32 v30, v30, v33
  v_add_u32 v237, s51, v236
  v_mfma_f32_16x16x32_bf16 a[148:151], a[172:175], v[148:151], a[148:151]
  v_cvt_pk_bf16_f32 v134, v32, v33
  v_exp_f32 v35, v71
  v_add_u32 v233, s51, v232
  v_mfma_f32_16x16x32_bf16 a[152:155], a[172:175], v[152:155], a[152:155]
  ds_read_b64_tr_b16 a[166:167], v15 offset:20480
  v_mfma_f32_16x16x32_bf16 a[156:159], a[172:175], v[156:159], a[156:159]
  v_add_f32 v30, v30, v34
  v_exp_f32 v32, v72
  v_add_u32 v238, s51, v237
  s_waitcnt lgkmcnt(2)
  v_mfma_f32_16x16x32_bf16 a[0:3], a[160:163], v[140:143], a[0:3]
  v_add_f32 v30, v30, v35
  v_add_u32 v234, s51, v233
  v_mfma_f32_16x16x32_bf16 a[4:7], a[160:163], v[144:147], a[4:7]
  s_waitcnt vmcnt(5)
  buffer_load_dwordx4 v9, s[32:35], s46 offen offset:3072 nt lds
  ds_read_b64_tr_b16 a[168:169], v16 offset:16384
  v_cvt_pk_bf16_f32 v135, v34, v35
  v_exp_f32 v33, v73
  v_add_u32 v239, s51, v238
  v_mfma_f32_16x16x32_bf16 a[8:11], a[160:163], v[148:151], a[8:11]
  s_lshl_b32 s48, s40, 5
  v_mfma_f32_16x16x32_bf16 a[12:15], a[160:163], v[152:155], a[12:15]
  ds_read_b64_tr_b16 a[170:171], v16 offset:20480
  v_exp_f32 v34, v74
  v_mfma_f32_16x16x32_bf16 a[16:19], a[160:163], v[156:159], a[16:19]
  v_add_f32 v31, v32, v33
  v_cvt_pk_bf16_f32 v136, v32, v33
  s_lshl_b32 s50, s93, 3
  s_waitcnt lgkmcnt(2)
  v_mfma_f32_16x16x32_bf16 a[20:23], a[164:167], v[140:143], a[20:23]
  v_exp_f32 v35, v75
  s_add_u32 s48, s48, s50
  v_mfma_f32_16x16x32_bf16 a[24:27], a[164:167], v[144:147], a[24:27]
  ds_read_b64_tr_b16 a[172:173], v17 offset:16384
  v_add_f32 v31, v31, v34
  v_exp_f32 v32, v76
  s_lshl_b32 s48, s48, 7
  v_mfma_f32_16x16x32_bf16 a[28:31], a[164:167], v[148:151], a[28:31]
  s_add_u32 s11, s48, 29360128
  v_mfma_f32_16x16x32_bf16 a[32:35], a[164:167], v[152:155], a[32:35]
  ds_read_b64_tr_b16 a[174:175], v17 offset:20480
  v_add_f32 v31, v31, v35
  v_cvt_pk_bf16_f32 v137, v34, v35
  v_mfma_f32_16x16x32_bf16 a[36:39], a[164:167], v[156:159], a[36:39]
  v_exp_f32 v33, v77
  v_and_b32 v255, 7, v1
  s_waitcnt lgkmcnt(2)
  v_mfma_f32_16x16x32_bf16 a[40:43], a[168:171], v[140:143], a[40:43]
  v_add_f32 v31, v31, v32
  v_exp_f32 v34, v78
  v_max_u32 v255, 1, v255
  v_mfma_f32_16x16x32_bf16 a[44:47], a[168:171], v[144:147], a[44:47]
  s_waitcnt lgkmcnt(0)
  s_barrier
  ds_read_b128 a[160:163], v10
  v_xor_b32 v255, s92, v255
  v_mfma_f32_16x16x32_bf16 a[48:51], a[168:171], v[148:151], a[48:51]
  v_add_f32 v31, v31, v33
  v_cvt_pk_bf16_f32 v138, v32, v33
  v_lshlrev_b32 v255, 7, v255
  v_mfma_f32_16x16x32_bf16 a[52:55], a[168:171], v[152:155], a[52:55]
  v_exp_f32 v35, v79
  v_mfma_f32_16x16x32_bf16 a[56:59], a[168:171], v[156:159], a[56:59]
  s_add_u32 m0, s47, 32768
  s_add_u32 s46, s47, 229376
  s_waitcnt vmcnt(5)
  buffer_load_dwordx4 v4, s[28:31], s46 offen nt lds
  v_add_f32 v31, v31, v34
  v_add_f32 v31, v31, v35
  v_mfma_f32_16x16x32_bf16 a[60:63], a[172:175], v[140:143], a[60:63]
  v_cvt_pk_bf16_f32 v139, v34, v35
  v_mfma_f32_16x16x32_bf16 a[64:67], a[172:175], v[144:147], a[64:67]
  ds_read_b128 a[164:167], v11
  v_max3_f32 v36, v27, v28, v29
  v_mfma_f32_16x16x32_bf16 a[68:71], a[172:175], v[148:151], a[68:71]
  v_max3_f32 v36, v36, v30, v31
  v_mfma_f32_16x16x32_bf16 a[72:75], a[172:175], v[152:155], a[72:75]
  v_cmp_nge_f32 vcc, s49, v36
  v_mfma_f32_16x16x32_bf16 a[76:79], a[172:175], v[156:159], a[76:79]
  s_cbranch_vccnz Lstub10
Lret10:
  v_add_f32 v22, v22, v27
  v_add_f32 v23, v23, v28
  v_add_f32 v24, v24, v29
  v_add_f32 v25, v25, v30
  v_add_f32 v26, v26, v31
  s_waitcnt lgkmcnt(1)
  v_mfma_f32_16x16x32_bf16 v[40:43], a[160:163], a[176:179], v[160:163]
  v_exp_f32 v32, v80
  v_mfma_f32_16x16x32_bf16 v[48:51], a[160:163], a[192:195], v[164:167]
  ds_read_b128 a[168:171], v12
  v_exp_f32 v33, v81
  v_mfma_f32_16x16x32_bf16 v[56:59], a[160:163], a[208:211], v[168:171]
  v_exp_f32 v34, v82
  v_mfma_f32_16x16x32_bf16 v[64:67], a[160:163], a[224:227], v[172:175]
  s_waitcnt vmcnt(5)
  buffer_load_dwordx4 v5, s[28:31], s46 offen offset:1024 nt lds
  v_add_f32 v27, v32, v33
  v_cvt_pk_bf16_f32 v140, v32, v33
  v_mfma_f32_16x16x32_bf16 v[72:75], a[160:163], a[240:243], v[176:179]
  v_exp_f32 v35, v83
  s_waitcnt lgkmcnt(1)
  v_mfma_f32_16x16x32_bf16 v[40:43], a[164:167], a[180:183], v[40:43]
  v_add_f32 v27, v27, v34
  v_mfma_f32_16x16x32_bf16 v[48:51], a[164:167], a[196:199], v[48:51]
  ds_read_b128 a[172:175], v13
  v_exp_f32 v32, v84
  v_mfma_f32_16x16x32_bf16 v[56:59], a[164:167], a[212:215], v[56:59]
  v_add_f32 v27, v27, v35
  v_cvt_pk_bf16_f32 v141, v34, v35
  v_mfma_f32_16x16x32_bf16 v[64:67], a[164:167], a[228:231], v[64:67]
  v_exp_f32 v33, v85
  v_mfma_f32_16x16x32_bf16 v[72:75], a[164:167], a[244:247], v[72:75]
  v_add_f32 v27, v27, v32
  s_waitcnt lgkmcnt(1)
  v_mfma_f32_16x16x32_bf16 v[40:43], a[168:171], a[184:187], v[40:43]
  v_exp_f32 v34, v86
  v_mfma_f32_16x16x32_bf16 v[48:51], a[168:171], a[200:203], v[48:51]
  ds_read_b128 a[160:163], v10 offset:4096
  v_add_f32 v27, v27, v33
  v_cvt_pk_bf16_f32 v142, v32, v33
  v_mfma_f32_16x16x32_bf16 v[56:59], a[168:171], a[216:219], v[56:59]
  v_exp_f32 v35, v87
  v_mfma_f32_16x16x32_bf16 v[64:67], a[168:171], a[232:235], v[64:67]
  s_waitcnt vmcnt(5)
  buffer_load_dwordx4 v6, s[28:31], s46 offen offset:2048 nt lds
  v_add_f32 v27, v27, v34
  v_mfma_f32_16x16x32_bf16 v[72:75], a[168:171], a[248:251], v[72:75]
  v_exp_f32 v32, v88
  s_waitcnt lgkmcnt(1)
  v_mfma_f32_16x16x32_bf16 v[40:43], a[172:175], a[188:191], v[40:43]
  v_add_f32 v27, v27, v35
  v_cvt_pk_bf16_f32 v143, v34, v35
  v_mfma_f32_16x16x32_bf16 v[48:51], a[172:175], a[204:207], v[48:51]
  ds_read_b128 a[164:167], v11 offset:4096
  v_exp_f32 v33, v89
  v_mfma_f32_16x16x32_bf16 v[56:59], a[172:175], a[220:223], v[56:59]
  v_exp_f32 v34, v90
  v_mfma_f32_16x16x32_bf16 v[64:67], a[172:175], a[236:239], v[64:67]
  v_add_f32 v28, v32, v33
  v_mfma_f32_16x16x32_bf16 v[72:75], a[172:175], a[252:255], v[72:75]
  v_cvt_pk_bf16_f32 v144, v32, v33
  v_exp_f32 v35, v91
  s_waitcnt lgkmcnt(1)
  v_mfma_f32_16x16x32_bf16 v[44:47], a[160:163], a[176:179], v[160:163]
  v_add_f32 v28, v28, v34
  v_mfma_f32_16x16x32_bf16 v[52:55], a[160:163], a[192:195], v[164:167]
  ds_read_b128 a[168:171], v12 offset:4096
  v_exp_f32 v32, v92
  v_mfma_f32_16x16x32_bf16 v[60:63], a[160:163], a[208:211], v[168:171]
  v_add_f32 v28, v28, v35
  v_mfma_f32_16x16x32_bf16 v[68:71], a[160:163], a[224:227], v[172:175]
  s_waitcnt vmcnt(5)
  buffer_load_dwordx4 v7, s[28:31], s46 offen offset:3072 nt lds
  v_cvt_pk_bf16_f32 v145, v34, v35
  v_exp_f32 v33, v93
  v_mfma_f32_16x16x32_bf16 v[76:79], a[160:163], a[240:243], v[176:179]
  v_add_f32 v28, v28, v32
  s_waitcnt lgkmcnt(1)
  v_mfma_f32_16x16x32_bf16 v[44:47], a[164:167], a[180:183], v[44:47]
  v_exp_f32 v34, v94
  v_mfma_f32_16x16x32_bf16 v[52:55], a[164:167], a[196:199], v[52:55]
  ds_read_b128 a[172:175], v13 offset:4096
  v_add_f32 v28, v28, v33
  v_mfma_f32_16x16x32_bf16 v[60:63], a[164:167], a[212:215], v[60:63]
  v_cvt_pk_bf16_f32 v146, v32, v33
  v_exp_f32 v35, v95
  v_mfma_f32_16x16x32_bf16 v[68:71], a[164:167], a[228:231], v[68:71]
  v_add_f32 v28, v28, v34
  v_mfma_f32_16x16x32_bf16 v[76:79], a[164:167], a[244:247], v[76:79]
  v_exp_f32 v32, v96
  s_waitcnt lgkmcnt(1)
  v_mfma_f32_16x16x32_bf16 v[44:47], a[168:171], a[184:187], v[44:47]
  v_add_f32 v28, v28, v35
  v_cvt_pk_bf16_f32 v147, v34, v35
  v_mfma_f32_16x16x32_bf16 v[52:55], a[168:171], a[200:203], v[52:55]
  ds_read_b64_tr_b16 a[160:161], v18 offset:32768
  v_exp_f32 v33, v97
  v_mfma_f32_16x16x32_bf16 v[60:63], a[168:171], a[216:219], v[60:63]
  s_add_u32 m0, s47, 65536
  s_add_u32 s46, s47, 196608
  s_waitcnt vmcnt(5)
  buffer_load_dwordx4 v8, s[32:35], s46 offen nt lds
  v_exp_f32 v34, v98
  v_mfma_f32_16x16x32_bf16 v[68:71], a[168:171], a[232:235], v[68:71]
  ds_read_b64_tr_b16 a[162:163], v18 offset:36864
  v_add_f32 v29, v32, v33
  v_mfma_f32_16x16x32_bf16 v[76:79], a[168:171], a[248:251], v[76:79]
  v_cvt_pk_bf16_f32 v148, v32, v33
  v_exp_f32 v35, v99
  s_waitcnt lgkmcnt(2)
  v_mfma_f32_16x16x32_bf16 v[44:47], a[172:175], a[188:191], v[44:47]
  v_mfma_f32_16x16x32_bf16 v[52:55], a[172:175], a[204:207], v[52:55]
  ds_read_b64_tr_b16 a[164:165], v19 offset:32768
  v_add_f32 v29, v29, v34
  v_exp_f32 v32, v100
  v_mfma_f32_16x16x32_bf16 v[60:63], a[172:175], a[220:223], v[60:63]
  v_add_f32 v29, v29, v35
  v_mfma_f32_16x16x32_bf16 v[68:71], a[172:175], a[236:239], v[68:71]
  ds_read_b64_tr_b16 a[166:167], v19 offset:36864
  v_cvt_pk_bf16_f32 v149, v34, v35
  v_exp_f32 v33, v101
  v_mfma_f32_16x16x32_bf16 v[76:79], a[172:175], a[252:255], v[76:79]
  v_add_f32 v29, v29, v32
  s_waitcnt lgkmcnt(2)
  v_mfma_f32_16x16x32_bf16 a[80:83], a[160:163], v[120:123], a[80:83]
  v_exp_f32 v34, v102
  v_mfma_f32_16x16x32_bf16 a[84:87], a[160:163], v[124:127], a[84:87]
  ds_read_b64_tr_b16 a[168:169], v20 offset:32768
  v_add_f32 v29, v29, v33
  v_mfma_f32_16x16x32_bf16 a[88:91], a[160:163], v[128:131], a[88:91]
  s_waitcnt vmcnt(5)
  buffer_load_dwordx4 v9, s[32:35], s46 offen offset:1024 nt lds
  v_cvt_pk_bf16_f32 v150, v32, v33
  v_exp_f32 v35, v103
  v_mfma_f32_16x16x32_bf16 a[92:95], a[160:163], v[132:135], a[92:95]
  ds_read_b64_tr_b16 a[170:171], v20 offset:36864
  v_add_f32 v29, v29, v34
  v_mfma_f32_16x16x32_bf16 a[96:99], a[160:163], v[136:139], a[96:99]
  v_exp_f32 v32, v104
  s_waitcnt lgkmcnt(2)
  v_mfma_f32_16x16x32_bf16 a[100:103], a[164:167], v[120:123], a[100:103]
  v_add_f32 v29, v29, v35
  v_mfma_f32_16x16x32_bf16 a[104:107], a[164:167], v[124:127], a[104:107]
  ds_read_b64_tr_b16 a[172:173], v21 offset:32768
  v_cvt_pk_bf16_f32 v151, v34, v35
  v_exp_f32 v33, v105
  v_mfma_f32_16x16x32_bf16 a[108:111], a[164:167], v[128:131], a[108:111]
  v_exp_f32 v34, v106
  v_mfma_f32_16x16x32_bf16 a[112:115], a[164:167], v[132:135], a[112:115]
  ds_read_b64_tr_b16 a[174:175], v21 offset:36864
  v_add_f32 v30, v32, v33
  v_mfma_f32_16x16x32_bf16 a[116:119], a[164:167], v[136:139], a[116:119]
  v_cvt_pk_bf16_f32 v152, v32, v33
  s_waitcnt lgkmcnt(2)
  v_mfma_f32_16x16x32_bf16 a[120:123], a[168:171], v[120:123], a[120:123]
  v_exp_f32 v35, v107
  v_mfma_f32_16x16x32_bf16 a[124:127], a[168:171], v[124:127], a[124:127]
  ds_read_b64_tr_b16 a[160:161], v14 offset:32768
  v_add_f32 v30, v30, v34
  v_exp_f32 v32, v108
  v_mfma_f32_16x16x32_bf16 a[128:131], a[168:171], v[128:131], a[128:131]
  s_waitcnt vmcnt(5)
  buffer_load_dwordx4 v8, s[32:35], s46 offen offset:2048 nt lds
  v_add_f32 v30, v30, v35
  v_mfma_f32_16x16x32_bf16 a[132:135], a[168:171], v[132:135], a[132:135]
  ds_read_b64_tr_b16 a[162:163], v14 offset:36864
  v_cvt_pk_bf16_f32 v153, v34, v35
  v_mfma_f32_16x16x32_bf16 a[136:139], a[168:171], v[136:139], a[136:139]
  v_exp_f32 v33, v109
  s_waitcnt lgkmcnt(2)
  v_mfma_f32_16x16x32_bf16 a[140:143], a[172:175], v[120:123], a[140:143]
  v_add_f32 v30, v30, v32
  v_exp_f32 v34, v110
  v_mfma_f32_16x16x32_bf16 a[144:147], a[172:175], v[124:127], a[144:147]
  ds_read_b64_tr_b16 a[164:165], v15 offset:32768
  v_add_f32 v30, v30, v33
  v_mfma_f32_16x16x32_bf16 a[148:151], a[172:175], v[128:131], a[148:151]
  v_cvt_pk_bf16_f32 v154, v32, v33
  v_exp_f32 v35, v111
  v_mfma_f32_16x16x32_bf16 a[152:155], a[172:175], v[132:135], a[152:155]
  ds_read_b64_tr_b16 a[166:167], v15 offset:36864
  v_mfma_f32_16x16x32_bf16 a[156:159], a[172:175], v[136:139], a[156:159]
  v_add_f32 v30, v30, v34
  v_exp_f32 v32, v112
  s_waitcnt lgkmcnt(2)
  v_mfma_f32_16x16x32_bf16 a[0:3], a[160:163], v[120:123], a[0:3]
  v_add_f32 v30, v30, v35
  v_mfma_f32_16x16x32_bf16 a[4:7], a[160:163], v[124:127], a[4:7]
  s_waitcnt vmcnt(5)
  buffer_load_dwordx4 v9, s[32:35], s46 offen offset:3072 nt lds
  ds_read_b64_tr_b16 a[168:169], v16 offset:32768
  v_cvt_pk_bf16_f32 v155, v34, v35
  v_exp_f32 v33, v113
  v_mfma_f32_16x16x32_bf16 a[8:11], a[160:163], v[128:131], a[8:11]
  v_mfma_f32_16x16x32_bf16 a[12:15], a[160:163], v[132:135], a[12:15]
  ds_read_b64_tr_b16 a[170:171], v16 offset:36864
  v_exp_f32 v34, v114
  v_mfma_f32_16x16x32_bf16 a[16:19], a[160:163], v[136:139], a[16:19]
  v_add_f32 v31, v32, v33
  v_cvt_pk_bf16_f32 v156, v32, v33
  s_waitcnt lgkmcnt(2)
  v_mfma_f32_16x16x32_bf16 a[20:23], a[164:167], v[120:123], a[20:23]
  v_exp_f32 v35, v115
  v_mfma_f32_16x16x32_bf16 a[24:27], a[164:167], v[124:127], a[24:27]
  ds_read_b64_tr_b16 a[172:173], v17 offset:32768
  v_add_f32 v31, v31, v34
  v_exp_f32 v32, v116
  v_mfma_f32_16x16x32_bf16 a[28:31], a[164:167], v[128:131], a[28:31]
  v_mfma_f32_16x16x32_bf16 a[32:35], a[164:167], v[132:135], a[32:35]
  ds_read_b64_tr_b16 a[174:175], v17 offset:36864
  v_add_f32 v31, v31, v35
  v_cvt_pk_bf16_f32 v157, v34, v35
  v_mfma_f32_16x16x32_bf16 a[36:39], a[164:167], v[136:139], a[36:39]
  v_exp_f32 v33, v117
  s_waitcnt lgkmcnt(2)
  v_mfma_f32_16x16x32_bf16 a[40:43], a[168:171], v[120:123], a[40:43]
  v_add_f32 v31, v31, v32
  v_exp_f32 v34, v118
  v_mfma_f32_16x16x32_bf16 a[44:47], a[168:171], v[124:127], a[44:47]
  s_waitcnt lgkmcnt(0)
  s_barrier
  ds_read_b128 a[160:163], v10 offset:16384
  v_mfma_f32_16x16x32_bf16 a[48:51], a[168:171], v[128:131], a[48:51]
  v_add_f32 v31, v31, v33
  v_cvt_pk_bf16_f32 v158, v32, v33
  v_mfma_f32_16x16x32_bf16 a[52:55], a[168:171], v[132:135], a[52:55]
  v_exp_f32 v35, v119
  v_mfma_f32_16x16x32_bf16 a[56:59], a[168:171], v[136:139], a[56:59]
  s_add_u32 m0, s47, 49152
  s_add_u32 s46, s47, 245760
  s_waitcnt vmcnt(4)
  buffer_load_dwordx4 v4, s[28:31], s46 offen nt lds
  v_add_f32 v31, v31, v34
  v_add_f32 v31, v31, v35
  v_mfma_f32_16x16x32_bf16 a[60:63], a[172:175], v[120:123], a[60:63]
  v_cvt_pk_bf16_f32 v159, v34, v35
  v_mfma_f32_16x16x32_bf16 a[64:67], a[172:175], v[124:127], a[64:67]
  ds_read_b128 a[164:167], v11 offset:16384
  v_max3_f32 v36, v27, v28, v29
  v_mfma_f32_16x16x32_bf16 a[68:71], a[172:175], v[128:131], a[68:71]
  v_max3_f32 v36, v36, v30, v31
  v_mfma_f32_16x16x32_bf16 a[72:75], a[172:175], v[132:135], a[72:75]
  v_cmp_nge_f32 vcc, s49, v36
  v_mfma_f32_16x16x32_bf16 a[76:79], a[172:175], v[136:139], a[76:79]
  s_cbranch_vccnz Lstub11
Lret11:
  v_add_f32 v22, v22, v27
  v_add_f32 v23, v23, v28
  v_add_f32 v24, v24, v29
  v_add_f32 v25, v25, v30
  v_add_f32 v26, v26, v31
  s_waitcnt lgkmcnt(1)
  v_mfma_f32_16x16x32_bf16 v[80:83], a[160:163], a[176:179], v[160:163]
  v_exp_f32 v32, v40
  v_mfma_f32_16x16x32_bf16 v[88:91], a[160:163], a[192:195], v[164:167]
  ds_read_b128 a[168:171], v12 offset:16384
  v_exp_f32 v33, v41
  v_mfma_f32_16x16x32_bf16 v[96:99], a[160:163], a[208:211], v[168:171]
  s_waitcnt vmcnt(4)
  buffer_load_dwordx4 v5, s[28:31], s46 offen offset:1024 nt lds
  v_exp_f32 v34, v42
  v_mfma_f32_16x16x32_bf16 v[104:107], a[160:163], a[224:227], v[172:175]
  v_add_f32 v27, v32, v33
  v_cvt_pk_bf16_f32 v120, v32, v33
  v_mfma_f32_16x16x32_bf16 v[112:115], a[160:163], a[240:243], v[176:179]
  v_exp_f32 v35, v43
  s_waitcnt lgkmcnt(1)
  v_mfma_f32_16x16x32_bf16 v[80:83], a[164:167], a[180:183], v[80:83]
  v_add_f32 v27, v27, v34
  v_mfma_f32_16x16x32_bf16 v[88:91], a[164:167], a[196:199], v[88:91]
  ds_read_b128 a[172:175], v13 offset:16384
  v_exp_f32 v32, v44
  v_mfma_f32_16x16x32_bf16 v[96:99], a[164:167], a[212:215], v[96:99]
  v_add_f32 v27, v27, v35
  v_cvt_pk_bf16_f32 v121, v34, v35
  v_mfma_f32_16x16x32_bf16 v[104:107], a[164:167], a[228:231], v[104:107]
  v_exp_f32 v33, v45
  v_mfma_f32_16x16x32_bf16 v[112:115], a[164:167], a[244:247], v[112:115]
  v_add_f32 v27, v27, v32
  s_waitcnt lgkmcnt(1)
  v_mfma_f32_16x16x32_bf16 v[80:83], a[168:171], a[184:187], v[80:83]
  v_exp_f32 v34, v46
  v_mfma_f32_16x16x32_bf16 v[88:91], a[168:171], a[200:203], v[88:91]
  s_waitcnt vmcnt(4)
  buffer_load_dwordx4 v6, s[28:31], s46 offen offset:2048 nt lds
  ds_read_b128 a[160:163], v10 offset:20480
  v_add_f32 v27, v27, v33
  v_cvt_pk_bf16_f32 v122, v32, v33
  v_mfma_f32_16x16x32_bf16 v[96:99], a[168:171], a[216:219], v[96:99]
  v_exp_f32 v35, v47
  v_mfma_f32_16x16x32_bf16 v[104:107], a[168:171], a[232:235], v[104:107]
  v_add_f32 v27, v27, v34
  v_mfma_f32_16x16x32_bf16 v[112:115], a[168:171], a[248:251], v[112:115]
  v_exp_f32 v32, v48
  s_waitcnt lgkmcnt(1)
  v_mfma_f32_16x16x32_bf16 v[80:83], a[172:175], a[188:191], v[80:83]
  v_add_f32 v27, v27, v35
  v_cvt_pk_bf16_f32 v123, v34, v35
  v_mfma_f32_16x16x32_bf16 v[88:91], a[172:175], a[204:207], v[88:91]
  ds_read_b128 a[164:167], v11 offset:20480
  v_exp_f32 v33, v49
  v_mfma_f32_16x16x32_bf16 v[96:99], a[172:175], a[220:223], v[96:99]
  v_exp_f32 v34, v50
  v_mfma_f32_16x16x32_bf16 v[104:107], a[172:175], a[236:239], v[104:107]
  v_add_f32 v28, v32, v33
  v_mfma_f32_16x16x32_bf16 v[112:115], a[172:175], a[252:255], v[112:115]
  v_cvt_pk_bf16_f32 v124, v32, v33
  v_exp_f32 v35, v51
  s_waitcnt lgkmcnt(1)
  v_mfma_f32_16x16x32_bf16 v[84:87], a[160:163], a[176:179], v[160:163]
  s_waitcnt vmcnt(4)
  buffer_load_dwordx4 v7, s[28:31], s46 offen offset:3072 nt lds
  v_add_f32 v28, v28, v34
  v_mfma_f32_16x16x32_bf16 v[92:95], a[160:163], a[192:195], v[164:167]
  ds_read_b128 a[168:171], v12 offset:20480
  v_exp_f32 v32, v52
  v_mfma_f32_16x16x32_bf16 v[100:103], a[160:163], a[208:211], v[168:171]
  v_add_f32 v28, v28, v35
  v_mfma_f32_16x16x32_bf16 v[108:111], a[160:163], a[224:227], v[172:175]
  v_cvt_pk_bf16_f32 v125, v34, v35
  v_exp_f32 v33, v53
  v_mfma_f32_16x16x32_bf16 v[116:119], a[160:163], a[240:243], v[176:179]
  v_add_f32 v28, v28, v32
  s_waitcnt lgkmcnt(1)
  v_mfma_f32_16x16x32_bf16 v[84:87], a[164:167], a[180:183], v[84:87]
  v_exp_f32 v34, v54
  v_mfma_f32_16x16x32_bf16 v[92:95], a[164:167], a[196:199], v[92:95]
  ds_read_b128 a[172:175], v13 offset:20480
  v_add_f32 v28, v28, v33
  v_mfma_f32_16x16x32_bf16 v[100:103], a[164:167], a[212:215], v[100:103]
  v_cvt_pk_bf16_f32 v126, v32, v33
  v_exp_f32 v35, v55
  v_mfma_f32_16x16x32_bf16 v[108:111], a[164:167], a[228:231], v[108:111]
  v_add_f32 v28, v28, v34
  v_mfma_f32_16x16x32_bf16 v[116:119], a[164:167], a[244:247], v[116:119]
  s_add_u32 m0, s47, 81920
  s_add_u32 s46, s47, 212992
  s_waitcnt vmcnt(4)
  buffer_load_dwordx4 v8, s[32:35], s46 offen nt lds
  v_exp_f32 v32, v56
  s_waitcnt lgkmcnt(1)
  v_mfma_f32_16x16x32_bf16 v[84:87], a[168:171], a[184:187], v[84:87]
  v_add_f32 v28, v28, v35
  v_cvt_pk_bf16_f32 v127, v34, v35
  v_mfma_f32_16x16x32_bf16 v[92:95], a[168:171], a[200:203], v[92:95]
  ds_read_b64_tr_b16 a[160:161], v18 offset:49152
  v_exp_f32 v33, v57
  v_mfma_f32_16x16x32_bf16 v[100:103], a[168:171], a[216:219], v[100:103]
  v_exp_f32 v34, v58
  v_mfma_f32_16x16x32_bf16 v[108:111], a[168:171], a[232:235], v[108:111]
  ds_read_b64_tr_b16 a[162:163], v18 offset:53248
  v_add_f32 v29, v32, v33
  v_mfma_f32_16x16x32_bf16 v[116:119], a[168:171], a[248:251], v[116:119]
  v_cvt_pk_bf16_f32 v128, v32, v33
  v_exp_f32 v35, v59
  s_waitcnt lgkmcnt(2)
  v_mfma_f32_16x16x32_bf16 v[84:87], a[172:175], a[188:191], v[84:87]
  v_mfma_f32_16x16x32_bf16 v[92:95], a[172:175], a[204:207], v[92:95]
  ds_read_b64_tr_b16 a[164:165], v19 offset:49152
  v_add_f32 v29, v29, v34
  v_exp_f32 v32, v60
  v_mfma_f32_16x16x32_bf16 v[100:103], a[172:175], a[220:223], v[100:103]
  v_add_f32 v29, v29, v35
  v_mfma_f32_16x16x32_bf16 v[108:111], a[172:175], a[236:239], v[108:111]
  s_waitcnt vmcnt(4)
  buffer_load_dwordx4 v9, s[32:35], s46 offen offset:1024 nt lds
  ds_read_b64_tr_b16 a[166:167], v19 offset:53248
  v_cvt_pk_bf16_f32 v129, v34, v35
  v_exp_f32 v33, v61
  v_mfma_f32_16x16x32_bf16 v[116:119], a[172:175], a[252:255], v[116:119]
  v_add_f32 v29, v29, v32
  s_waitcnt lgkmcnt(2)
  v_mfma_f32_16x16x32_bf16 a[80:83], a[160:163], v[140:143], a[80:83]
  v_exp_f32 v34, v62
  v_mfma_f32_16x16x32_bf16 a[84:87], a[160:163], v[144:147], a[84:87]
  ds_read_b64_tr_b16 a[168:169], v20 offset:49152
  v_add_f32 v29, v29, v33
  v_mfma_f32_16x16x32_bf16 a[88:91], a[160:163], v[148:151], a[88:91]
  v_cvt_pk_bf16_f32 v130, v32, v33
  v_exp_f32 v35, v63
  v_mfma_f32_16x16x32_bf16 a[92:95], a[160:163], v[152:155], a[92:95]
  ds_read_b64_tr_b16 a[170:171], v20 offset:53248
  v_add_f32 v29, v29, v34
  v_mfma_f32_16x16x32_bf16 a[96:99], a[160:163], v[156:159], a[96:99]
  v_exp_f32 v32, v64
  s_waitcnt lgkmcnt(2)
  v_mfma_f32_16x16x32_bf16 a[100:103], a[164:167], v[140:143], a[100:103]
  v_add_f32 v29, v29, v35
  v_mfma_f32_16x16x32_bf16 a[104:107], a[164:167], v[144:147], a[104:107]
  ds_read_b64_tr_b16 a[172:173], v21 offset:49152
  v_cvt_pk_bf16_f32 v131, v34, v35
  v_exp_f32 v33, v65
  v_mfma_f32_16x16x32_bf16 a[108:111], a[164:167], v[148:151], a[108:111]
  s_waitcnt vmcnt(4)
  buffer_load_dwordx4 v8, s[32:35], s46 offen offset:2048 nt lds
  v_exp_f32 v34, v66
  v_mfma_f32_16x16x32_bf16 a[112:115], a[164:167], v[152:155], a[112:115]
  ds_read_b64_tr_b16 a[174:175], v21 offset:53248
  v_add_f32 v30, v32, v33
  v_mfma_f32_16x16x32_bf16 a[116:119], a[164:167], v[156:159], a[116:119]
  v_cvt_pk_bf16_f32 v132, v32, v33
  s_waitcnt lgkmcnt(2)
  v_mfma_f32_16x16x32_bf16 a[120:123], a[168:171], v[140:143], a[120:123]
  v_exp_f32 v35, v67
  v_mfma_f32_16x16x32_bf16 a[124:127], a[168:171], v[144:147], a[124:127]
  ds_read_b64_tr_b16 a[160:161], v14 offset:49152
  v_add_f32 v30, v30, v34
  v_exp_f32 v32, v68
  v_mfma_f32_16x16x32_bf16 a[128:131], a[168:171], v[148:151], a[128:131]
  v_add_f32 v30, v30, v35
  v_mfma_f32_16x16x32_bf16 a[132:135], a[168:171], v[152:155], a[132:135]
  ds_read_b64_tr_b16 a[162:163], v14 offset:53248
  v_cvt_pk_bf16_f32 v133, v34, v35
  v_mfma_f32_16x16x32_bf16 a[136:139], a[168:171], v[156:159], a[136:139]
  v_exp_f32 v33, v69
  s_waitcnt lgkmcnt(2)
  v_mfma_f32_16x16x32_bf16 a[140:143], a[172:175], v[140:143], a[140:143]
  v_add_f32 v30, v30, v32
  v_exp_f32 v34, v70
  v_mfma_f32_16x16x32_bf16 a[144:147], a[172:175], v[144:147], a[144:147]
  s_waitcnt vmcnt(4)
  buffer_load_dwordx4 v9, s[32:35], s46 offen offset:3072 nt lds
  ds_read_b64_tr_b16 a[164:165], v15 offset:49152
  v_add_f32 v30, v30, v33
  v_mfma_f32_16x16x32_bf16 a[148:151], a[172:175], v[148:151], a[148:151]
  v_cvt_pk_bf16_f32 v134, v32, v33
  v_exp_f32 v35, v71
  v_mfma_f32_16x16x32_bf16 a[152:155], a[172:175], v[152:155], a[152:155]
  ds_read_b64_tr_b16 a[166:167], v15 offset:53248
  v_mfma_f32_16x16x32_bf16 a[156:159], a[172:175], v[156:159], a[156:159]
  v_add_f32 v30, v30, v34
  v_exp_f32 v32, v72
  s_waitcnt lgkmcnt(2)
  v_mfma_f32_16x16x32_bf16 a[0:3], a[160:163], v[140:143], a[0:3]
  v_add_f32 v30, v30, v35
  v_mfma_f32_16x16x32_bf16 a[4:7], a[160:163], v[144:147], a[4:7]
  ds_read_b64_tr_b16 a[168:169], v16 offset:49152
  v_cvt_pk_bf16_f32 v135, v34, v35
  v_exp_f32 v33, v73
  v_mfma_f32_16x16x32_bf16 a[8:11], a[160:163], v[148:151], a[8:11]
  v_mfma_f32_16x16x32_bf16 a[12:15], a[160:163], v[152:155], a[12:15]
  ds_read_b64_tr_b16 a[170:171], v16 offset:53248
  v_exp_f32 v34, v74
  v_mfma_f32_16x16x32_bf16 a[16:19], a[160:163], v[156:159], a[16:19]
  v_add_f32 v31, v32, v33
  v_cvt_pk_bf16_f32 v136, v32, v33
  s_waitcnt lgkmcnt(2)
  v_mfma_f32_16x16x32_bf16 a[20:23], a[164:167], v[140:143], a[20:23]
  v_mov_b32 v254, 0
  s_lshl_b32 s48, s40, 2
  buffer_load_dword v229, v254, s[84:87], s48 offen sc1
  v_exp_f32 v35, v75
  v_mfma_f32_16x16x32_bf16 a[24:27], a[164:167], v[144:147], a[24:27]
  ds_read_b64_tr_b16 a[172:173], v17 offset:49152
  v_add_f32 v31, v31, v34
  v_exp_f32 v32, v76
  v_mfma_f32_16x16x32_bf16 a[28:31], a[164:167], v[148:151], a[28:31]
  v_mfma_f32_16x16x32_bf16 a[32:35], a[164:167], v[152:155], a[32:35]
  ds_read_b64_tr_b16 a[174:175], v17 offset:53248
  v_add_f32 v31, v31, v35
  v_cvt_pk_bf16_f32 v137, v34, v35
  v_mfma_f32_16x16x32_bf16 a[36:39], a[164:167], v[156:159], a[36:39]
  v_exp_f32 v33, v77
  s_waitcnt lgkmcnt(2)
  v_mfma_f32_16x16x32_bf16 a[40:43], a[168:171], v[140:143], a[40:43]
  v_add_f32 v31, v31, v32
  v_exp_f32 v34, v78
  v_mfma_f32_16x16x32_bf16 a[44:47], a[168:171], v[144:147], a[44:47]
  s_waitcnt lgkmcnt(0)
  s_barrier
  ds_read_b128 a[160:163], v10 offset:32768
  v_mfma_f32_16x16x32_bf16 a[48:51], a[168:171], v[148:151], a[48:51]
  v_add_f32 v31, v31, v33
  v_cvt_pk_bf16_f32 v138, v32, v33
  v_mfma_f32_16x16x32_bf16 a[52:55], a[168:171], v[152:155], a[52:55]
  v_exp_f32 v35, v79
  v_mfma_f32_16x16x32_bf16 a[56:59], a[168:171], v[156:159], a[56:59]
  s_add_u32 m0, s47, 98304
  s_add_u32 s46, s47, 229376
  s_waitcnt vmcnt(4)
  buffer_load_dwordx4 v8, s[32:35], s46 offen nt lds
  v_add_f32 v31, v31, v34
  v_add_f32 v31, v31, v35
  v_mfma_f32_16x16x32_bf16 a[60:63], a[172:175], v[140:143], a[60:63]
  v_cvt_pk_bf16_f32 v139, v34, v35
  v_mfma_f32_16x16x32_bf16 a[64:67], a[172:175], v[144:147], a[64:67]
  ds_read_b128 a[164:167], v11 offset:32768
  v_max3_f32 v36, v27, v28, v29
  v_mfma_f32_16x16x32_bf16 a[68:71], a[172:175], v[148:151], a[68:71]
  v_max3_f32 v36, v36, v30, v31
  v_mfma_f32_16x16x32_bf16 a[72:75], a[172:175], v[152:155], a[72:75]
  v_cmp_nge_f32 vcc, s49, v36
  v_mfma_f32_16x16x32_bf16 a[76:79], a[172:175], v[156:159], a[76:79]
  s_cbranch_vccnz Lstub12
Lret12:
  v_add_f32 v22, v22, v27
  v_add_f32 v23, v23, v28
  v_add_f32 v24, v24, v29
  v_add_f32 v25, v25, v30
  v_add_f32 v26, v26, v31
  s_waitcnt lgkmcnt(1)
  v_mfma_f32_16x16x32_bf16 v[40:43], a[160:163], a[176:179], v[160:163]
  v_exp_f32 v32, v80
  v_mfma_f32_16x16x32_bf16 v[48:51], a[160:163], a[192:195], v[164:167]
  ds_read_b128 a[168:171], v12 offset:32768
  v_exp_f32 v33, v81
  v_mfma_f32_16x16x32_bf16 v[56:59], a[160:163], a[208:211], v[168:171]
  s_waitcnt vmcnt(4)
  buffer_load_dwordx4 v9, s[32:35], s46 offen offset:1024 nt lds
  v_exp_f32 v34, v82
  v_mfma_f32_16x16x32_bf16 v[64:67], a[160:163], a[224:227], v[172:175]
  v_add_f32 v27, v32, v33
  v_cvt_pk_bf16_f32 v140, v32, v33
  v_mfma_f32_16x16x32_bf16 v[72:75], a[160:163], a[240:243], v[176:179]
  v_exp_f32 v35, v83
  s_waitcnt lgkmcnt(1)
  v_mfma_f32_16x16x32_bf16 v[40:43], a[164:167], a[180:183], v[40:43]
  v_add_f32 v27, v27, v34
  v_mfma_f32_16x16x32_bf16 v[48:51], a[164:167], a[196:199], v[48:51]
  ds_read_b128 a[172:175], v13 offset:32768
  v_exp_f32 v32, v84
  v_mfma_f32_16x16x32_bf16 v[56:59], a[164:167], a[212:215], v[56:59]
  v_add_f32 v27, v27, v35
  v_cvt_pk_bf16_f32 v141, v34, v35
  v_mfma_f32_16x16x32_bf16 v[64:67], a[164:167], a[228:231], v[64:67]
  v_exp_f32 v33, v85
  v_mfma_f32_16x16x32_bf16 v[72:75], a[164:167], a[244:247], v[72:75]
  v_add_f32 v27, v27, v32
  s_waitcnt lgkmcnt(1)
  v_mfma_f32_16x16x32_bf16 v[40:43], a[168:171], a[184:187], v[40:43]
  s_waitcnt vmcnt(4)
  buffer_load_dwordx4 v8, s[32:35], s46 offen offset:2048 nt lds
  v_exp_f32 v34, v86
  v_mfma_f32_16x16x32_bf16 v[48:51], a[168:171], a[200:203], v[48:51]
  ds_read_b128 a[160:163], v10 offset:36864
  v_add_f32 v27, v27, v33
  v_cvt_pk_bf16_f32 v142, v32, v33
  v_mfma_f32_16x16x32_bf16 v[56:59], a[168:171], a[216:219], v[56:59]
  v_exp_f32 v35, v87
  v_mfma_f32_16x16x32_bf16 v[64:67], a[168:171], a[232:235], v[64:67]
  v_add_f32 v27, v27, v34
  v_mfma_f32_16x16x32_bf16 v[72:75], a[168:171], a[248:251], v[72:75]
  v_exp_f32 v32, v88
  s_waitcnt lgkmcnt(1)
  v_mfma_f32_16x16x32_bf16 v[40:43], a[172:175], a[188:191], v[40:43]
  v_add_f32 v27, v27, v35
  v_cvt_pk_bf16_f32 v143, v34, v35
  v_mfma_f32_16x16x32_bf16 v[48:51], a[172:175], a[204:207], v[48:51]
  ds_read_b128 a[164:167], v11 offset:36864
  v_exp_f32 v33, v89
  v_mfma_f32_16x16x32_bf16 v[56:59], a[172:175], a[220:223], v[56:59]
  v_exp_f32 v34, v90
  v_mfma_f32_16x16x32_bf16 v[64:67], a[172:175], a[236:239], v[64:67]
  s_waitcnt vmcnt(4)
  buffer_load_dwordx4 v9, s[32:35], s46 offen offset:3072 nt lds
  v_add_f32 v28, v32, v33
  v_mfma_f32_16x16x32_bf16 v[72:75], a[172:175], a[252:255], v[72:75]
  v_cvt_pk_bf16_f32 v144, v32, v33
  v_exp_f32 v35, v91
  s_waitcnt lgkmcnt(1)
  v_mfma_f32_16x16x32_bf16 v[44:47], a[160:163], a[176:179], v[160:163]
  v_add_f32 v28, v28, v34
  v_mfma_f32_16x16x32_bf16 v[52:55], a[160:163], a[192:195], v[164:167]
  ds_read_b128 a[168:171], v12 offset:36864
  v_exp_f32 v32, v92
  v_mfma_f32_16x16x32_bf16 v[60:63], a[160:163], a[208:211], v[168:171]
  v_add_f32 v28, v28, v35
  v_mfma_f32_16x16x32_bf16 v[68:71], a[160:163], a[224:227], v[172:175]
  v_cvt_pk_bf16_f32 v145, v34, v35
  v_exp_f32 v33, v93
  v_mfma_f32_16x16x32_bf16 v[76:79], a[160:163], a[240:243], v[176:179]
  v_add_f32 v28, v28, v32
  s_waitcnt lgkmcnt(1)
  v_mfma_f32_16x16x32_bf16 v[44:47], a[164:167], a[180:183], v[44:47]
  v_exp_f32 v34, v94
  v_mfma_f32_16x16x32_bf16 v[52:55], a[164:167], a[196:199], v[52:55]
  ds_read_b128 a[172:175], v13 offset:36864
  v_add_f32 v28, v28, v33
  v_mfma_f32_16x16x32_bf16 v[60:63], a[164:167], a[212:215], v[60:63]
  v_cvt_pk_bf16_f32 v146, v32, v33
  v_exp_f32 v35, v95
  v_mfma_f32_16x16x32_bf16 v[68:71], a[164:167], a[228:231], v[68:71]
  v_add_f32 v28, v28, v34
  v_mfma_f32_16x16x32_bf16 v[76:79], a[164:167], a[244:247], v[76:79]
  v_exp_f32 v32, v96
  s_waitcnt lgkmcnt(1)
  v_mfma_f32_16x16x32_bf16 v[44:47], a[168:171], a[184:187], v[44:47]
  v_add_f32 v28, v28, v35
  v_cvt_pk_bf16_f32 v147, v34, v35
  v_mfma_f32_16x16x32_bf16 v[52:55], a[168:171], a[200:203], v[52:55]
  ds_read_b64_tr_b16 a[160:161], v18
  v_exp_f32 v33, v97
  v_mfma_f32_16x16x32_bf16 v[60:63], a[168:171], a[216:219], v[60:63]
  v_exp_f32 v34, v98
  v_mfma_f32_16x16x32_bf16 v[68:71], a[168:171], a[232:235], v[68:71]
  ds_read_b64_tr_b16 a[162:163], v18 offset:4096
  v_add_f32 v29, v32, v33
  v_mfma_f32_16x16x32_bf16 v[76:79], a[168:171], a[248:251], v[76:79]
  v_cvt_pk_bf16_f32 v148, v32, v33
  v_exp_f32 v35, v99
  s_waitcnt lgkmcnt(2)
  v_mfma_f32_16x16x32_bf16 v[44:47], a[172:175], a[188:191], v[44:47]
  v_mfma_f32_16x16x32_bf16 v[52:55], a[172:175], a[204:207], v[52:55]
  ds_read_b64_tr_b16 a[164:165], v19
  v_add_f32 v29, v29, v34
  v_exp_f32 v32, v100
  v_mfma_f32_16x16x32_bf16 v[60:63], a[172:175], a[220:223], v[60:63]
  v_add_f32 v29, v29, v35
  v_mfma_f32_16x16x32_bf16 v[68:71], a[172:175], a[236:239], v[68:71]
  ds_read_b64_tr_b16 a[166:167], v19 offset:4096
  v_cvt_pk_bf16_f32 v149, v34, v35
  v_exp_f32 v33, v101
  v_mfma_f32_16x16x32_bf16 v[76:79], a[172:175], a[252:255], v[76:79]
  v_add_f32 v29, v29, v32
  s_waitcnt lgkmcnt(2)
  v_mfma_f32_16x16x32_bf16 a[80:83], a[160:163], v[120:123], a[80:83]
  v_exp_f32 v34, v102
  v_mfma_f32_16x16x32_bf16 a[84:87], a[160:163], v[124:127], a[84:87]
  ds_read_b64_tr_b16 a[168:169], v20
  v_add_f32 v29, v29, v33
  v_mfma_f32_16x16x32_bf16 a[88:91], a[160:163], v[128:131], a[88:91]
  v_cvt_pk_bf16_f32 v150, v32, v33
  v_exp_f32 v35, v103
  v_mfma_f32_16x16x32_bf16 a[92:95], a[160:163], v[132:135], a[92:95]
  ds_read_b64_tr_b16 a[170:171], v20 offset:4096
  v_add_f32 v29, v29, v34
  v_mfma_f32_16x16x32_bf16 a[96:99], a[160:163], v[136:139], a[96:99]
  v_exp_f32 v32, v104
  s_waitcnt lgkmcnt(2)
  v_mfma_f32_16x16x32_bf16 a[100:103], a[164:167], v[120:123], a[100:103]
  v_add_f32 v29, v29, v35
  v_mfma_f32_16x16x32_bf16 a[104:107], a[164:167], v[124:127], a[104:107]
  ds_read_b64_tr_b16 a[172:173], v21
  v_cvt_pk_bf16_f32 v151, v34, v35
  v_exp_f32 v33, v105
  v_mfma_f32_16x16x32_bf16 a[108:111], a[164:167], v[128:131], a[108:111]
  v_exp_f32 v34, v106
  v_mfma_f32_16x16x32_bf16 a[112:115], a[164:167], v[132:135], a[112:115]
  ds_read_b64_tr_b16 a[174:175], v21 offset:4096
  v_add_f32 v30, v32, v33
  v_mfma_f32_16x16x32_bf16 a[116:119], a[164:167], v[136:139], a[116:119]
  v_cvt_pk_bf16_f32 v152, v32, v33
  s_waitcnt lgkmcnt(2)
  v_mfma_f32_16x16x32_bf16 a[120:123], a[168:171], v[120:123], a[120:123]
  v_exp_f32 v35, v107
  v_mfma_f32_16x16x32_bf16 a[124:127], a[168:171], v[124:127], a[124:127]
  ds_read_b64_tr_b16 a[160:161], v14
  v_add_f32 v30, v30, v34
  v_exp_f32 v32, v108
  v_mfma_f32_16x16x32_bf16 a[128:131], a[168:171], v[128:131], a[128:131]
  v_add_f32 v30, v30, v35
  v_mfma_f32_16x16x32_bf16 a[132:135], a[168:171], v[132:135], a[132:135]
  ds_read_b64_tr_b16 a[162:163], v14 offset:4096
  v_cvt_pk_bf16_f32 v153, v34, v35
  v_mfma_f32_16x16x32_bf16 a[136:139], a[168:171], v[136:139], a[136:139]
  v_exp_f32 v33, v109
  s_waitcnt lgkmcnt(2)
  v_mfma_f32_16x16x32_bf16 a[140:143], a[172:175], v[120:123], a[140:143]
  v_add_f32 v30, v30, v32
  v_exp_f32 v34, v110
  v_mfma_f32_16x16x32_bf16 a[144:147], a[172:175], v[124:127], a[144:147]
  ds_read_b64_tr_b16 a[164:165], v15
  v_add_f32 v30, v30, v33
  v_mfma_f32_16x16x32_bf16 a[148:151], a[172:175], v[128:131], a[148:151]
  v_cvt_pk_bf16_f32 v154, v32, v33
  v_exp_f32 v35, v111
  v_mfma_f32_16x16x32_bf16 a[152:155], a[172:175], v[132:135], a[152:155]
  ds_read_b64_tr_b16 a[166:167], v15 offset:4096
  v_mfma_f32_16x16x32_bf16 a[156:159], a[172:175], v[136:139], a[156:159]
  v_add_f32 v30, v30, v34
  v_exp_f32 v32, v112
  s_waitcnt lgkmcnt(2)
  v_mfma_f32_16x16x32_bf16 a[0:3], a[160:163], v[120:123], a[0:3]
  v_add_f32 v30, v30, v35
  v_mfma_f32_16x16x32_bf16 a[4:7], a[160:163], v[124:127], a[4:7]
  ds_read_b64_tr_b16 a[168:169], v16
  v_cvt_pk_bf16_f32 v155, v34, v35
  v_exp_f32 v33, v113
  v_mfma_f32_16x16x32_bf16 a[8:11], a[160:163], v[128:131], a[8:11]
  v_mfma_f32_16x16x32_bf16 a[12:15], a[160:163], v[132:135], a[12:15]
  ds_read_b64_tr_b16 a[170:171], v16 offset:4096
  v_exp_f32 v34, v114
  v_mfma_f32_16x16x32_bf16 a[16:19], a[160:163], v[136:139], a[16:19]
  v_add_f32 v31, v32, v33
  v_cvt_pk_bf16_f32 v156, v32, v33
  s_waitcnt lgkmcnt(2)
  v_mfma_f32_16x16x32_bf16 a[20:23], a[164:167], v[120:123], a[20:23]
  v_exp_f32 v35, v115
  v_mfma_f32_16x16x32_bf16 a[24:27], a[164:167], v[124:127], a[24:27]
  ds_read_b64_tr_b16 a[172:173], v17
  v_add_f32 v31, v31, v34
  v_exp_f32 v32, v116
  v_mfma_f32_16x16x32_bf16 a[28:31], a[164:167], v[128:131], a[28:31]
  v_mfma_f32_16x16x32_bf16 a[32:35], a[164:167], v[132:135], a[32:35]
  ds_read_b64_tr_b16 a[174:175], v17 offset:4096
  v_add_f32 v31, v31, v35
  v_cvt_pk_bf16_f32 v157, v34, v35
  v_mfma_f32_16x16x32_bf16 a[36:39], a[164:167], v[136:139], a[36:39]
  v_exp_f32 v33, v117
  s_waitcnt lgkmcnt(2)
  v_mfma_f32_16x16x32_bf16 a[40:43], a[168:171], v[120:123], a[40:43]
  v_add_f32 v31, v31, v32
  v_exp_f32 v34, v118
  v_mfma_f32_16x16x32_bf16 a[44:47], a[168:171], v[124:127], a[44:47]
  s_waitcnt lgkmcnt(0)
  s_barrier
  ds_read_b128 a[160:163], v10 offset:49152
  v_mfma_f32_16x16x32_bf16 a[48:51], a[168:171], v[128:131], a[48:51]
  v_add_f32 v31, v31, v33
  v_cvt_pk_bf16_f32 v158, v32, v33
  v_mfma_f32_16x16x32_bf16 a[52:55], a[168:171], v[132:135], a[52:55]
  v_exp_f32 v35, v119
  v_mfma_f32_16x16x32_bf16 a[56:59], a[168:171], v[136:139], a[56:59]
  s_add_u32 m0, s47, 114688
  s_add_u32 s46, s47, 245760
  s_waitcnt vmcnt(4)
  buffer_load_dwordx4 v8, s[32:35], s46 offen nt lds
  v_add_f32 v31, v31, v34
  v_add_f32 v31, v31, v35
  v_mfma_f32_16x16x32_bf16 a[60:63], a[172:175], v[120:123], a[60:63]
  v_cvt_pk_bf16_f32 v159, v34, v35
  v_mfma_f32_16x16x32_bf16 a[64:67], a[172:175], v[124:127], a[64:67]
  ds_read_b128 a[164:167], v11 offset:49152
  v_max3_f32 v36, v27, v28, v29
  v_mfma_f32_16x16x32_bf16 a[68:71], a[172:175], v[128:131], a[68:71]
  v_max3_f32 v36, v36, v30, v31
  v_mfma_f32_16x16x32_bf16 a[72:75], a[172:175], v[132:135], a[72:75]
  v_cmp_nge_f32 vcc, s49, v36
  v_mfma_f32_16x16x32_bf16 a[76:79], a[172:175], v[136:139], a[76:79]
  s_cbranch_vccnz Lstub13
Lret13:
  v_add_f32 v22, v22, v27
  v_add_f32 v23, v23, v28
  v_add_f32 v24, v24, v29
  v_add_f32 v25, v25, v30
  v_add_f32 v26, v26, v31
  s_waitcnt lgkmcnt(1)
  v_mfma_f32_16x16x32_bf16 v[80:83], a[160:163], a[176:179], v[160:163]
  v_exp_f32 v32, v40
  v_mfma_f32_16x16x32_bf16 v[88:91], a[160:163], a[192:195], v[164:167]
  ds_read_b128 a[168:171], v12 offset:49152
  v_exp_f32 v33, v41
  v_mfma_f32_16x16x32_bf16 v[96:99], a[160:163], a[208:211], v[168:171]
  s_waitcnt vmcnt(4)
  buffer_load_dwordx4 v9, s[32:35], s46 offen offset:1024 nt lds
  v_exp_f32 v34, v42
  v_mfma_f32_16x16x32_bf16 v[104:107], a[160:163], a[224:227], v[172:175]
  v_add_f32 v27, v32, v33
  v_cvt_pk_bf16_f32 v120, v32, v33
  v_mfma_f32_16x16x32_bf16 v[112:115], a[160:163], a[240:243], v[176:179]
  v_exp_f32 v35, v43
  s_waitcnt lgkmcnt(1)
  v_mfma_f32_16x16x32_bf16 v[80:83], a[164:167], a[180:183], v[80:83]
  v_add_f32 v27, v27, v34
  v_mfma_f32_16x16x32_bf16 v[88:91], a[164:167], a[196:199], v[88:91]
  ds_read_b128 a[172:175], v13 offset:49152
  v_exp_f32 v32, v44
  v_mfma_f32_16x16x32_bf16 v[96:99], a[164:167], a[212:215], v[96:99]
  v_add_f32 v27, v27, v35
  v_cvt_pk_bf16_f32 v121, v34, v35
  v_mfma_f32_16x16x32_bf16 v[104:107], a[164:167], a[228:231], v[104:107]
  v_exp_f32 v33, v45
  v_mfma_f32_16x16x32_bf16 v[112:115], a[164:167], a[244:247], v[112:115]
  v_add_f32 v27, v27, v32
  s_waitcnt lgkmcnt(1)
  v_mfma_f32_16x16x32_bf16 v[80:83], a[168:171], a[184:187], v[80:83]
  s_waitcnt vmcnt(4)
  buffer_load_dwordx4 v8, s[32:35], s46 offen offset:2048 nt lds
  v_exp_f32 v34, v46
  v_mfma_f32_16x16x32_bf16 v[88:91], a[168:171], a[200:203], v[88:91]
  ds_read_b128 a[160:163], v10 offset:53248
  v_add_f32 v27, v27, v33
  v_cvt_pk_bf16_f32 v122, v32, v33
  v_mfma_f32_16x16x32_bf16 v[96:99], a[168:171], a[216:219], v[96:99]
  v_exp_f32 v35, v47
  v_mfma_f32_16x16x32_bf16 v[104:107], a[168:171], a[232:235], v[104:107]
  v_add_f32 v27, v27, v34
  v_mfma_f32_16x16x32_bf16 v[112:115], a[168:171], a[248:251], v[112:115]
  v_exp_f32 v32, v48
  s_waitcnt lgkmcnt(1)
  v_mfma_f32_16x16x32_bf16 v[80:83], a[172:175], a[188:191], v[80:83]
  v_add_f32 v27, v27, v35
  v_cvt_pk_bf16_f32 v123, v34, v35
  v_mfma_f32_16x16x32_bf16 v[88:91], a[172:175], a[204:207], v[88:91]
  ds_read_b128 a[164:167], v11 offset:53248
  v_exp_f32 v33, v49
  v_mfma_f32_16x16x32_bf16 v[96:99], a[172:175], a[220:223], v[96:99]
  v_exp_f32 v34, v50
  v_mfma_f32_16x16x32_bf16 v[104:107], a[172:175], a[236:239], v[104:107]
  s_waitcnt vmcnt(4)
  buffer_load_dwordx4 v9, s[32:35], s46 offen offset:3072 nt lds
  v_add_f32 v28, v32, v33
  v_mfma_f32_16x16x32_bf16 v[112:115], a[172:175], a[252:255], v[112:115]
  v_cvt_pk_bf16_f32 v124, v32, v33
  v_exp_f32 v35, v51
  s_waitcnt lgkmcnt(1)
  v_mfma_f32_16x16x32_bf16 v[84:87], a[160:163], a[176:179], v[160:163]
  v_add_f32 v28, v28, v34
  v_mfma_f32_16x16x32_bf16 v[92:95], a[160:163], a[192:195], v[164:167]
  ds_read_b128 a[168:171], v12 offset:53248
  v_exp_f32 v32, v52
  v_mfma_f32_16x16x32_bf16 v[100:103], a[160:163], a[208:211], v[168:171]
  v_add_f32 v28, v28, v35
  v_mfma_f32_16x16x32_bf16 v[108:111], a[160:163], a[224:227], v[172:175]
  v_cvt_pk_bf16_f32 v125, v34, v35
  v_exp_f32 v33, v53
  v_mfma_f32_16x16x32_bf16 v[116:119], a[160:163], a[240:243], v[176:179]
  v_add_f32 v28, v28, v32
  s_waitcnt lgkmcnt(1)
  v_mfma_f32_16x16x32_bf16 v[84:87], a[164:167], a[180:183], v[84:87]
  v_exp_f32 v34, v54
  v_mfma_f32_16x16x32_bf16 v[92:95], a[164:167], a[196:199], v[92:95]
  s_and_b32 s48, s40, 3
  s_lshl_b32 s48, s48, 3
  s_add_u32 s48, s48, s92
  s_lshl_b32 s50, s93, 5
  s_add_u32 s48, s48, s50
  s_lshl_b32 s48, s48, 2
  s_add_u32 s48, s48, s42
  s_mul_i32 s48, s48, 10240
  s_mul_i32 s50, s92, 160
  s_sub_u32 s48, s48, s50
  s_max_i32 s10, s48, 0
  v_min_u32 v246, 9, v1
  v_lshlrev_b32 v246, 7, v246
  buffer_load_dword v250, v246, s[80:83], s10 offen
  ds_read_b128 a[172:175], v13 offset:53248
  v_add_f32 v28, v28, v33
  v_mfma_f32_16x16x32_bf16 v[100:103], a[164:167], a[212:215], v[100:103]
  v_cvt_pk_bf16_f32 v126, v32, v33
  v_exp_f32 v35, v55
  v_mfma_f32_16x16x32_bf16 v[108:111], a[164:167], a[228:231], v[108:111]
  v_add_f32 v28, v28, v34
  v_mfma_f32_16x16x32_bf16 v[116:119], a[164:167], a[244:247], v[116:119]
  v_exp_f32 v32, v56
  s_waitcnt lgkmcnt(1)
  v_mfma_f32_16x16x32_bf16 v[84:87], a[168:171], a[184:187], v[84:87]
  v_add_f32 v28, v28, v35
  v_cvt_pk_bf16_f32 v127, v34, v35
  v_mfma_f32_16x16x32_bf16 v[92:95], a[168:171], a[200:203], v[92:95]
  ds_read_b64_tr_b16 a[160:161], v18 offset:16384
  v_exp_f32 v33, v57
  v_mfma_f32_16x16x32_bf16 v[100:103], a[168:171], a[216:219], v[100:103]
  v_exp_f32 v34, v58
  v_mfma_f32_16x16x32_bf16 v[108:111], a[168:171], a[232:235], v[108:111]
  ds_read_b64_tr_b16 a[162:163], v18 offset:20480
  v_add_f32 v29, v32, v33
  v_mfma_f32_16x16x32_bf16 v[116:119], a[168:171], a[248:251], v[116:119]
  s_add_u32 s10, s10, 1280
  s_waitcnt vmcnt(5)
  buffer_load_dword v251, v246, s[80:83], s10 offen
  v_cvt_pk_bf16_f32 v128, v32, v33
  v_exp_f32 v35, v59
  s_waitcnt lgkmcnt(2)
  v_mfma_f32_16x16x32_bf16 v[84:87], a[172:175], a[188:191], v[84:87]
  v_mfma_f32_16x16x32_bf16 v[92:95], a[172:175], a[204:207], v[92:95]
  ds_read_b64_tr_b16 a[164:165], v19 offset:16384
  v_add_f32 v29, v29, v34
  v_exp_f32 v32, v60
  v_mfma_f32_16x16x32_bf16 v[100:103], a[172:175], a[220:223], v[100:103]
  v_add_f32 v29, v29, v35
  v_mfma_f32_16x16x32_bf16 v[108:111], a[172:175], a[236:239], v[108:111]
  ds_read_b64_tr_b16 a[166:167], v19 offset:20480
  v_cvt_pk_bf16_f32 v129, v34, v35
  v_exp_f32 v33, v61
  v_mfma_f32_16x16x32_bf16 v[116:119], a[172:175], a[252:255], v[116:119]
  v_add_f32 v29, v29, v32
  s_waitcnt lgkmcnt(2)
  v_mfma_f32_16x16x32_bf16 a[80:83], a[160:163], v[140:143], a[80:83]
  v_exp_f32 v34, v62
  v_mfma_f32_16x16x32_bf16 a[84:87], a[160:163], v[144:147], a[84:87]
  ds_read_b64_tr_b16 a[168:169], v20 offset:16384
  v_add_f32 v29, v29, v33
  v_mfma_f32_16x16x32_bf16 a[88:91], a[160:163], v[148:151], a[88:91]
  s_add_u32 s10, s10, 1280
  s_waitcnt vmcnt(5)
  buffer_load_dword v252, v246, s[80:83], s10 offen
  v_cvt_pk_bf16_f32 v130, v32, v33
  v_exp_f32 v35, v63
  v_mfma_f32_16x16x32_bf16 a[92:95], a[160:163], v[152:155], a[92:95]
  ds_read_b64_tr_b16 a[170:171], v20 offset:20480
  v_add_f32 v29, v29, v34
  v_mfma_f32_16x16x32_bf16 a[96:99], a[160:163], v[156:159], a[96:99]
  v_exp_f32 v32, v64
  s_waitcnt lgkmcnt(2)
  v_mfma_f32_16x16x32_bf16 a[100:103], a[164:167], v[140:143], a[100:103]
  v_add_f32 v29, v29, v35
  v_mfma_f32_16x16x32_bf16 a[104:107], a[164:167], v[144:147], a[104:107]
  ds_read_b64_tr_b16 a[172:173], v21 offset:16384
  v_cvt_pk_bf16_f32 v131, v34, v35
  v_exp_f32 v33, v65
  v_mfma_f32_16x16x32_bf16 a[108:111], a[164:167], v[148:151], a[108:111]
  v_exp_f32 v34, v66
  v_mfma_f32_16x16x32_bf16 a[112:115], a[164:167], v[152:155], a[112:115]
  ds_read_b64_tr_b16 a[174:175], v21 offset:20480
  v_add_f32 v30, v32, v33
  v_mfma_f32_16x16x32_bf16 a[116:119], a[164:167], v[156:159], a[116:119]
  v_cvt_pk_bf16_f32 v132, v32, v33
  s_waitcnt lgkmcnt(2)
  v_mfma_f32_16x16x32_bf16 a[120:123], a[168:171], v[140:143], a[120:123]
  s_add_u32 s10, s10, 1280
  s_waitcnt vmcnt(5)
  buffer_load_dword v253, v246, s[80:83], s10 offen
  v_exp_f32 v35, v67
  v_mfma_f32_16x16x32_bf16 a[124:127], a[168:171], v[144:147], a[124:127]
  ds_read_b64_tr_b16 a[160:161], v14 offset:16384
  v_add_f32 v30, v30, v34
  v_exp_f32 v32, v68
  v_mfma_f32_16x16x32_bf16 a[128:131], a[168:171], v[148:151], a[128:131]
  v_add_f32 v30, v30, v35
  v_mfma_f32_16x16x32_bf16 a[132:135], a[168:171], v[152:155], a[132:135]
  ds_read_b64_tr_b16 a[162:163], v14 offset:20480
  v_cvt_pk_bf16_f32 v133, v34, v35
  v_mfma_f32_16x16x32_bf16 a[136:139], a[168:171], v[156:159], a[136:139]
  v_exp_f32 v33, v69
  s_waitcnt lgkmcnt(2)
  v_mfma_f32_16x16x32_bf16 a[140:143], a[172:175], v[140:143], a[140:143]
  v_add_f32 v30, v30, v32
  v_exp_f32 v34, v70
  v_mfma_f32_16x16x32_bf16 a[144:147], a[172:175], v[144:147], a[144:147]
  ds_read_b64_tr_b16 a[164:165], v15 offset:16384
  v_add_f32 v30, v30, v33
  v_mfma_f32_16x16x32_bf16 a[148:151], a[172:175], v[148:151], a[148:151]
  v_cvt_pk_bf16_f32 v134, v32, v33
  v_exp_f32 v35, v71
  v_mfma_f32_16x16x32_bf16 a[152:155], a[172:175], v[152:155], a[152:155]
  ds_read_b64_tr_b16 a[166:167], v15 offset:20480
  v_mfma_f32_16x16x32_bf16 a[156:159], a[172:175], v[156:159], a[156:159]
  v_add_f32 v30, v30, v34
  v_exp_f32 v32, v72
  s_waitcnt lgkmcnt(2)
  v_mfma_f32_16x16x32_bf16 a[0:3], a[160:163], v[140:143], a[0:3]
  v_add_f32 v30, v30, v35
  v_mfma_f32_16x16x32_bf16 a[4:7], a[160:163], v[144:147], a[4:7]
  ds_read_b64_tr_b16 a[168:169], v16 offset:16384
  v_cvt_pk_bf16_f32 v135, v34, v35
  v_exp_f32 v33, v73
  v_mfma_f32_16x16x32_bf16 a[8:11], a[160:163], v[148:151], a[8:11]
  v_mfma_f32_16x16x32_bf16 a[12:15], a[160:163], v[152:155], a[12:15]
  ds_read_b64_tr_b16 a[170:171], v16 offset:20480
  v_exp_f32 v34, v74
  v_mfma_f32_16x16x32_bf16 a[16:19], a[160:163], v[156:159], a[16:19]
  v_add_f32 v31, v32, v33
  v_cvt_pk_bf16_f32 v136, v32, v33
  s_waitcnt lgkmcnt(2)
  v_mfma_f32_16x16x32_bf16 a[20:23], a[164:167], v[140:143], a[20:23]
  v_exp_f32 v35, v75
  v_mfma_f32_16x16x32_bf16 a[24:27], a[164:167], v[144:147], a[24:27]
  ds_read_b64_tr_b16 a[172:173], v17 offset:16384
  v_add_f32 v31, v31, v34
  v_exp_f32 v32, v76
  v_mfma_f32_16x16x32_bf16 a[28:31], a[164:167], v[148:151], a[28:31]
  v_mfma_f32_16x16x32_bf16 a[32:35], a[164:167], v[152:155], a[32:35]
  ds_read_b64_tr_b16 a[174:175], v17 offset:20480
  v_add_f32 v31, v31, v35
  v_cvt_pk_bf16_f32 v137, v34, v35
  v_mfma_f32_16x16x32_bf16 a[36:39], a[164:167], v[156:159], a[36:39]
  v_exp_f32 v33, v77
  s_waitcnt lgkmcnt(2)
  v_mfma_f32_16x16x32_bf16 a[40:43], a[168:171], v[140:143], a[40:43]
  v_add_f32 v31, v31, v32
  v_exp_f32 v34, v78
  v_mfma_f32_16x16x32_bf16 a[44:47], a[168:171], v[144:147], a[44:47]
  s_waitcnt lgkmcnt(0)
  s_barrier
  ds_read_b64_tr_b16 a[160:161], v18 offset:32768
  v_mfma_f32_16x16x32_bf16 a[48:51], a[168:171], v[148:151], a[48:51]
  v_add_f32 v31, v31, v33
  v_cvt_pk_bf16_f32 v138, v32, v33
  v_mfma_f32_16x16x32_bf16 a[52:55], a[168:171], v[152:155], a[52:55]
  ds_read_b64_tr_b16 a[162:163], v18 offset:36864
  v_exp_f32 v35, v79
  v_mfma_f32_16x16x32_bf16 a[56:59], a[168:171], v[156:159], a[56:59]
  s_add_u32 s10, s10, 1280
  s_waitcnt vmcnt(5)
  buffer_load_dword v250, v246, s[80:83], s10 offen
  v_add_f32 v31, v31, v34
  v_add_f32 v31, v31, v35
  v_mfma_f32_16x16x32_bf16 a[60:63], a[172:175], v[140:143], a[60:63]
  v_cvt_pk_bf16_f32 v139, v34, v35
  v_mfma_f32_16x16x32_bf16 a[64:67], a[172:175], v[144:147], a[64:67]
  ds_read_b64_tr_b16 a[164:165], v19 offset:32768
  v_max3_f32 v36, v27, v28, v29
  v_mfma_f32_16x16x32_bf16 a[68:71], a[172:175], v[148:151], a[68:71]
  v_max3_f32 v36, v36, v30, v31
  v_mfma_f32_16x16x32_bf16 a[72:75], a[172:175], v[152:155], a[72:75]
  ds_read_b64_tr_b16 a[166:167], v19 offset:36864
  v_cmp_nge_f32 vcc, s49, v36
  v_mfma_f32_16x16x32_bf16 a[76:79], a[172:175], v[156:159], a[76:79]
  s_cbranch_vccnz Lstub14
Lret14:
  v_add_f32 v22, v22, v27
  v_add_f32 v23, v23, v28
  v_add_f32 v24, v24, v29
  v_add_f32 v25, v25, v30
  v_add_f32 v26, v26, v31
  s_waitcnt lgkmcnt(2)
  v_mfma_f32_16x16x32_bf16 a[80:83], a[160:163], v[120:123], a[80:83]
  v_exp_f32 v32, v80
  v_exp_f32 v33, v81
  v_mfma_f32_16x16x32_bf16 a[84:87], a[160:163], v[124:127], a[84:87]
  ds_read_b64_tr_b16 a[168:169], v20 offset:32768
  v_exp_f32 v34, v82
  v_add_f32 v27, v32, v33
  v_cvt_pk_bf16_f32 v140, v32, v33
  v_mfma_f32_16x16x32_bf16 a[88:91], a[160:163], v[128:131], a[88:91]
  s_add_u32 s10, s10, 1280
  s_waitcnt vmcnt(5)
  buffer_load_dword v251, v246, s[80:83], s10 offen
  v_exp_f32 v35, v83
  v_add_f32 v27, v27, v34
  v_exp_f32 v32, v84
  v_mfma_f32_16x16x32_bf16 a[92:95], a[160:163], v[132:135], a[92:95]
  ds_read_b64_tr_b16 a[170:171], v20 offset:36864
  v_add_f32 v27, v27, v35
  v_cvt_pk_bf16_f32 v141, v34, v35
  v_mfma_f32_16x16x32_bf16 a[96:99], a[160:163], v[136:139], a[96:99]
  v_exp_f32 v33, v85
  v_add_f32 v27, v27, v32
  v_exp_f32 v34, v86
  s_waitcnt lgkmcnt(2)
  v_mfma_f32_16x16x32_bf16 a[100:103], a[164:167], v[120:123], a[100:103]
  v_add_f32 v27, v27, v33
  v_cvt_pk_bf16_f32 v142, v32, v33
  v_exp_f32 v35, v87
  v_mfma_f32_16x16x32_bf16 a[104:107], a[164:167], v[124:127], a[104:107]
  ds_read_b64_tr_b16 a[172:173], v21 offset:32768
  v_add_f32 v27, v27, v34
  v_exp_f32 v32, v88
  v_mfma_f32_16x16x32_bf16 a[108:111], a[164:167], v[128:131], a[108:111]
  v_add_f32 v27, v27, v35
  v_cvt_pk_bf16_f32 v143, v34, v35
  v_exp_f32 v33, v89
  v_mfma_f32_16x16x32_bf16 a[112:115], a[164:167], v[132:135], a[112:115]
  ds_read_b64_tr_b16 a[174:175], v21 offset:36864
  v_exp_f32 v34, v90
  v_add_f32 v28, v32, v33
  v_mfma_f32_16x16x32_bf16 a[116:119], a[164:167], v[136:139], a[116:119]
  v_cvt_pk_bf16_f32 v144, v32, v33
  v_exp_f32 v35, v91
  v_add_f32 v28, v28, v34
  s_waitcnt lgkmcnt(2)
  v_mfma_f32_16x16x32_bf16 a[120:123], a[168:171], v[120:123], a[120:123]
  s_add_u32 s10, s10, 1280
  s_waitcnt vmcnt(5)
  buffer_load_dword v252, v246, s[80:83], s10 offen
  v_exp_f32 v32, v92
  v_add_f32 v28, v28, v35
  v_cvt_pk_bf16_f32 v145, v34, v35
  v_mfma_f32_16x16x32_bf16 a[124:127], a[168:171], v[124:127], a[124:127]
  ds_read_b64_tr_b16 a[160:161], v14 offset:32768
  v_exp_f32 v33, v93
  v_add_f32 v28, v28, v32
  v_mfma_f32_16x16x32_bf16 a[128:131], a[168:171], v[128:131], a[128:131]
  v_exp_f32 v34, v94
  v_add_f32 v28, v28, v33
  v_cvt_pk_bf16_f32 v146, v32, v33
  v_mfma_f32_16x16x32_bf16 a[132:135], a[168:171], v[132:135], a[132:135]
  ds_read_b64_tr_b16 a[162:163], v14 offset:36864
  v_exp_f32 v35, v95
  v_add_f32 v28, v28, v34
  v_exp_f32 v32, v96
  v_mfma_f32_16x16x32_bf16 a[136:139], a[168:171], v[136:139], a[136:139]
  v_add_f32 v28, v28, v35
  v_cvt_pk_bf16_f32 v147, v34, v35
  v_exp_f32 v33, v97
  s_waitcnt lgkmcnt(2)
  v_mfma_f32_16x16x32_bf16 a[140:143], a[172:175], v[120:123], a[140:143]
  v_exp_f32 v34, v98
  v_mfma_f32_16x16x32_bf16 a[144:147], a[172:175], v[124:127], a[144:147]
  ds_read_b64_tr_b16 a[164:165], v15 offset:32768
  v_add_f32 v29, v32, v33
  v_cvt_pk_bf16_f32 v148, v32, v33
  v_exp_f32 v35, v99
  v_mfma_f32_16x16x32_bf16 a[148:151], a[172:175], v[128:131], a[148:151]
  v_add_f32 v29, v29, v34
  v_exp_f32 v32, v100
  v_add_f32 v29, v29, v35
  v_mfma_f32_16x16x32_bf16 a[152:155], a[172:175], v[132:135], a[152:155]
  s_add_u32 s10, s10, 1280
  s_waitcnt vmcnt(5)
  buffer_load_dword v253, v246, s[80:83], s10 offen
  ds_read_b64_tr_b16 a[166:167], v15 offset:36864
  v_cvt_pk_bf16_f32 v149, v34, v35
  v_exp_f32 v33, v101
  v_add_f32 v29, v29, v32
  v_mfma_f32_16x16x32_bf16 a[156:159], a[172:175], v[136:139], a[156:159]
  v_exp_f32 v34, v102
  v_add_f32 v29, v29, v33
  s_waitcnt lgkmcnt(2)
  v_mfma_f32_16x16x32_bf16 a[0:3], a[160:163], v[120:123], a[0:3]
  v_cvt_pk_bf16_f32 v150, v32, v33
  v_exp_f32 v35, v103
  v_add_f32 v29, v29, v34
  v_mfma_f32_16x16x32_bf16 a[4:7], a[160:163], v[124:127], a[4:7]
  ds_read_b64_tr_b16 a[168:169], v16 offset:32768
  v_exp_f32 v32, v104
  v_add_f32 v29, v29, v35
  v_cvt_pk_bf16_f32 v151, v34, v35
  v_mfma_f32_16x16x32_bf16 a[8:11], a[160:163], v[128:131], a[8:11]
  v_exp_f32 v33, v105
  v_exp_f32 v34, v106
  v_mfma_f32_16x16x32_bf16 a[12:15], a[160:163], v[132:135], a[12:15]
  ds_read_b64_tr_b16 a[170:171], v16 offset:36864
  v_add_f32 v30, v32, v33
  v_cvt_pk_bf16_f32 v152, v32, v33
  v_exp_f32 v35, v107
  v_mfma_f32_16x16x32_bf16 a[16:19], a[160:163], v[136:139], a[16:19]
  v_add_f32 v30, v30, v34
  v_exp_f32 v32, v108
  s_waitcnt lgkmcnt(2)
  v_mfma_f32_16x16x32_bf16 a[20:23], a[164:167], v[120:123], a[20:23]
  v_add_f32 v30, v30, v35
  v_cvt_pk_bf16_f32 v153, v34, v35
  v_exp_f32 v33, v109
  v_mfma_f32_16x16x32_bf16 a[24:27], a[164:167], v[124:127], a[24:27]
  ds_read_b64_tr_b16 a[172:173], v17 offset:32768
  v_add_f32 v30, v30, v32
  v_exp_f32 v34, v110
  v_add_f32 v30, v30, v33
  v_mfma_f32_16x16x32_bf16 a[28:31], a[164:167], v[128:131], a[28:31]
  v_cvt_pk_bf16_f32 v154, v32, v33
  v_exp_f32 v35, v111
  v_mfma_f32_16x16x32_bf16 a[32:35], a[164:167], v[132:135], a[32:35]
  ds_read_b64_tr_b16 a[174:175], v17 offset:36864
  v_add_f32 v30, v30, v34
  v_exp_f32 v32, v112
  v_add_f32 v30, v30, v35
  v_mfma_f32_16x16x32_bf16 a[36:39], a[164:167], v[136:139], a[36:39]
  v_cvt_pk_bf16_f32 v155, v34, v35
  v_exp_f32 v33, v113
  v_exp_f32 v34, v114
  s_waitcnt lgkmcnt(2)
  v_mfma_f32_16x16x32_bf16 a[40:43], a[168:171], v[120:123], a[40:43]
  v_add_f32 v31, v32, v33
  v_cvt_pk_bf16_f32 v156, v32, v33
  v_exp_f32 v35, v115
  v_mfma_f32_16x16x32_bf16 a[44:47], a[168:171], v[124:127], a[44:47]
  s_waitcnt lgkmcnt(0)
  s_barrier
  ds_read_b64_tr_b16 a[160:161], v18 offset:49152
  v_add_f32 v31, v31, v34
  v_exp_f32 v32, v116
  v_mfma_f32_16x16x32_bf16 a[48:51], a[168:171], v[128:131], a[48:51]
  v_add_f32 v31, v31, v35
  v_cvt_pk_bf16_f32 v157, v34, v35
  v_exp_f32 v33, v117
  v_mfma_f32_16x16x32_bf16 a[52:55], a[168:171], v[132:135], a[52:55]
  ds_read_b64_tr_b16 a[162:163], v18 offset:53248
  v_add_f32 v31, v31, v32
  v_exp_f32 v34, v118
  v_mfma_f32_16x16x32_bf16 a[56:59], a[168:171], v[136:139], a[56:59]
  s_add_u32 s7, s58, s4
  s_mul_i32 s6, s59, 26
  s_add_u32 s6, s6, s58
  s_mul_i32 s6, s6, 5120
  s_mov_b32 m0, s6
  s_and_b32 s7, s7, 31
  s_or_b32 s5, s7, s100
  s_mul_i32 s5, s5, 40960
  buffer_load_dwordx4 v224, s[80:83], s5 offen lds
  v_add_f32 v31, v31, v33
  v_cvt_pk_bf16_f32 v158, v32, v33
  v_exp_f32 v35, v119
  v_mfma_f32_16x16x32_bf16 a[60:63], a[172:175], v[120:123], a[60:63]
  v_add_f32 v31, v31, v34
  v_add_f32 v31, v31, v35
  v_cvt_pk_bf16_f32 v159, v34, v35
  v_mfma_f32_16x16x32_bf16 a[64:67], a[172:175], v[124:127], a[64:67]
  buffer_load_dwordx4 v225, s[80:83], s5 offen offset:1024 lds
  ds_read_b64_tr_b16 a[164:165], v19 offset:49152
  v_max3_f32 v36, v27, v28, v29
  v_mfma_f32_16x16x32_bf16 a[68:71], a[172:175], v[128:131], a[68:71]
  v_max3_f32 v36, v36, v30, v31
  v_mfma_f32_16x16x32_bf16 a[72:75], a[172:175], v[132:135], a[72:75]
  buffer_load_dwordx4 v226, s[80:83], s5 offen offset:2048 lds
  ds_read_b64_tr_b16 a[166:167], v19 offset:53248
  v_cmp_nge_f32 vcc, s49, v36
  v_mfma_f32_16x16x32_bf16 a[76:79], a[172:175], v[136:139], a[76:79]
  s_cbranch_vccnz Lstub15
Lret15:
  v_add_f32 v22, v22, v27
  v_add_f32 v23, v23, v28
  v_add_f32 v24, v24, v29
  v_add_f32 v25, v25, v30
  v_add_f32 v26, v26, v31
  s_waitcnt lgkmcnt(2)
  v_mfma_f32_16x16x32_bf16 a[80:83], a[160:163], v[140:143], a[80:83]
  buffer_load_dwordx4 v227, s[80:83], s5 offen offset:3072 lds
  ds_read_b64_tr_b16 a[176:177], v20 offset:49152
  ds_read_b64_tr_b16 a[178:179], v20 offset:53248
  ds_write2_b32 v220, v160, v164 offset0:0 offset1:16
  ds_write2_b32 v220, v168, v172 offset0:32 offset1:48
  ds_write_b32 v220, v176 offset:256
  v_mov_b32 v209, v22
  v_mfma_f32_16x16x32_bf16 a[84:87], a[160:163], v[144:147], a[84:87]
  ds_read_b64_tr_b16 a[180:181], v21 offset:49152
  ds_read_b64_tr_b16 a[182:183], v21 offset:53248
  v_mov_b32 v210, v23
  v_mov_b32 v211, v24
  v_mov_b32 v212, v25
  v_mov_b32 v213, v26
  v_mfma_f32_16x16x32_bf16 a[88:91], a[160:163], v[148:151], a[88:91]
  s_add_u32 m0, s6, 4096
  s_nop 0
  buffer_load_dwordx4 v228, s[80:83], s5 offen lds
  ds_read_b64_tr_b16 a[184:185], v14 offset:49152
  ds_read_b64_tr_b16 a[186:187], v14 offset:53248
  v_permlane32_swap_b32 v22, v209
  v_permlane32_swap_b32 v23, v210
  v_permlane32_swap_b32 v24, v211
  v_mfma_f32_16x16x32_bf16 a[92:95], a[160:163], v[152:155], a[92:95]
  ds_read_b64_tr_b16 a[188:189], v15 offset:49152
  ds_read_b64_tr_b16 a[190:191], v15 offset:53248
  v_permlane32_swap_b32 v25, v212
  v_permlane32_swap_b32 v26, v213
  v_add_f32 v22, v22, v209
  v_add_f32 v23, v23, v210
  v_mfma_f32_16x16x32_bf16 a[96:99], a[160:163], v[156:159], a[96:99]
  s_add_u32 s7, s58, s3
  s_add_u32 s7, s7, 2
  s_add_u32 s6, s6, 10240
  s_mov_b32 m0, s6
  s_and_b32 s7, s7, 31
  s_or_b32 s5, s7, s100
  s_mul_i32 s5, s5, 40960
  buffer_load_dwordx4 v224, s[80:83], s5 offen lds
  ds_read_b64_tr_b16 a[192:193], v16 offset:49152
  ds_read_b64_tr_b16 a[194:195], v16 offset:53248
  v_add_f32 v24, v24, v211
  v_add_f32 v25, v25, v212
  v_add_f32 v26, v26, v213
  s_waitcnt lgkmcnt(13)
  v_mfma_f32_16x16x32_bf16 a[100:103], a[164:167], v[140:143], a[100:103]
  ds_read_b64_tr_b16 a[196:197], v17 offset:49152
  ds_read_b64_tr_b16 a[198:199], v17 offset:53248
  v_mov_b32 v209, v22
  v_mov_b32 v210, v23
  v_mov_b32 v211, v24
  v_mov_b32 v212, v25
  v_mfma_f32_16x16x32_bf16 a[104:107], a[164:167], v[144:147], a[104:107]
  buffer_load_dwordx4 v225, s[80:83], s5 offen offset:1024 lds
  v_mov_b32 v213, v26
  v_permlane16_swap_b32 v22, v209
  v_permlane16_swap_b32 v23, v210
  v_permlane16_swap_b32 v24, v211
  v_mfma_f32_16x16x32_bf16 a[108:111], a[164:167], v[148:151], a[108:111]
  v_permlane16_swap_b32 v25, v212
  v_permlane16_swap_b32 v26, v213
  v_add_f32 v22, v22, v209
  v_mfma_f32_16x16x32_bf16 a[112:115], a[164:167], v[152:155], a[112:115]
  buffer_load_dwordx4 v226, s[80:83], s5 offen offset:2048 lds
  v_add_f32 v23, v23, v210
  v_add_f32 v24, v24, v211
  v_add_f32 v25, v25, v212
  v_add_f32 v26, v26, v213
  v_mfma_f32_16x16x32_bf16 a[116:119], a[164:167], v[156:159], a[116:119]
  ds_write2_b32 v221, v22, v23 offset0:0 offset1:16
  ds_write2_b32 v221, v24, v25 offset0:32 offset1:48
  ds_write_b32 v221, v26 offset:256
  s_waitcnt lgkmcnt(15)
  v_mfma_f32_16x16x32_bf16 a[120:123], a[176:179], v[140:143], a[120:123]
  buffer_load_dwordx4 v227, s[80:83], s5 offen offset:3072 lds
  v_mfma_f32_16x16x32_bf16 a[124:127], a[176:179], v[144:147], a[124:127]
  s_waitcnt lgkmcnt(0)
  s_barrier
  ds_read2_b32 v[204:205], v222 offset0:64 offset1:48
  ds_read2_b32 v[206:207], v222 offset0:32 offset1:16
  ds_read_b32 v208, v222
  ds_read_b32 v209, v223 offset:256
  ds_read2_b32 v[210:211], v223 offset0:48 offset1:32
  ds_read2_b32 v[212:213], v223 offset0:16 offset1:0
  v_mfma_f32_16x16x32_bf16 a[128:131], a[176:179], v[148:151], a[128:131]
  s_add_u32 m0, s6, 4096
  s_nop 0
  buffer_load_dwordx4 v228, s[80:83], s5 offen lds
  ds_write_b128 v219, a[80:83] offset:32768
  v_mfma_f32_16x16x32_bf16 a[132:135], a[176:179], v[152:155], a[132:135]
  ds_write_b128 v219, a[84:87] offset:33792
  v_mfma_f32_16x16x32_bf16 a[136:139], a[176:179], v[156:159], a[136:139]
  s_add_u32 s7, s7, 2
  s_add_u32 s6, s6, 10240
  s_mov_b32 m0, s6
  s_and_b32 s7, s7, 31
  s_or_b32 s5, s7, s100
  s_mul_i32 s5, s5, 40960
  buffer_load_dwordx4 v224, s[80:83], s5 offen lds
  ds_write_b128 v219, a[88:91] offset:34816
  v_mfma_f32_16x16x32_bf16 a[140:143], a[180:183], v[140:143], a[140:143]
  ds_write_b128 v219, a[92:95] offset:35840
  v_mfma_f32_16x16x32_bf16 a[144:147], a[180:183], v[144:147], a[144:147]
  buffer_load_dwordx4 v225, s[80:83], s5 offen offset:1024 lds
  ds_write_b128 v219, a[96:99] offset:36864
  s_waitcnt lgkmcnt(10)
  v_min_f32 v32, v204, v160
  v_sub_f32 v180, v32, v160
  v_sub_f32 v181, v32, v204
  v_mfma_f32_16x16x32_bf16 a[148:151], a[180:183], v[148:151], a[148:151]
  ds_write_b128 v219, a[100:103] offset:37888
  v_min_f32 v33, v205, v164
  v_sub_f32 v182, v33, v164
  v_mfma_f32_16x16x32_bf16 a[152:155], a[180:183], v[152:155], a[152:155]
  buffer_load_dwordx4 v226, s[80:83], s5 offen offset:2048 lds
  ds_write_b128 v219, a[104:107] offset:38912
  v_sub_f32 v183, v33, v205
  s_waitcnt lgkmcnt(11)
  v_min_f32 v34, v206, v168
  v_mfma_f32_16x16x32_bf16 a[156:159], a[180:183], v[156:159], a[156:159]
  ds_write_b128 v219, a[108:111] offset:39936
  v_sub_f32 v184, v34, v168
  v_sub_f32 v185, v34, v206
  v_mfma_f32_16x16x32_bf16 a[0:3], a[184:187], v[140:143], a[0:3]
  buffer_load_dwordx4 v227, s[80:83], s5 offen offset:3072 lds
  ds_write_b128 v219, a[112:115] offset:40960
  v_min_f32 v35, v207, v172
  v_sub_f32 v186, v35, v172
  v_mfma_f32_16x16x32_bf16 a[4:7], a[184:187], v[144:147], a[4:7]
  ds_write_b128 v219, a[116:119] offset:41984
  v_sub_f32 v187, v35, v207
  s_waitcnt lgkmcnt(13)
  v_min_f32 v32, v208, v176
  v_mfma_f32_16x16x32_bf16 a[8:11], a[184:187], v[148:151], a[8:11]
  s_add_u32 m0, s6, 4096
  s_nop 0
  buffer_load_dwordx4 v228, s[80:83], s5 offen lds
  ds_write_b128 v219, a[120:123] offset:43008
  v_sub_f32 v188, v32, v176
  v_sub_f32 v189, v32, v208
  v_mfma_f32_16x16x32_bf16 a[12:15], a[184:187], v[152:155], a[12:15]
  ds_write_b128 v219, a[124:127] offset:44032
  v_exp_f32 v180, v180
  v_exp_f32 v181, v181
  v_mfma_f32_16x16x32_bf16 a[16:19], a[184:187], v[156:159], a[16:19]
  ds_write_b128 v219, a[128:131] offset:45056
  v_exp_f32 v182, v182
  v_exp_f32 v183, v183
  v_mfma_f32_16x16x32_bf16 a[20:23], a[188:191], v[140:143], a[20:23]
  ds_write_b128 v219, a[132:135] offset:46080
  v_exp_f32 v184, v184
  v_exp_f32 v185, v185
  v_mfma_f32_16x16x32_bf16 a[24:27], a[188:191], v[144:147], a[24:27]
  ds_write_b128 v219, a[136:139] offset:47104
  v_exp_f32 v186, v186
  v_exp_f32 v187, v187
  v_mfma_f32_16x16x32_bf16 a[28:31], a[188:191], v[148:151], a[28:31]
  ds_write_b128 v219, a[140:143] offset:48128
  v_exp_f32 v188, v188
  v_exp_f32 v189, v189
  v_mfma_f32_16x16x32_bf16 a[32:35], a[188:191], v[152:155], a[32:35]
  ds_write_b128 v219, a[144:147] offset:49152
  s_waitcnt lgkmcnt(15)
  v_mul_f32 v209, v209, v181
  v_mul_f32 v210, v210, v183
  v_mul_f32 v211, v211, v185
  v_mfma_f32_16x16x32_bf16 a[36:39], a[188:191], v[156:159], a[36:39]
  ds_write_b128 v219, a[148:151] offset:50176
  v_mul_f32 v212, v212, v187
  v_mul_f32 v213, v213, v189
  v_mfma_f32_16x16x32_bf16 a[40:43], a[192:195], v[140:143], a[40:43]
  ds_write_b128 v219, a[152:155] offset:51200
  v_fmac_f32 v209, v22, v180
  v_fmac_f32 v210, v23, v182
  v_mfma_f32_16x16x32_bf16 a[44:47], a[192:195], v[144:147], a[44:47]
  ds_write_b128 v219, a[156:159] offset:52224
  v_fmac_f32 v211, v24, v184
  v_fmac_f32 v212, v25, v186
  v_mfma_f32_16x16x32_bf16 a[48:51], a[192:195], v[148:151], a[48:51]
  v_fmac_f32 v213, v26, v188
  v_rcp_f32 v209, v209
  v_mfma_f32_16x16x32_bf16 a[52:55], a[192:195], v[152:155], a[52:55]
  v_rcp_f32 v210, v210
  v_rcp_f32 v211, v211
  v_mfma_f32_16x16x32_bf16 a[56:59], a[192:195], v[156:159], a[56:59]
  v_rcp_f32 v212, v212
  v_rcp_f32 v213, v213
  v_mfma_f32_16x16x32_bf16 a[60:63], a[196:199], v[140:143], a[60:63]
  v_mul_f32 v180, v180, v209
  v_mul_f32 v181, v181, v209
  v_mfma_f32_16x16x32_bf16 a[64:67], a[196:199], v[144:147], a[64:67]
  v_mul_f32 v182, v182, v210
  v_mul_f32 v183, v183, v210
  v_mfma_f32_16x16x32_bf16 a[68:71], a[196:199], v[148:151], a[68:71]
  v_mul_f32 v184, v184, v211
  v_mul_f32 v185, v185, v211
  v_mfma_f32_16x16x32_bf16 a[72:75], a[196:199], v[152:155], a[72:75]
  v_mul_f32 v186, v186, v212
  v_mul_f32 v187, v187, v212
  v_mfma_f32_16x16x32_bf16 a[76:79], a[196:199], v[156:159], a[76:79]
  v_mul_f32 v188, v188, v213
  v_mul_f32 v189, v189, v213
  v_accvgpr_read_b32 v40, a0
  v_accvgpr_read_b32 v41, a1
  v_accvgpr_read_b32 v42, a2
  v_accvgpr_read_b32 v43, a3
  v_pk_mul_f32 v[40:41], v[40:41], v[180:181] op_sel_hi:[1,0]
  v_pk_mul_f32 v[42:43], v[42:43], v[180:181] op_sel_hi:[1,0]
  v_accvgpr_read_b32 v60, a20
  v_accvgpr_read_b32 v61, a21
  v_accvgpr_read_b32 v62, a22
  v_accvgpr_read_b32 v63, a23
  v_pk_mul_f32 v[60:61], v[60:61], v[180:181] op_sel_hi:[1,0]
  v_pk_mul_f32 v[62:63], v[62:63], v[180:181] op_sel_hi:[1,0]
  v_accvgpr_read_b32 v44, a4
  v_accvgpr_read_b32 v45, a5
  v_accvgpr_read_b32 v46, a6
  v_accvgpr_read_b32 v47, a7
  v_pk_mul_f32 v[44:45], v[44:45], v[182:183] op_sel_hi:[1,0]
  v_pk_mul_f32 v[46:47], v[46:47], v[182:183] op_sel_hi:[1,0]
  v_accvgpr_read_b32 v64, a24
  v_accvgpr_read_b32 v65, a25
  v_accvgpr_read_b32 v66, a26
  v_accvgpr_read_b32 v67, a27
  v_pk_mul_f32 v[64:65], v[64:65], v[182:183] op_sel_hi:[1,0]
  v_pk_mul_f32 v[66:67], v[66:67], v[182:183] op_sel_hi:[1,0]
  s_waitcnt lgkmcnt(0)
  s_barrier
  ds_read_b128 v[160:163], v39 offset:36864
  ds_read_b128 v[164:167], v39 offset:41984
  ds_read_b128 v[168:171], v39 offset:35840
  ds_read_b128 v[172:175], v39 offset:40960
  ds_read_b128 v[176:179], v39 offset:34816
  ds_read_b128 v[4:7], v39 offset:39936
  ds_read_b128 v[8:11], v39 offset:33792
  ds_read_b128 v[12:15], v39 offset:38912
  ds_read_b128 v[16:19], v39 offset:32768
  ds_read_b128 v[200:203], v39 offset:37888
  s_waitcnt lgkmcnt(9)
  v_pk_fma_f32 v[40:41], v[160:161], v[180:181], v[40:41] op_sel:[0,1,0] op_sel_hi:[1,1,1]
  v_pk_fma_f32 v[42:43], v[162:163], v[180:181], v[42:43] op_sel:[0,1,0] op_sel_hi:[1,1,1]
  ds_read_b128 v[160:163], v39 offset:47104
  v_cvt_pk_bf16_f32 v120, v40, v41
  v_cvt_pk_bf16_f32 v121, v42, v43
  s_waitcnt lgkmcnt(9)
  v_pk_fma_f32 v[60:61], v[164:165], v[180:181], v[60:61] op_sel:[0,1,0] op_sel_hi:[1,1,1]
  v_pk_fma_f32 v[62:63], v[166:167], v[180:181], v[62:63] op_sel:[0,1,0] op_sel_hi:[1,1,1]
  ds_read_b128 v[164:167], v39 offset:52224
  v_cvt_pk_bf16_f32 v122, v60, v61
  v_cvt_pk_bf16_f32 v123, v62, v63
  buffer_store_dwordx4 v[120:123], v240, s[36:39], s44 offen sc1
  s_waitcnt lgkmcnt(9)
  v_pk_fma_f32 v[44:45], v[168:169], v[182:183], v[44:45] op_sel:[0,1,0] op_sel_hi:[1,1,1]
  v_pk_fma_f32 v[46:47], v[170:171], v[182:183], v[46:47] op_sel:[0,1,0] op_sel_hi:[1,1,1]
  ds_read_b128 v[168:171], v39 offset:46080
  v_cvt_pk_bf16_f32 v124, v44, v45
  v_cvt_pk_bf16_f32 v125, v46, v47
  s_waitcnt lgkmcnt(9)
  v_pk_fma_f32 v[64:65], v[172:173], v[182:183], v[64:65] op_sel:[0,1,0] op_sel_hi:[1,1,1]
  v_pk_fma_f32 v[66:67], v[174:175], v[182:183], v[66:67] op_sel:[0,1,0] op_sel_hi:[1,1,1]
  ds_read_b128 v[172:175], v39 offset:51200
  v_cvt_pk_bf16_f32 v126, v64, v65
  v_cvt_pk_bf16_f32 v127, v66, v67
  buffer_store_dwordx4 v[124:127], v241, s[36:39], s44 offen sc1
  v_accvgpr_read_b32 v48, a8
  v_accvgpr_read_b32 v49, a9
  v_accvgpr_read_b32 v50, a10
  v_accvgpr_read_b32 v51, a11
  v_pk_mul_f32 v[48:49], v[48:49], v[184:185] op_sel_hi:[1,0]
  v_pk_mul_f32 v[50:51], v[50:51], v[184:185] op_sel_hi:[1,0]
  s_waitcnt lgkmcnt(9)
  v_pk_fma_f32 v[48:49], v[176:177], v[184:185], v[48:49] op_sel:[0,1,0] op_sel_hi:[1,1,1]
  v_pk_fma_f32 v[50:51], v[178:179], v[184:185], v[50:51] op_sel:[0,1,0] op_sel_hi:[1,1,1]
  ds_read_b128 v[176:179], v39 offset:45056
  v_cvt_pk_bf16_f32 v128, v48, v49
  v_cvt_pk_bf16_f32 v129, v50, v51
  v_accvgpr_read_b32 v68, a28
  v_accvgpr_read_b32 v69, a29
  v_accvgpr_read_b32 v70, a30
  v_accvgpr_read_b32 v71, a31
  v_pk_mul_f32 v[68:69], v[68:69], v[184:185] op_sel_hi:[1,0]
  v_pk_mul_f32 v[70:71], v[70:71], v[184:185] op_sel_hi:[1,0]
  s_waitcnt lgkmcnt(9)
  v_pk_fma_f32 v[68:69], v[4:5], v[184:185], v[68:69] op_sel:[0,1,0] op_sel_hi:[1,1,1]
  v_pk_fma_f32 v[70:71], v[6:7], v[184:185], v[70:71] op_sel:[0,1,0] op_sel_hi:[1,1,1]
  ds_read_b128 v[4:7], v39 offset:50176
  v_cvt_pk_bf16_f32 v130, v68, v69
  v_cvt_pk_bf16_f32 v131, v70, v71
  buffer_store_dwordx4 v[128:131], v242, s[36:39], s44 offen sc1
  v_accvgpr_read_b32 v52, a12
  v_accvgpr_read_b32 v53, a13
  v_accvgpr_read_b32 v54, a14
  v_accvgpr_read_b32 v55, a15
  v_pk_mul_f32 v[52:53], v[52:53], v[186:187] op_sel_hi:[1,0]
  v_pk_mul_f32 v[54:55], v[54:55], v[186:187] op_sel_hi:[1,0]
  s_waitcnt lgkmcnt(9)
  v_pk_fma_f32 v[52:53], v[8:9], v[186:187], v[52:53] op_sel:[0,1,0] op_sel_hi:[1,1,1]
  v_pk_fma_f32 v[54:55], v[10:11], v[186:187], v[54:55] op_sel:[0,1,0] op_sel_hi:[1,1,1]
  ds_read_b128 v[8:11], v39 offset:44032
  v_cvt_pk_bf16_f32 v132, v52, v53
  v_cvt_pk_bf16_f32 v133, v54, v55
  v_accvgpr_read_b32 v72, a32
  v_accvgpr_read_b32 v73, a33
  v_accvgpr_read_b32 v74, a34
  v_accvgpr_read_b32 v75, a35
  v_pk_mul_f32 v[72:73], v[72:73], v[186:187] op_sel_hi:[1,0]
  v_pk_mul_f32 v[74:75], v[74:75], v[186:187] op_sel_hi:[1,0]
  s_waitcnt lgkmcnt(9)
  v_pk_fma_f32 v[72:73], v[12:13], v[186:187], v[72:73] op_sel:[0,1,0] op_sel_hi:[1,1,1]
  v_pk_fma_f32 v[74:75], v[14:15], v[186:187], v[74:75] op_sel:[0,1,0] op_sel_hi:[1,1,1]
  ds_read_b128 v[12:15], v39 offset:49152
  v_cvt_pk_bf16_f32 v134, v72, v73
  v_cvt_pk_bf16_f32 v135, v74, v75
  buffer_store_dwordx4 v[132:135], v243, s[36:39], s44 offen sc1
  v_accvgpr_read_b32 v56, a16
  v_accvgpr_read_b32 v57, a17
  v_accvgpr_read_b32 v58, a18
  v_accvgpr_read_b32 v59, a19
  v_pk_mul_f32 v[56:57], v[56:57], v[188:189] op_sel_hi:[1,0]
  v_pk_mul_f32 v[58:59], v[58:59], v[188:189] op_sel_hi:[1,0]
  s_waitcnt lgkmcnt(9)
  v_pk_fma_f32 v[56:57], v[16:17], v[188:189], v[56:57] op_sel:[0,1,0] op_sel_hi:[1,1,1]
  v_pk_fma_f32 v[58:59], v[18:19], v[188:189], v[58:59] op_sel:[0,1,0] op_sel_hi:[1,1,1]
  ds_read_b128 v[16:19], v39 offset:43008
  v_cvt_pk_bf16_f32 v136, v56, v57
  v_cvt_pk_bf16_f32 v137, v58, v59
  v_accvgpr_read_b32 v76, a36
  v_accvgpr_read_b32 v77, a37
  v_accvgpr_read_b32 v78, a38
  v_accvgpr_read_b32 v79, a39
  v_pk_mul_f32 v[76:77], v[76:77], v[188:189] op_sel_hi:[1,0]
  v_pk_mul_f32 v[78:79], v[78:79], v[188:189] op_sel_hi:[1,0]
  s_waitcnt lgkmcnt(9)
  v_pk_fma_f32 v[76:77], v[200:201], v[188:189], v[76:77] op_sel:[0,1,0] op_sel_hi:[1,1,1]
  v_pk_fma_f32 v[78:79], v[202:203], v[188:189], v[78:79] op_sel:[0,1,0] op_sel_hi:[1,1,1]
  ds_read_b128 v[200:203], v39 offset:48128
  v_cvt_pk_bf16_f32 v138, v76, v77
  v_cvt_pk_bf16_f32 v139, v78, v79
  buffer_store_dwordx4 v[136:139], v244, s[36:39], s44 offen sc1
  v_accvgpr_read_b32 v80, a40
  v_accvgpr_read_b32 v81, a41
  v_accvgpr_read_b32 v82, a42
  v_accvgpr_read_b32 v83, a43
  v_pk_mul_f32 v[80:81], v[80:81], v[180:181] op_sel_hi:[1,0]
  v_pk_mul_f32 v[82:83], v[82:83], v[180:181] op_sel_hi:[1,0]
  s_waitcnt lgkmcnt(9)
  v_pk_fma_f32 v[80:81], v[160:161], v[180:181], v[80:81] op_sel:[0,1,0] op_sel_hi:[1,1,1]
  v_pk_fma_f32 v[82:83], v[162:163], v[180:181], v[82:83] op_sel:[0,1,0] op_sel_hi:[1,1,1]
  v_cvt_pk_bf16_f32 v140, v80, v81
  v_cvt_pk_bf16_f32 v141, v82, v83
  v_accvgpr_read_b32 v100, a60
  v_accvgpr_read_b32 v101, a61
  v_accvgpr_read_b32 v102, a62
  v_accvgpr_read_b32 v103, a63
  v_pk_mul_f32 v[100:101], v[100:101], v[180:181] op_sel_hi:[1,0]
  v_pk_mul_f32 v[102:103], v[102:103], v[180:181] op_sel_hi:[1,0]
  s_waitcnt lgkmcnt(8)
  v_pk_fma_f32 v[100:101], v[164:165], v[180:181], v[100:101] op_sel:[0,1,0] op_sel_hi:[1,1,1]
  v_pk_fma_f32 v[102:103], v[166:167], v[180:181], v[102:103] op_sel:[0,1,0] op_sel_hi:[1,1,1]
  v_cvt_pk_bf16_f32 v142, v100, v101
  v_cvt_pk_bf16_f32 v143, v102, v103
  buffer_store_dwordx4 v[140:143], v240, s[36:39], s45 offen sc1
  v_accvgpr_read_b32 v84, a44
  v_accvgpr_read_b32 v85, a45
  v_accvgpr_read_b32 v86, a46
  v_accvgpr_read_b32 v87, a47
  v_pk_mul_f32 v[84:85], v[84:85], v[182:183] op_sel_hi:[1,0]
  v_pk_mul_f32 v[86:87], v[86:87], v[182:183] op_sel_hi:[1,0]
  s_waitcnt lgkmcnt(7)
  v_pk_fma_f32 v[84:85], v[168:169], v[182:183], v[84:85] op_sel:[0,1,0] op_sel_hi:[1,1,1]
  v_pk_fma_f32 v[86:87], v[170:171], v[182:183], v[86:87] op_sel:[0,1,0] op_sel_hi:[1,1,1]
  v_cvt_pk_bf16_f32 v144, v84, v85
  v_cvt_pk_bf16_f32 v145, v86, v87
  v_accvgpr_read_b32 v104, a64
  v_accvgpr_read_b32 v105, a65
  v_accvgpr_read_b32 v106, a66
  v_accvgpr_read_b32 v107, a67
  v_pk_mul_f32 v[104:105], v[104:105], v[182:183] op_sel_hi:[1,0]
  v_pk_mul_f32 v[106:107], v[106:107], v[182:183] op_sel_hi:[1,0]
  s_waitcnt lgkmcnt(6)
  v_pk_fma_f32 v[104:105], v[172:173], v[182:183], v[104:105] op_sel:[0,1,0] op_sel_hi:[1,1,1]
  v_pk_fma_f32 v[106:107], v[174:175], v[182:183], v[106:107] op_sel:[0,1,0] op_sel_hi:[1,1,1]
  v_cvt_pk_bf16_f32 v146, v104, v105
  v_cvt_pk_bf16_f32 v147, v106, v107
  buffer_store_dwordx4 v[144:147], v241, s[36:39], s45 offen sc1
  v_accvgpr_read_b32 v88, a48
  v_accvgpr_read_b32 v89, a49
  v_accvgpr_read_b32 v90, a50
  v_accvgpr_read_b32 v91, a51
  v_pk_mul_f32 v[88:89], v[88:89], v[184:185] op_sel_hi:[1,0]
  v_pk_mul_f32 v[90:91], v[90:91], v[184:185] op_sel_hi:[1,0]
  s_waitcnt lgkmcnt(5)
  v_pk_fma_f32 v[88:89], v[176:177], v[184:185], v[88:89] op_sel:[0,1,0] op_sel_hi:[1,1,1]
  v_pk_fma_f32 v[90:91], v[178:179], v[184:185], v[90:91] op_sel:[0,1,0] op_sel_hi:[1,1,1]
  v_cvt_pk_bf16_f32 v148, v88, v89
  v_cvt_pk_bf16_f32 v149, v90, v91
  v_accvgpr_read_b32 v108, a68
  v_accvgpr_read_b32 v109, a69
  v_accvgpr_read_b32 v110, a70
  v_accvgpr_read_b32 v111, a71
  v_pk_mul_f32 v[108:109], v[108:109], v[184:185] op_sel_hi:[1,0]
  v_pk_mul_f32 v[110:111], v[110:111], v[184:185] op_sel_hi:[1,0]
  s_waitcnt lgkmcnt(4)
  v_pk_fma_f32 v[108:109], v[4:5], v[184:185], v[108:109] op_sel:[0,1,0] op_sel_hi:[1,1,1]
  v_pk_fma_f32 v[110:111], v[6:7], v[184:185], v[110:111] op_sel:[0,1,0] op_sel_hi:[1,1,1]
  s_waitcnt lgkmcnt(0)
  s_barrier
  v_cvt_pk_bf16_f32 v150, v108, v109
  v_cvt_pk_bf16_f32 v151, v110, v111
  buffer_store_dwordx4 v[148:151], v242, s[36:39], s45 offen sc1
  v_accvgpr_read_b32 v92, a52
  v_accvgpr_read_b32 v93, a53
  v_accvgpr_read_b32 v94, a54
  v_accvgpr_read_b32 v95, a55
  v_pk_mul_f32 v[92:93], v[92:93], v[186:187] op_sel_hi:[1,0]
  v_pk_mul_f32 v[94:95], v[94:95], v[186:187] op_sel_hi:[1,0]
  v_pk_fma_f32 v[92:93], v[8:9], v[186:187], v[92:93] op_sel:[0,1,0] op_sel_hi:[1,1,1]
  v_pk_fma_f32 v[94:95], v[10:11], v[186:187], v[94:95] op_sel:[0,1,0] op_sel_hi:[1,1,1]
  v_cvt_pk_bf16_f32 v152, v92, v93
  v_cvt_pk_bf16_f32 v153, v94, v95
  v_accvgpr_read_b32 v112, a72
  v_accvgpr_read_b32 v113, a73
  v_accvgpr_read_b32 v114, a74
  v_accvgpr_read_b32 v115, a75
  v_pk_mul_f32 v[112:113], v[112:113], v[186:187] op_sel_hi:[1,0]
  v_pk_mul_f32 v[114:115], v[114:115], v[186:187] op_sel_hi:[1,0]
  v_pk_fma_f32 v[112:113], v[12:13], v[186:187], v[112:113] op_sel:[0,1,0] op_sel_hi:[1,1,1]
  v_pk_fma_f32 v[114:115], v[14:15], v[186:187], v[114:115] op_sel:[0,1,0] op_sel_hi:[1,1,1]
  v_cvt_pk_bf16_f32 v154, v112, v113
  v_cvt_pk_bf16_f32 v155, v114, v115
  buffer_store_dwordx4 v[152:155], v243, s[36:39], s45 offen sc1
  v_accvgpr_read_b32 v96, a56
  v_accvgpr_read_b32 v97, a57
  v_accvgpr_read_b32 v98, a58
  v_accvgpr_read_b32 v99, a59
  v_pk_mul_f32 v[96:97], v[96:97], v[188:189] op_sel_hi:[1,0]
  v_pk_mul_f32 v[98:99], v[98:99], v[188:189] op_sel_hi:[1,0]
  v_pk_fma_f32 v[96:97], v[16:17], v[188:189], v[96:97] op_sel:[0,1,0] op_sel_hi:[1,1,1]
  v_pk_fma_f32 v[98:99], v[18:19], v[188:189], v[98:99] op_sel:[0,1,0] op_sel_hi:[1,1,1]
  v_cvt_pk_bf16_f32 v156, v96, v97
  v_cvt_pk_bf16_f32 v157, v98, v99
  v_accvgpr_read_b32 v116, a76
  v_accvgpr_read_b32 v117, a77
  v_accvgpr_read_b32 v118, a78
  v_accvgpr_read_b32 v119, a79
  v_pk_mul_f32 v[116:117], v[116:117], v[188:189] op_sel_hi:[1,0]
  v_pk_mul_f32 v[118:119], v[118:119], v[188:189] op_sel_hi:[1,0]
  v_pk_fma_f32 v[116:117], v[200:201], v[188:189], v[116:117] op_sel:[0,1,0] op_sel_hi:[1,1,1]
  v_pk_fma_f32 v[118:119], v[202:203], v[188:189], v[118:119] op_sel:[0,1,0] op_sel_hi:[1,1,1]
  v_cvt_pk_bf16_f32 v158, v116, v117
  v_cvt_pk_bf16_f32 v159, v118, v119
  buffer_store_dwordx4 v[156:159], v244, s[36:39], s45 offen sc1
  s_mov_b32 s46, s11
  v_cmp_gt_u32 vcc, 1, v229
  s_nop 0
  s_cbranch_vccz Lcnt_ok
  v_mov_b32 v254, 0
  s_lshl_b32 s48, s40, 2
  s_mov_b32 s94, 262144
Lpoll0:
  buffer_load_dword v36, v254, s[84:87], s48 offen sc1
  s_waitcnt vmcnt(0)
  s_sub_u32 s94, s94, 1
  v_cmp_gt_u32 vcc, 1, v36
  s_cbranch_scc1 Lpoll0_x
  s_cbranch_vccnz Lpoll0
Lpoll0_x:
Lcnt_ok:
  s_add_u32 s7, s7, 2
  s_mul_i32 s5, s59, -81920
  s_add_u32 s6, s6, s5
  s_add_u32 s6, s6, 10240
  s_mov_b32 m0, s6
  s_and_b32 s7, s7, 31
  s_or_b32 s5, s7, s100
  s_mul_i32 s5, s5, 40960
  buffer_load_dwordx4 v224, s[80:83], s5 offen lds
  buffer_load_dwordx4 v225, s[80:83], s5 offen offset:1024 lds
  buffer_load_dwordx4 v226, s[80:83], s5 offen offset:2048 lds
  buffer_load_dwordx4 v227, s[80:83], s5 offen offset:3072 lds
  s_add_u32 m0, s6, 4096
  s_nop 0
  buffer_load_dwordx4 v228, s[80:83], s5 offen lds
  s_add_u32 s7, s7, 2
  s_add_u32 s6, s6, 10240
  s_mov_b32 m0, s6
  s_and_b32 s7, s7, 31
  s_or_b32 s5, s7, s100
  s_mul_i32 s5, s5, 40960
  buffer_load_dwordx4 v224, s[80:83], s5 offen lds
  buffer_load_dwordx4 v225, s[80:83], s5 offen offset:1024 lds
  buffer_load_dwordx4 v226, s[80:83], s5 offen offset:2048 lds
  buffer_load_dwordx4 v227, s[80:83], s5 offen offset:3072 lds
  s_add_u32 m0, s6, 4096
  s_nop 0
  buffer_load_dwordx4 v228, s[80:83], s5 offen lds
  v_min_u32 v254, 1, v0
  v_lshlrev_b32 v254, 30, v254
  v_mov_b32 v3, 1
  s_lshl_b32 s9, s40, 5
  s_add_u32 s9, s9, s41
  s_lshl_b32 s9, s9, 7
  s_add_u32 s9, s9, 29360128
  s_waitcnt vmcnt(10)
  s_barrier
  buffer_store_dword v3, v254, s[36:39], s9 offen sc1
  s_add_u32 s7, s7, 2
  s_add_u32 s6, s6, 10240
  s_mov_b32 m0, s6
  s_and_b32 s7, s7, 31
  s_or_b32 s5, s7, s100
  s_mul_i32 s5, s5, 40960
  buffer_load_dwordx4 v224, s[80:83], s5 offen lds
  buffer_load_dwordx4 v225, s[80:83], s5 offen offset:1024 lds
  buffer_load_dwordx4 v226, s[80:83], s5 offen offset:2048 lds
  buffer_load_dwordx4 v227, s[80:83], s5 offen offset:3072 lds
  s_add_u32 m0, s6, 4096
  s_nop 0
  buffer_load_dwordx4 v228, s[80:83], s5 offen lds
  s_add_u32 s7, s7, 2
  s_add_u32 s6, s6, 10240
  s_mov_b32 m0, s6
  s_and_b32 s7, s7, 31
  s_or_b32 s5, s7, s100
  s_mul_i32 s5, s5, 40960
  buffer_load_dwordx4 v224, s[80:83], s5 offen lds
  buffer_load_dwordx4 v225, s[80:83], s5 offen offset:1024 lds
  buffer_load_dwordx4 v226, s[80:83], s5 offen offset:2048 lds
  buffer_load_dwordx4 v227, s[80:83], s5 offen offset:3072 lds
  s_add_u32 m0, s6, 4096
  s_nop 0
  buffer_load_dwordx4 v228, s[80:83], s5 offen lds
  s_add_u32 s7, s7, 2
  s_add_u32 s6, s6, 10240
  s_mov_b32 m0, s6
  s_and_b32 s7, s7, 31
  s_or_b32 s5, s7, s100
  s_mul_i32 s5, s5, 40960
  buffer_load_dwordx4 v224, s[80:83], s5 offen lds
  buffer_load_dwordx4 v225, s[80:83], s5 offen offset:1024 lds
  buffer_load_dwordx4 v226, s[80:83], s5 offen offset:2048 lds
  buffer_load_dwordx4 v227, s[80:83], s5 offen offset:3072 lds
  s_add_u32 m0, s6, 4096
  s_nop 0
  buffer_load_dwordx4 v228, s[80:83], s5 offen lds
  s_cmp_eq_u32 s42, 3
  s_cbranch_scc0 Lpoll1_x
  s_mov_b32 s94, 262144
Lpoll1:
  buffer_load_dword v36, v255, s[36:39], s46 offen sc1
  s_waitcnt vmcnt(0)
  s_sub_u32 s94, s94, 1
  v_cmp_gt_u32 vcc, 1, v36
  s_cbranch_scc1 Lpoll1_x
  s_cbranch_vccnz Lpoll1
Lpoll1_x:
  s_barrier
  ds_read_b64_tr_b16 a[160:161], v230
  ds_read_b64_tr_b16 a[162:163], v230 offset:2560
  ds_read_b64_tr_b16 a[164:165], v231
  ds_read_b64_tr_b16 a[166:167], v231 offset:2560
  s_waitcnt lgkmcnt(2)
  v_mfma_f32_16x16x32_bf16 v[40:43], a[160:163], v[120:123], 0
  s_add_u32 s48, s3, 2
  s_and_b32 s48, s48, 31
  s_mul_i32 s48, s48, 10240
  s_add_u32 s95, s101, s48
  buffer_load_dwordx4 a[40:43], v240, s[36:39], s95 offen sc1
  v_mfma_f32_16x16x32_bf16 v[60:63], a[160:163], v[124:127], 0
  ds_read_b64_tr_b16 a[168:169], v232
  v_mfma_f32_16x16x32_bf16 v[80:83], a[160:163], v[128:131], 0
  buffer_load_dwordx4 a[44:47], v241, s[36:39], s95 offen sc1
  v_mfma_f32_16x16x32_bf16 v[100:103], a[160:163], v[132:135], 0
  ds_read_b64_tr_b16 a[170:171], v232 offset:2560
  v_mfma_f32_16x16x32_bf16 v[160:163], a[160:163], v[136:139], 0
  s_waitcnt lgkmcnt(2)
  v_mfma_f32_16x16x32_bf16 v[44:47], a[164:167], v[120:123], 0
  buffer_load_dwordx4 a[48:51], v242, s[36:39], s95 offen sc1
  v_mfma_f32_16x16x32_bf16 v[64:67], a[164:167], v[124:127], 0
  ds_read_b64_tr_b16 a[172:173], v233
  v_mfma_f32_16x16x32_bf16 v[84:87], a[164:167], v[128:131], 0
  buffer_load_dwordx4 a[52:55], v243, s[36:39], s95 offen sc1
  v_mfma_f32_16x16x32_bf16 v[104:107], a[164:167], v[132:135], 0
  ds_read_b64_tr_b16 a[174:175], v233 offset:2560
  v_mfma_f32_16x16x32_bf16 v[164:167], a[164:167], v[136:139], 0
  s_waitcnt lgkmcnt(2)
  v_mfma_f32_16x16x32_bf16 v[48:51], a[168:171], v[120:123], 0
  buffer_load_dwordx4 a[56:59], v244, s[36:39], s95 offen sc1
  v_mfma_f32_16x16x32_bf16 v[68:71], a[168:171], v[124:127], 0
  ds_read_b64_tr_b16 a[160:161], v234
  v_mfma_f32_16x16x32_bf16 v[88:91], a[168:171], v[128:131], 0
  s_add_u32 s48, s3, 3
  s_and_b32 s48, s48, 31
  s_mul_i32 s48, s48, 10240
  s_add_u32 s95, s101, s48
  buffer_load_dwordx4 a[60:63], v240, s[36:39], s95 offen sc1
  v_mfma_f32_16x16x32_bf16 v[108:111], a[168:171], v[132:135], 0
  ds_read_b64_tr_b16 a[162:163], v234 offset:2560
  v_mfma_f32_16x16x32_bf16 v[168:171], a[168:171], v[136:139], 0
  s_waitcnt lgkmcnt(2)
  v_mfma_f32_16x16x32_bf16 v[52:55], a[172:175], v[120:123], 0
  buffer_load_dwordx4 a[64:67], v241, s[36:39], s95 offen sc1
  v_mfma_f32_16x16x32_bf16 v[72:75], a[172:175], v[124:127], 0
  ds_read_b64_tr_b16 a[164:165], v230 offset:5120
  v_mfma_f32_16x16x32_bf16 v[92:95], a[172:175], v[128:131], 0
  buffer_load_dwordx4 a[68:71], v242, s[36:39], s95 offen sc1
  v_mfma_f32_16x16x32_bf16 v[112:115], a[172:175], v[132:135], 0
  ds_read_b64_tr_b16 a[166:167], v230 offset:7680
  v_mfma_f32_16x16x32_bf16 v[172:175], a[172:175], v[136:139], 0
  s_waitcnt lgkmcnt(2)
  v_mfma_f32_16x16x32_bf16 v[56:59], a[160:163], v[120:123], 0
  buffer_load_dwordx4 a[72:75], v243, s[36:39], s95 offen sc1
  v_mfma_f32_16x16x32_bf16 v[76:79], a[160:163], v[124:127], 0
  ds_read_b64_tr_b16 a[168:169], v231 offset:5120
  v_mfma_f32_16x16x32_bf16 v[96:99], a[160:163], v[128:131], 0
  buffer_load_dwordx4 a[76:79], v244, s[36:39], s95 offen sc1
  v_mfma_f32_16x16x32_bf16 v[116:119], a[160:163], v[132:135], 0
  ds_read_b64_tr_b16 a[170:171], v231 offset:7680
  v_mfma_f32_16x16x32_bf16 v[176:179], a[160:163], v[136:139], 0
  s_waitcnt lgkmcnt(2)
  v_mfma_f32_16x16x32_bf16 v[40:43], a[164:167], v[140:143], v[40:43]
  s_add_u32 s48, s3, 4
  s_and_b32 s48, s48, 31
  s_mul_i32 s48, s48, 10240
  s_add_u32 s95, s101, s48
  buffer_load_dwordx4 a[80:83], v240, s[36:39], s95 offen sc1
  v_mfma_f32_16x16x32_bf16 v[60:63], a[164:167], v[144:147], v[60:63]
  ds_read_b64_tr_b16 a[172:173], v232 offset:5120
  v_mfma_f32_16x16x32_bf16 v[80:83], a[164:167], v[148:151], v[80:83]
  v_mfma_f32_16x16x32_bf16 v[100:103], a[164:167], v[152:155], v[100:103]
  ds_read_b64_tr_b16 a[174:175], v232 offset:7680
  v_mfma_f32_16x16x32_bf16 v[160:163], a[164:167], v[156:159], v[160:163]
  s_waitcnt lgkmcnt(2)
  v_mfma_f32_16x16x32_bf16 v[44:47], a[168:171], v[140:143], v[44:47]
  buffer_load_dwordx4 a[84:87], v241, s[36:39], s95 offen sc1
  v_mfma_f32_16x16x32_bf16 v[64:67], a[168:171], v[144:147], v[64:67]
  ds_read_b64_tr_b16 a[160:161], v233 offset:5120
  v_mfma_f32_16x16x32_bf16 v[84:87], a[168:171], v[148:151], v[84:87]
  v_mfma_f32_16x16x32_bf16 v[104:107], a[168:171], v[152:155], v[104:107]
  ds_read_b64_tr_b16 a[162:163], v233 offset:7680
  v_mfma_f32_16x16x32_bf16 v[164:167], a[168:171], v[156:159], v[164:167]
  s_waitcnt lgkmcnt(2)
  v_mfma_f32_16x16x32_bf16 v[48:51], a[172:175], v[140:143], v[48:51]
  buffer_load_dwordx4 a[88:91], v242, s[36:39], s95 offen sc1
  v_mfma_f32_16x16x32_bf16 v[68:71], a[172:175], v[144:147], v[68:71]
  ds_read_b64_tr_b16 a[164:165], v234 offset:5120
  v_mfma_f32_16x16x32_bf16 v[88:91], a[172:175], v[148:151], v[88:91]
  v_mfma_f32_16x16x32_bf16 v[108:111], a[172:175], v[152:155], v[108:111]
  ds_read_b64_tr_b16 a[166:167], v234 offset:7680
  v_mfma_f32_16x16x32_bf16 v[168:171], a[172:175], v[156:159], v[168:171]
  s_waitcnt lgkmcnt(2)
  v_mfma_f32_16x16x32_bf16 v[52:55], a[160:163], v[140:143], v[52:55]
  buffer_load_dwordx4 a[92:95], v243, s[36:39], s95 offen sc1
  v_mfma_f32_16x16x32_bf16 v[72:75], a[160:163], v[144:147], v[72:75]
  ds_read_b64_tr_b16 a[168:169], v230 offset:10240
  v_mfma_f32_16x16x32_bf16 v[92:95], a[160:163], v[148:151], v[92:95]
  v_mfma_f32_16x16x32_bf16 v[112:115], a[160:163], v[152:155], v[112:115]
  ds_read_b64_tr_b16 a[170:171], v230 offset:12800
  v_mfma_f32_16x16x32_bf16 v[172:175], a[160:163], v[156:159], v[172:175]
  s_waitcnt lgkmcnt(2)
  v_mfma_f32_16x16x32_bf16 v[56:59], a[164:167], v[140:143], v[56:59]
  buffer_load_dwordx4 a[96:99], v244, s[36:39], s95 offen sc1
  v_mfma_f32_16x16x32_bf16 v[76:79], a[164:167], v[144:147], v[76:79]
  ds_read_b64_tr_b16 a[172:173], v231 offset:10240
  v_mfma_f32_16x16x32_bf16 v[96:99], a[164:167], v[148:151], v[96:99]
  v_mfma_f32_16x16x32_bf16 v[116:119], a[164:167], v[152:155], v[116:119]
  ds_read_b64_tr_b16 a[174:175], v231 offset:12800
  v_mfma_f32_16x16x32_bf16 v[176:179], a[164:167], v[156:159], v[176:179]
  s_waitcnt vmcnt(10) lgkmcnt(2)
  v_mfma_f32_16x16x32_bf16 v[40:43], a[168:171], a[40:43], v[40:43]
  s_add_u32 s48, s3, 5
  s_and_b32 s48, s48, 31
  s_mul_i32 s48, s48, 10240
  s_add_u32 s95, s101, s48
  buffer_load_dwordx4 a[0:3], v240, s[36:39], s95 offen sc1
  v_mfma_f32_16x16x32_bf16 v[60:63], a[168:171], a[44:47], v[60:63]
  ds_read_b64_tr_b16 a[160:161], v232 offset:10240
  v_mfma_f32_16x16x32_bf16 v[80:83], a[168:171], a[48:51], v[80:83]
  v_mfma_f32_16x16x32_bf16 v[100:103], a[168:171], a[52:55], v[100:103]
  ds_read_b64_tr_b16 a[162:163], v232 offset:12800
  v_mfma_f32_16x16x32_bf16 v[160:163], a[168:171], a[56:59], v[160:163]
  s_waitcnt lgkmcnt(2)
  v_mfma_f32_16x16x32_bf16 v[44:47], a[172:175], a[40:43], v[44:47]
  buffer_load_dwordx4 a[4:7], v241, s[36:39], s95 offen sc1
  v_mfma_f32_16x16x32_bf16 v[64:67], a[172:175], a[44:47], v[64:67]
  ds_read_b64_tr_b16 a[164:165], v233 offset:10240
  v_mfma_f32_16x16x32_bf16 v[84:87], a[172:175], a[48:51], v[84:87]
  v_mfma_f32_16x16x32_bf16 v[104:107], a[172:175], a[52:55], v[104:107]
  ds_read_b64_tr_b16 a[166:167], v233 offset:12800
  v_mfma_f32_16x16x32_bf16 v[164:167], a[172:175], a[56:59], v[164:167]
  s_waitcnt lgkmcnt(2)
  v_mfma_f32_16x16x32_bf16 v[48:51], a[160:163], a[40:43], v[48:51]
  buffer_load_dwordx4 a[8:11], v242, s[36:39], s95 offen sc1
  v_mfma_f32_16x16x32_bf16 v[68:71], a[160:163], a[44:47], v[68:71]
  ds_read_b64_tr_b16 a[168:169], v234 offset:10240
  v_mfma_f32_16x16x32_bf16 v[88:91], a[160:163], a[48:51], v[88:91]
  v_mfma_f32_16x16x32_bf16 v[108:111], a[160:163], a[52:55], v[108:111]
  ds_read_b64_tr_b16 a[170:171], v234 offset:12800
  v_mfma_f32_16x16x32_bf16 v[168:171], a[160:163], a[56:59], v[168:171]
  s_waitcnt lgkmcnt(2)
  v_mfma_f32_16x16x32_bf16 v[52:55], a[164:167], a[40:43], v[52:55]
  buffer_load_dwordx4 a[12:15], v243, s[36:39], s95 offen sc1
  v_mfma_f32_16x16x32_bf16 v[72:75], a[164:167], a[44:47], v[72:75]
  ds_read_b64_tr_b16 a[172:173], v230 offset:15360
  v_mfma_f32_16x16x32_bf16 v[92:95], a[164:167], a[48:51], v[92:95]
  v_mfma_f32_16x16x32_bf16 v[112:115], a[164:167], a[52:55], v[112:115]
  ds_read_b64_tr_b16 a[174:175], v230 offset:17920
  v_mfma_f32_16x16x32_bf16 v[172:175], a[164:167], a[56:59], v[172:175]
  s_waitcnt lgkmcnt(2)
  v_mfma_f32_16x16x32_bf16 v[56:59], a[168:171], a[40:43], v[56:59]
  buffer_load_dwordx4 a[16:19], v244, s[36:39], s95 offen sc1
  v_mfma_f32_16x16x32_bf16 v[76:79], a[168:171], a[44:47], v[76:79]
  ds_read_b64_tr_b16 a[160:161], v231 offset:15360
  v_mfma_f32_16x16x32_bf16 v[96:99], a[168:171], a[48:51], v[96:99]
  v_mfma_f32_16x16x32_bf16 v[116:119], a[168:171], a[52:55], v[116:119]
  ds_read_b64_tr_b16 a[162:163], v231 offset:17920
  v_mfma_f32_16x16x32_bf16 v[176:179], a[168:171], a[56:59], v[176:179]
  s_waitcnt vmcnt(10) lgkmcnt(2)
  v_mfma_f32_16x16x32_bf16 v[40:43], a[172:175], a[60:63], v[40:43]
  s_add_u32 s48, s3, 6
  s_and_b32 s48, s48, 31
  s_mul_i32 s48, s48, 10240
  s_add_u32 s95, s101, s48
  buffer_load_dwordx4 a[20:23], v240, s[36:39], s95 offen sc1
  v_mfma_f32_16x16x32_bf16 v[60:63], a[172:175], a[64:67], v[60:63]
  ds_read_b64_tr_b16 a[164:165], v232 offset:15360
  v_mfma_f32_16x16x32_bf16 v[80:83], a[172:175], a[68:71], v[80:83]
  v_mfma_f32_16x16x32_bf16 v[100:103], a[172:175], a[72:75], v[100:103]
  ds_read_b64_tr_b16 a[166:167], v232 offset:17920
  v_mfma_f32_16x16x32_bf16 v[160:163], a[172:175], a[76:79], v[160:163]
  s_waitcnt lgkmcnt(2)
  v_mfma_f32_16x16x32_bf16 v[44:47], a[160:163], a[60:63], v[44:47]
  buffer_load_dwordx4 a[24:27], v241, s[36:39], s95 offen sc1
  v_mfma_f32_16x16x32_bf16 v[64:67], a[160:163], a[64:67], v[64:67]
  ds_read_b64_tr_b16 a[168:169], v233 offset:15360
  v_mfma_f32_16x16x32_bf16 v[84:87], a[160:163], a[68:71], v[84:87]
  v_mfma_f32_16x16x32_bf16 v[104:107], a[160:163], a[72:75], v[104:107]
  ds_read_b64_tr_b16 a[170:171], v233 offset:17920
  v_mfma_f32_16x16x32_bf16 v[164:167], a[160:163], a[76:79], v[164:167]
  s_waitcnt lgkmcnt(2)
  v_mfma_f32_16x16x32_bf16 v[48:51], a[164:167], a[60:63], v[48:51]
  buffer_load_dwordx4 a[28:31], v242, s[36:39], s95 offen sc1
  v_mfma_f32_16x16x32_bf16 v[68:71], a[164:167], a[64:67], v[68:71]
  ds_read_b64_tr_b16 a[172:173], v234 offset:15360
  v_mfma_f32_16x16x32_bf16 v[88:91], a[164:167], a[68:71], v[88:91]
  v_mfma_f32_16x16x32_bf16 v[108:111], a[164:167], a[72:75], v[108:111]
  ds_read_b64_tr_b16 a[174:175], v234 offset:17920
  v_mfma_f32_16x16x32_bf16 v[168:171], a[164:167], a[76:79], v[168:171]
  s_waitcnt lgkmcnt(2)
  v_mfma_f32_16x16x32_bf16 v[52:55], a[168:171], a[60:63], v[52:55]
  buffer_load_dwordx4 a[32:35], v243, s[36:39], s95 offen sc1
  v_mfma_f32_16x16x32_bf16 v[72:75], a[168:171], a[64:67], v[72:75]
  ds_read_b64_tr_b16 a[160:161], v230 offset:20480
  v_mfma_f32_16x16x32_bf16 v[92:95], a[168:171], a[68:71], v[92:95]
  v_mfma_f32_16x16x32_bf16 v[112:115], a[168:171], a[72:75], v[112:115]
  ds_read_b64_tr_b16 a[162:163], v230 offset:23040
  v_mfma_f32_16x16x32_bf16 v[172:175], a[168:171], a[76:79], v[172:175]
  s_waitcnt lgkmcnt(2)
  v_mfma_f32_16x16x32_bf16 v[56:59], a[172:175], a[60:63], v[56:59]
  buffer_load_dwordx4 a[36:39], v244, s[36:39], s95 offen sc1
  v_mfma_f32_16x16x32_bf16 v[76:79], a[172:175], a[64:67], v[76:79]
  ds_read_b64_tr_b16 a[164:165], v231 offset:20480
  v_mfma_f32_16x16x32_bf16 v[96:99], a[172:175], a[68:71], v[96:99]
  v_mfma_f32_16x16x32_bf16 v[116:119], a[172:175], a[72:75], v[116:119]
  ds_read_b64_tr_b16 a[166:167], v231 offset:23040
  v_mfma_f32_16x16x32_bf16 v[176:179], a[172:175], a[76:79], v[176:179]
  s_waitcnt vmcnt(10) lgkmcnt(2)
  v_mfma_f32_16x16x32_bf16 v[40:43], a[160:163], a[80:83], v[40:43]
  s_add_u32 s48, s3, 7
  s_and_b32 s48, s48, 31
  s_mul_i32 s48, s48, 10240
  s_add_u32 s95, s101, s48
  buffer_load_dwordx4 a[40:43], v240, s[36:39], s95 offen sc1
  v_mfma_f32_16x16x32_bf16 v[60:63], a[160:163], a[84:87], v[60:63]
  ds_read_b64_tr_b16 a[168:169], v232 offset:20480
  v_mfma_f32_16x16x32_bf16 v[80:83], a[160:163], a[88:91], v[80:83]
  v_mfma_f32_16x16x32_bf16 v[100:103], a[160:163], a[92:95], v[100:103]
  ds_read_b64_tr_b16 a[170:171], v232 offset:23040
  v_mfma_f32_16x16x32_bf16 v[160:163], a[160:163], a[96:99], v[160:163]
  s_waitcnt lgkmcnt(2)
  v_mfma_f32_16x16x32_bf16 v[44:47], a[164:167], a[80:83], v[44:47]
  buffer_load_dwordx4 a[44:47], v241, s[36:39], s95 offen sc1
  v_mfma_f32_16x16x32_bf16 v[64:67], a[164:167], a[84:87], v[64:67]
  ds_read_b64_tr_b16 a[172:173], v233 offset:20480
  v_mfma_f32_16x16x32_bf16 v[84:87], a[164:167], a[88:91], v[84:87]
  v_mfma_f32_16x16x32_bf16 v[104:107], a[164:167], a[92:95], v[104:107]
  ds_read_b64_tr_b16 a[174:175], v233 offset:23040
  v_mfma_f32_16x16x32_bf16 v[164:167], a[164:167], a[96:99], v[164:167]
  s_waitcnt lgkmcnt(2)
  v_mfma_f32_16x16x32_bf16 v[48:51], a[168:171], a[80:83], v[48:51]
  buffer_load_dwordx4 a[48:51], v242, s[36:39], s95 offen sc1
  v_mfma_f32_16x16x32_bf16 v[68:71], a[168:171], a[84:87], v[68:71]
  ds_read_b64_tr_b16 a[160:161], v234 offset:20480
  v_mfma_f32_16x16x32_bf16 v[88:91], a[168:171], a[88:91], v[88:91]
  v_mfma_f32_16x16x32_bf16 v[108:111], a[168:171], a[92:95], v[108:111]
  ds_read_b64_tr_b16 a[162:163], v234 offset:23040
  v_mfma_f32_16x16x32_bf16 v[168:171], a[168:171], a[96:99], v[168:171]
  s_waitcnt lgkmcnt(2)
  v_mfma_f32_16x16x32_bf16 v[52:55], a[172:175], a[80:83], v[52:55]
  buffer_load_dwordx4 a[52:55], v243, s[36:39], s95 offen sc1
  v_mfma_f32_16x16x32_bf16 v[72:75], a[172:175], a[84:87], v[72:75]
  ds_read_b64_tr_b16 a[164:165], v230 offset:25600
  v_mfma_f32_16x16x32_bf16 v[92:95], a[172:175], a[88:91], v[92:95]
  v_mfma_f32_16x16x32_bf16 v[112:115], a[172:175], a[92:95], v[112:115]
  ds_read_b64_tr_b16 a[166:167], v230 offset:28160
  v_mfma_f32_16x16x32_bf16 v[172:175], a[172:175], a[96:99], v[172:175]
  s_waitcnt lgkmcnt(2)
  v_mfma_f32_16x16x32_bf16 v[56:59], a[160:163], a[80:83], v[56:59]
  buffer_load_dwordx4 a[56:59], v244, s[36:39], s95 offen sc1
  v_mfma_f32_16x16x32_bf16 v[76:79], a[160:163], a[84:87], v[76:79]
  ds_read_b64_tr_b16 a[168:169], v231 offset:25600
  v_mfma_f32_16x16x32_bf16 v[96:99], a[160:163], a[88:91], v[96:99]
  v_mfma_f32_16x16x32_bf16 v[116:119], a[160:163], a[92:95], v[116:119]
  ds_read_b64_tr_b16 a[170:171], v231 offset:28160
  v_mfma_f32_16x16x32_bf16 v[176:179], a[160:163], a[96:99], v[176:179]
  s_waitcnt vmcnt(10) lgkmcnt(2)
  v_mfma_f32_16x16x32_bf16 v[40:43], a[164:167], a[0:3], v[40:43]
  s_add_u32 s48, s3, 8
  s_and_b32 s48, s48, 31
  s_mul_i32 s48, s48, 10240
  s_add_u32 s95, s101, s48
  buffer_load_dwordx4 a[60:63], v240, s[36:39], s95 offen sc1
  v_mfma_f32_16x16x32_bf16 v[60:63], a[164:167], a[4:7], v[60:63]
  ds_read_b64_tr_b16 a[172:173], v232 offset:25600
  v_mfma_f32_16x16x32_bf16 v[80:83], a[164:167], a[8:11], v[80:83]
  v_mfma_f32_16x16x32_bf16 v[100:103], a[164:167], a[12:15], v[100:103]
  ds_read_b64_tr_b16 a[174:175], v232 offset:28160
  v_mfma_f32_16x16x32_bf16 v[160:163], a[164:167], a[16:19], v[160:163]
  s_waitcnt lgkmcnt(2)
  v_mfma_f32_16x16x32_bf16 v[44:47], a[168:171], a[0:3], v[44:47]
  buffer_load_dwordx4 a[64:67], v241, s[36:39], s95 offen sc1
  v_mfma_f32_16x16x32_bf16 v[64:67], a[168:171], a[4:7], v[64:67]
  ds_read_b64_tr_b16 a[160:161], v233 offset:25600
  v_mfma_f32_16x16x32_bf16 v[84:87], a[168:171], a[8:11], v[84:87]
  v_mfma_f32_16x16x32_bf16 v[104:107], a[168:171], a[12:15], v[104:107]
  ds_read_b64_tr_b16 a[162:163], v233 offset:28160
  v_mfma_f32_16x16x32_bf16 v[164:167], a[168:171], a[16:19], v[164:167]
  s_waitcnt lgkmcnt(2)
  v_mfma_f32_16x16x32_bf16 v[48:51], a[172:175], a[0:3], v[48:51]
  buffer_load_dwordx4 a[68:71], v242, s[36:39], s95 offen sc1
  v_mfma_f32_16x16x32_bf16 v[68:71], a[172:175], a[4:7], v[68:71]
  ds_read_b64_tr_b16 a[164:165], v234 offset:25600
  v_mfma_f32_16x16x32_bf16 v[88:91], a[172:175], a[8:11], v[88:91]
  v_mfma_f32_16x16x32_bf16 v[108:111], a[172:175], a[12:15], v[108:111]
  ds_read_b64_tr_b16 a[166:167], v234 offset:28160
  v_mfma_f32_16x16x32_bf16 v[168:171], a[172:175], a[16:19], v[168:171]
  s_waitcnt lgkmcnt(2)
  v_mfma_f32_16x16x32_bf16 v[52:55], a[160:163], a[0:3], v[52:55]
  buffer_load_dwordx4 a[72:75], v243, s[36:39], s95 offen sc1
  v_mfma_f32_16x16x32_bf16 v[72:75], a[160:163], a[4:7], v[72:75]
  s_waitcnt lgkmcnt(0)
  s_barrier
  ds_read_b64_tr_b16 a[168:169], v235
  v_mfma_f32_16x16x32_bf16 v[92:95], a[160:163], a[8:11], v[92:95]
  v_mfma_f32_16x16x32_bf16 v[112:115], a[160:163], a[12:15], v[112:115]
  ds_read_b64_tr_b16 a[170:171], v235 offset:2560
  v_mfma_f32_16x16x32_bf16 v[172:175], a[160:163], a[16:19], v[172:175]
  v_mfma_f32_16x16x32_bf16 v[56:59], a[164:167], a[0:3], v[56:59]
  buffer_load_dwordx4 a[76:79], v244, s[36:39], s95 offen sc1
  v_mfma_f32_16x16x32_bf16 v[76:79], a[164:167], a[4:7], v[76:79]
  ds_read_b64_tr_b16 a[172:173], v236
  v_mfma_f32_16x16x32_bf16 v[96:99], a[164:167], a[8:11], v[96:99]
  v_mfma_f32_16x16x32_bf16 v[116:119], a[164:167], a[12:15], v[116:119]
  ds_read_b64_tr_b16 a[174:175], v236 offset:2560
  v_mfma_f32_16x16x32_bf16 v[176:179], a[164:167], a[16:19], v[176:179]
  s_waitcnt vmcnt(10) lgkmcnt(2)
  v_mfma_f32_16x16x32_bf16 v[40:43], a[168:171], a[20:23], v[40:43]
  s_add_u32 s48, s3, 9
  s_and_b32 s48, s48, 31
  s_mul_i32 s48, s48, 10240
  s_add_u32 s95, s101, s48
  buffer_load_dwordx4 a[80:83], v240, s[36:39], s95 offen sc1
  v_mfma_f32_16x16x32_bf16 v[60:63], a[168:171], a[24:27], v[60:63]
  ds_read_b64_tr_b16 a[160:161], v237
  v_mfma_f32_16x16x32_bf16 v[80:83], a[168:171], a[28:31], v[80:83]
  v_mfma_f32_16x16x32_bf16 v[100:103], a[168:171], a[32:35], v[100:103]
  ds_read_b64_tr_b16 a[162:163], v237 offset:2560
  v_mfma_f32_16x16x32_bf16 v[160:163], a[168:171], a[36:39], v[160:163]
  s_waitcnt lgkmcnt(2)
  v_mfma_f32_16x16x32_bf16 v[44:47], a[172:175], a[20:23], v[44:47]
  buffer_load_dwordx4 a[84:87], v241, s[36:39], s95 offen sc1
  v_mfma_f32_16x16x32_bf16 v[64:67], a[172:175], a[24:27], v[64:67]
  ds_read_b64_tr_b16 a[164:165], v238
  v_mfma_f32_16x16x32_bf16 v[84:87], a[172:175], a[28:31], v[84:87]
  v_mfma_f32_16x16x32_bf16 v[104:107], a[172:175], a[32:35], v[104:107]
  ds_read_b64_tr_b16 a[166:167], v238 offset:2560
  v_mfma_f32_16x16x32_bf16 v[164:167], a[172:175], a[36:39], v[164:167]
  s_waitcnt lgkmcnt(2)
  v_mfma_f32_16x16x32_bf16 v[48:51], a[160:163], a[20:23], v[48:51]
  buffer_load_dwordx4 a[88:91], v242, s[36:39], s95 offen sc1
  v_mfma_f32_16x16x32_bf16 v[68:71], a[160:163], a[24:27], v[68:71]
  ds_read_b64_tr_b16 a[168:169], v239
  v_mfma_f32_16x16x32_bf16 v[88:91], a[160:163], a[28:31], v[88:91]
  v_mfma_f32_16x16x32_bf16 v[108:111], a[160:163], a[32:35], v[108:111]
  ds_read_b64_tr_b16 a[170:171], v239 offset:2560
  v_mfma_f32_16x16x32_bf16 v[168:171], a[160:163], a[36:39], v[168:171]
  s_waitcnt lgkmcnt(2)
  v_mfma_f32_16x16x32_bf16 v[52:55], a[164:167], a[20:23], v[52:55]
  buffer_load_dwordx4 a[92:95], v243, s[36:39], s95 offen sc1
  v_mfma_f32_16x16x32_bf16 v[72:75], a[164:167], a[24:27], v[72:75]
  ds_read_b64_tr_b16 a[172:173], v235 offset:5120
  v_mfma_f32_16x16x32_bf16 v[92:95], a[164:167], a[28:31], v[92:95]
  v_mfma_f32_16x16x32_bf16 v[112:115], a[164:167], a[32:35], v[112:115]
  ds_read_b64_tr_b16 a[174:175], v235 offset:7680
  v_mfma_f32_16x16x32_bf16 v[172:175], a[164:167], a[36:39], v[172:175]
  s_waitcnt lgkmcnt(2)
  v_mfma_f32_16x16x32_bf16 v[56:59], a[168:171], a[20:23], v[56:59]
  buffer_load_dwordx4 a[96:99], v244, s[36:39], s95 offen sc1
  v_mfma_f32_16x16x32_bf16 v[76:79], a[168:171], a[24:27], v[76:79]
  ds_read_b64_tr_b16 a[160:161], v236 offset:5120
  v_mfma_f32_16x16x32_bf16 v[96:99], a[168:171], a[28:31], v[96:99]
  v_mfma_f32_16x16x32_bf16 v[116:119], a[168:171], a[32:35], v[116:119]
  ds_read_b64_tr_b16 a[162:163], v236 offset:7680
  v_mfma_f32_16x16x32_bf16 v[176:179], a[168:171], a[36:39], v[176:179]
  s_waitcnt vmcnt(10) lgkmcnt(2)
  v_mfma_f32_16x16x32_bf16 v[40:43], a[172:175], a[40:43], v[40:43]
  s_add_u32 s48, s3, 10
  s_and_b32 s48, s48, 31
  s_mul_i32 s48, s48, 10240
  s_add_u32 s95, s101, s48
  buffer_load_dwordx4 a[0:3], v240, s[36:39], s95 offen sc1
  v_mfma_f32_16x16x32_bf16 v[60:63], a[172:175], a[44:47], v[60:63]
  ds_read_b64_tr_b16 a[164:165], v237 offset:5120
  v_mfma_f32_16x16x32_bf16 v[80:83], a[172:175], a[48:51], v[80:83]
  v_mfma_f32_16x16x32_bf16 v[100:103], a[172:175], a[52:55], v[100:103]
  ds_read_b64_tr_b16 a[166:167], v237 offset:7680
  v_mfma_f32_16x16x32_bf16 v[160:163], a[172:175], a[56:59], v[160:163]
  s_waitcnt lgkmcnt(2)
  v_mfma_f32_16x16x32_bf16 v[44:47], a[160:163], a[40:43], v[44:47]
  buffer_load_dwordx4 a[4:7], v241, s[36:39], s95 offen sc1
  v_mfma_f32_16x16x32_bf16 v[64:67], a[160:163], a[44:47], v[64:67]
  ds_read_b64_tr_b16 a[168:169], v238 offset:5120
  v_mfma_f32_16x16x32_bf16 v[84:87], a[160:163], a[48:51], v[84:87]
  v_mfma_f32_16x16x32_bf16 v[104:107], a[160:163], a[52:55], v[104:107]
  ds_read_b64_tr_b16 a[170:171], v238 offset:7680
  v_mfma_f32_16x16x32_bf16 v[164:167], a[160:163], a[56:59], v[164:167]
  s_waitcnt lgkmcnt(2)
  v_mfma_f32_16x16x32_bf16 v[48:51], a[164:167], a[40:43], v[48:51]
  buffer_load_dwordx4 a[8:11], v242, s[36:39], s95 offen sc1
  v_mfma_f32_16x16x32_bf16 v[68:71], a[164:167], a[44:47], v[68:71]
  ds_read_b64_tr_b16 a[172:173], v239 offset:5120
  v_mfma_f32_16x16x32_bf16 v[88:91], a[164:167], a[48:51], v[88:91]
  v_mfma_f32_16x16x32_bf16 v[108:111], a[164:167], a[52:55], v[108:111]
  ds_read_b64_tr_b16 a[174:175], v239 offset:7680
  v_mfma_f32_16x16x32_bf16 v[168:171], a[164:167], a[56:59], v[168:171]
  s_waitcnt lgkmcnt(2)
  v_mfma_f32_16x16x32_bf16 v[52:55], a[168:171], a[40:43], v[52:55]
  buffer_load_dwordx4 a[12:15], v243, s[36:39], s95 offen sc1
  v_mfma_f32_16x16x32_bf16 v[72:75], a[168:171], a[44:47], v[72:75]
  ds_read_b64_tr_b16 a[160:161], v235 offset:10240
  v_mfma_f32_16x16x32_bf16 v[92:95], a[168:171], a[48:51], v[92:95]
  v_mfma_f32_16x16x32_bf16 v[112:115], a[168:171], a[52:55], v[112:115]
  ds_read_b64_tr_b16 a[162:163], v235 offset:12800
  v_mfma_f32_16x16x32_bf16 v[172:175], a[168:171], a[56:59], v[172:175]
  s_waitcnt lgkmcnt(2)
  v_mfma_f32_16x16x32_bf16 v[56:59], a[172:175], a[40:43], v[56:59]
  buffer_load_dwordx4 a[16:19], v244, s[36:39], s95 offen sc1
  v_mfma_f32_16x16x32_bf16 v[76:79], a[172:175], a[44:47], v[76:79]
  ds_read_b64_tr_b16 a[164:165], v236 offset:10240
  v_mfma_f32_16x16x32_bf16 v[96:99], a[172:175], a[48:51], v[96:99]
  v_mfma_f32_16x16x32_bf16 v[116:119], a[172:175], a[52:55], v[116:119]
  ds_read_b64_tr_b16 a[166:167], v236 offset:12800
  v_mfma_f32_16x16x32_bf16 v[176:179], a[172:175], a[56:59], v[176:179]
  s_waitcnt vmcnt(10) lgkmcnt(2)
  v_mfma_f32_16x16x32_bf16 v[40:43], a[160:163], a[60:63], v[40:43]
  s_add_u32 s48, s3, 11
  s_and_b32 s48, s48, 31
  s_mul_i32 s48, s48, 10240
  s_add_u32 s95, s101, s48
  buffer_load_dwordx4 a[20:23], v240, s[36:39], s95 offen sc1
  v_mfma_f32_16x16x32_bf16 v[60:63], a[160:163], a[64:67], v[60:63]
  ds_read_b64_tr_b16 a[168:169], v237 offset:10240
  v_mfma_f32_16x16x32_bf16 v[80:83], a[160:163], a[68:71], v[80:83]
  v_mfma_f32_16x16x32_bf16 v[100:103], a[160:163], a[72:75], v[100:103]
  ds_read_b64_tr_b16 a[170:171], v237 offset:12800
  v_mfma_f32_16x16x32_bf16 v[160:163], a[160:163], a[76:79], v[160:163]
  s_waitcnt lgkmcnt(2)
  v_mfma_f32_16x16x32_bf16 v[44:47], a[164:167], a[60:63], v[44:47]
  buffer_load_dwordx4 a[24:27], v241, s[36:39], s95 offen sc1
  v_mfma_f32_16x16x32_bf16 v[64:67], a[164:167], a[64:67], v[64:67]
  ds_read_b64_tr_b16 a[172:173], v238 offset:10240
  v_mfma_f32_16x16x32_bf16 v[84:87], a[164:167], a[68:71], v[84:87]
  v_mfma_f32_16x16x32_bf16 v[104:107], a[164:167], a[72:75], v[104:107]
  ds_read_b64_tr_b16 a[174:175], v238 offset:12800
  v_mfma_f32_16x16x32_bf16 v[164:167], a[164:167], a[76:79], v[164:167]
  s_waitcnt lgkmcnt(2)
  v_mfma_f32_16x16x32_bf16 v[48:51], a[168:171], a[60:63], v[48:51]
  buffer_load_dwordx4 a[28:31], v242, s[36:39], s95 offen sc1
  v_mfma_f32_16x16x32_bf16 v[68:71], a[168:171], a[64:67], v[68:71]
  ds_read_b64_tr_b16 a[160:161], v239 offset:10240
  v_mfma_f32_16x16x32_bf16 v[88:91], a[168:171], a[68:71], v[88:91]
  v_mfma_f32_16x16x32_bf16 v[108:111], a[168:171], a[72:75], v[108:111]
  ds_read_b64_tr_b16 a[162:163], v239 offset:12800
  v_mfma_f32_16x16x32_bf16 v[168:171], a[168:171], a[76:79], v[168:171]
  s_waitcnt lgkmcnt(2)
  v_mfma_f32_16x16x32_bf16 v[52:55], a[172:175], a[60:63], v[52:55]
  buffer_load_dwordx4 a[32:35], v243, s[36:39], s95 offen sc1
  v_mfma_f32_16x16x32_bf16 v[72:75], a[172:175], a[64:67], v[72:75]
  ds_read_b64_tr_b16 a[164:165], v235 offset:15360
  v_mfma_f32_16x16x32_bf16 v[92:95], a[172:175], a[68:71], v[92:95]
  v_mfma_f32_16x16x32_bf16 v[112:115], a[172:175], a[72:75], v[112:115]
  ds_read_b64_tr_b16 a[166:167], v235 offset:17920
  v_mfma_f32_16x16x32_bf16 v[172:175], a[172:175], a[76:79], v[172:175]
  s_waitcnt lgkmcnt(2)
  v_mfma_f32_16x16x32_bf16 v[56:59], a[160:163], a[60:63], v[56:59]
  buffer_load_dwordx4 a[36:39], v244, s[36:39], s95 offen sc1
  v_mfma_f32_16x16x32_bf16 v[76:79], a[160:163], a[64:67], v[76:79]
  ds_read_b64_tr_b16 a[168:169], v236 offset:15360
  v_mfma_f32_16x16x32_bf16 v[96:99], a[160:163], a[68:71], v[96:99]
  v_mfma_f32_16x16x32_bf16 v[116:119], a[160:163], a[72:75], v[116:119]
  ds_read_b64_tr_b16 a[170:171], v236 offset:17920
  v_mfma_f32_16x16x32_bf16 v[176:179], a[160:163], a[76:79], v[176:179]
  s_waitcnt vmcnt(10) lgkmcnt(2)
  v_mfma_f32_16x16x32_bf16 v[40:43], a[164:167], a[80:83], v[40:43]
  s_add_u32 s48, s3, 12
  s_and_b32 s48, s48, 31
  s_mul_i32 s48, s48, 10240
  s_add_u32 s95, s101, s48
  buffer_load_dwordx4 a[40:43], v240, s[36:39], s95 offen sc1
  v_mfma_f32_16x16x32_bf16 v[60:63], a[164:167], a[84:87], v[60:63]
  ds_read_b64_tr_b16 a[172:173], v237 offset:15360
  v_mfma_f32_16x16x32_bf16 v[80:83], a[164:167], a[88:91], v[80:83]
  v_mfma_f32_16x16x32_bf16 v[100:103], a[164:167], a[92:95], v[100:103]
  ds_read_b64_tr_b16 a[174:175], v237 offset:17920
  v_mfma_f32_16x16x32_bf16 v[160:163], a[164:167], a[96:99], v[160:163]
  s_waitcnt lgkmcnt(2)
  v_mfma_f32_16x16x32_bf16 v[44:47], a[168:171], a[80:83], v[44:47]
  buffer_load_dwordx4 a[44:47], v241, s[36:39], s95 offen sc1
  v_mfma_f32_16x16x32_bf16 v[64:67], a[168:171], a[84:87], v[64:67]
  ds_read_b64_tr_b16 a[160:161], v238 offset:15360
  v_mfma_f32_16x16x32_bf16 v[84:87], a[168:171], a[88:91], v[84:87]
  v_mfma_f32_16x16x32_bf16 v[104:107], a[168:171], a[92:95], v[104:107]
  ds_read_b64_tr_b16 a[162:163], v238 offset:17920
  v_mfma_f32_16x16x32_bf16 v[164:167], a[168:171], a[96:99], v[164:167]
  s_waitcnt lgkmcnt(2)
  v_mfma_f32_16x16x32_bf16 v[48:51], a[172:175], a[80:83], v[48:51]
  buffer_load_dwordx4 a[48:51], v242, s[36:39], s95 offen sc1
  v_mfma_f32_16x16x32_bf16 v[68:71], a[172:175], a[84:87], v[68:71]
  ds_read_b64_tr_b16 a[164:165], v239 offset:15360
  v_mfma_f32_16x16x32_bf16 v[88:91], a[172:175], a[88:91], v[88:91]
  v_mfma_f32_16x16x32_bf16 v[108:111], a[172:175], a[92:95], v[108:111]
  ds_read_b64_tr_b16 a[166:167], v239 offset:17920
  v_mfma_f32_16x16x32_bf16 v[168:171], a[172:175], a[96:99], v[168:171]
  s_waitcnt lgkmcnt(2)
  v_mfma_f32_16x16x32_bf16 v[52:55], a[160:163], a[80:83], v[52:55]
  buffer_load_dwordx4 a[52:55], v243, s[36:39], s95 offen sc1
  v_mfma_f32_16x16x32_bf16 v[72:75], a[160:163], a[84:87], v[72:75]
  ds_read_b64_tr_b16 a[168:169], v235 offset:20480
  v_mfma_f32_16x16x32_bf16 v[92:95], a[160:163], a[88:91], v[92:95]
  v_mfma_f32_16x16x32_bf16 v[112:115], a[160:163], a[92:95], v[112:115]
  ds_read_b64_tr_b16 a[170:171], v235 offset:23040
  v_mfma_f32_16x16x32_bf16 v[172:175], a[160:163], a[96:99], v[172:175]
  s_waitcnt lgkmcnt(2)
  v_mfma_f32_16x16x32_bf16 v[56:59], a[164:167], a[80:83], v[56:59]
  buffer_load_dwordx4 a[56:59], v244, s[36:39], s95 offen sc1
  v_mfma_f32_16x16x32_bf16 v[76:79], a[164:167], a[84:87], v[76:79]
  ds_read_b64_tr_b16 a[172:173], v236 offset:20480
  v_mfma_f32_16x16x32_bf16 v[96:99], a[164:167], a[88:91], v[96:99]
  v_mfma_f32_16x16x32_bf16 v[116:119], a[164:167], a[92:95], v[116:119]
  ds_read_b64_tr_b16 a[174:175], v236 offset:23040
  v_mfma_f32_16x16x32_bf16 v[176:179], a[164:167], a[96:99], v[176:179]
  s_waitcnt vmcnt(10) lgkmcnt(2)
  v_mfma_f32_16x16x32_bf16 v[40:43], a[168:171], a[0:3], v[40:43]
  s_add_u32 s48, s3, 13
  s_and_b32 s48, s48, 31
  s_mul_i32 s48, s48, 10240
  s_add_u32 s95, s101, s48
  buffer_load_dwordx4 a[60:63], v240, s[36:39], s95 offen sc1
  v_mfma_f32_16x16x32_bf16 v[60:63], a[168:171], a[4:7], v[60:63]
  ds_read_b64_tr_b16 a[160:161], v237 offset:20480
  v_mfma_f32_16x16x32_bf16 v[80:83], a[168:171], a[8:11], v[80:83]
  v_mfma_f32_16x16x32_bf16 v[100:103], a[168:171], a[12:15], v[100:103]
  ds_read_b64_tr_b16 a[162:163], v237 offset:23040
  v_mfma_f32_16x16x32_bf16 v[160:163], a[168:171], a[16:19], v[160:163]
  s_waitcnt lgkmcnt(2)
  v_mfma_f32_16x16x32_bf16 v[44:47], a[172:175], a[0:3], v[44:47]
  buffer_load_dwordx4 a[64:67], v241, s[36:39], s95 offen sc1
  v_mfma_f32_16x16x32_bf16 v[64:67], a[172:175], a[4:7], v[64:67]
  ds_read_b64_tr_b16 a[164:165], v238 offset:20480
  v_mfma_f32_16x16x32_bf16 v[84:87], a[172:175], a[8:11], v[84:87]
  v_mfma_f32_16x16x32_bf16 v[104:107], a[172:175], a[12:15], v[104:107]
  ds_read_b64_tr_b16 a[166:167], v238 offset:23040
  v_mfma_f32_16x16x32_bf16 v[164:167], a[172:175], a[16:19], v[164:167]
  s_waitcnt lgkmcnt(2)
  v_mfma_f32_16x16x32_bf16 v[48:51], a[160:163], a[0:3], v[48:51]
  buffer_load_dwordx4 a[68:71], v242, s[36:39], s95 offen sc1
  v_mfma_f32_16x16x32_bf16 v[68:71], a[160:163], a[4:7], v[68:71]
  ds_read_b64_tr_b16 a[168:169], v239 offset:20480
  v_mfma_f32_16x16x32_bf16 v[88:91], a[160:163], a[8:11], v[88:91]
  v_mfma_f32_16x16x32_bf16 v[108:111], a[160:163], a[12:15], v[108:111]
  ds_read_b64_tr_b16 a[170:171], v239 offset:23040
  v_mfma_f32_16x16x32_bf16 v[168:171], a[160:163], a[16:19], v[168:171]
  s_waitcnt lgkmcnt(2)
  v_mfma_f32_16x16x32_bf16 v[52:55], a[164:167], a[0:3], v[52:55]
  buffer_load_dwordx4 a[72:75], v243, s[36:39], s95 offen sc1
  v_mfma_f32_16x16x32_bf16 v[72:75], a[164:167], a[4:7], v[72:75]
  ds_read_b64_tr_b16 a[172:173], v235 offset:25600
  v_mfma_f32_16x16x32_bf16 v[92:95], a[164:167], a[8:11], v[92:95]
  v_mfma_f32_16x16x32_bf16 v[112:115], a[164:167], a[12:15], v[112:115]
  ds_read_b64_tr_b16 a[174:175], v235 offset:28160
  v_mfma_f32_16x16x32_bf16 v[172:175], a[164:167], a[16:19], v[172:175]
  s_waitcnt lgkmcnt(2)
  v_mfma_f32_16x16x32_bf16 v[56:59], a[168:171], a[0:3], v[56:59]
  buffer_load_dwordx4 a[76:79], v244, s[36:39], s95 offen sc1
  v_mfma_f32_16x16x32_bf16 v[76:79], a[168:171], a[4:7], v[76:79]
  ds_read_b64_tr_b16 a[160:161], v236 offset:25600
  v_mfma_f32_16x16x32_bf16 v[96:99], a[168:171], a[8:11], v[96:99]
  v_mfma_f32_16x16x32_bf16 v[116:119], a[168:171], a[12:15], v[116:119]
  ds_read_b64_tr_b16 a[162:163], v236 offset:28160
  v_mfma_f32_16x16x32_bf16 v[176:179], a[168:171], a[16:19], v[176:179]
  s_waitcnt vmcnt(10) lgkmcnt(2)
  v_mfma_f32_16x16x32_bf16 v[40:43], a[172:175], a[20:23], v[40:43]
  s_add_u32 s48, s3, 14
  s_and_b32 s48, s48, 31
  s_mul_i32 s48, s48, 10240
  s_add_u32 s95, s101, s48
  buffer_load_dwordx4 a[80:83], v240, s[36:39], s95 offen sc1
  v_mfma_f32_16x16x32_bf16 v[60:63], a[172:175], a[24:27], v[60:63]
  ds_read_b64_tr_b16 a[164:165], v237 offset:25600
  v_mfma_f32_16x16x32_bf16 v[80:83], a[172:175], a[28:31], v[80:83]
  v_mfma_f32_16x16x32_bf16 v[100:103], a[172:175], a[32:35], v[100:103]
  ds_read_b64_tr_b16 a[166:167], v237 offset:28160
  v_mfma_f32_16x16x32_bf16 v[160:163], a[172:175], a[36:39], v[160:163]
  s_waitcnt lgkmcnt(2)
  v_mfma_f32_16x16x32_bf16 v[44:47], a[160:163], a[20:23], v[44:47]
  buffer_load_dwordx4 a[84:87], v241, s[36:39], s95 offen sc1
  v_mfma_f32_16x16x32_bf16 v[64:67], a[160:163], a[24:27], v[64:67]
  ds_read_b64_tr_b16 a[168:169], v238 offset:25600
  v_mfma_f32_16x16x32_bf16 v[84:87], a[160:163], a[28:31], v[84:87]
  v_mfma_f32_16x16x32_bf16 v[104:107], a[160:163], a[32:35], v[104:107]
  ds_read_b64_tr_b16 a[170:171], v238 offset:28160
  v_mfma_f32_16x16x32_bf16 v[164:167], a[160:163], a[36:39], v[164:167]
  s_waitcnt lgkmcnt(2)
  v_mfma_f32_16x16x32_bf16 v[48:51], a[164:167], a[20:23], v[48:51]
  buffer_load_dwordx4 a[88:91], v242, s[36:39], s95 offen sc1
  v_mfma_f32_16x16x32_bf16 v[68:71], a[164:167], a[24:27], v[68:71]
  ds_read_b64_tr_b16 a[172:173], v239 offset:25600
  v_mfma_f32_16x16x32_bf16 v[88:91], a[164:167], a[28:31], v[88:91]
  v_mfma_f32_16x16x32_bf16 v[108:111], a[164:167], a[32:35], v[108:111]
  ds_read_b64_tr_b16 a[174:175], v239 offset:28160
  v_mfma_f32_16x16x32_bf16 v[168:171], a[164:167], a[36:39], v[168:171]
  s_waitcnt lgkmcnt(2)
  v_mfma_f32_16x16x32_bf16 v[52:55], a[168:171], a[20:23], v[52:55]
  buffer_load_dwordx4 a[92:95], v243, s[36:39], s95 offen sc1
  v_mfma_f32_16x16x32_bf16 v[72:75], a[168:171], a[24:27], v[72:75]
  ds_read_b64_tr_b16 a[160:161], v235 offset:30720
  v_mfma_f32_16x16x32_bf16 v[92:95], a[168:171], a[28:31], v[92:95]
  v_mfma_f32_16x16x32_bf16 v[112:115], a[168:171], a[32:35], v[112:115]
  ds_read_b64_tr_b16 a[162:163], v235 offset:33280
  v_mfma_f32_16x16x32_bf16 v[172:175], a[168:171], a[36:39], v[172:175]
  s_waitcnt lgkmcnt(2)
  v_mfma_f32_16x16x32_bf16 v[56:59], a[172:175], a[20:23], v[56:59]
  buffer_load_dwordx4 a[96:99], v244, s[36:39], s95 offen sc1
  v_mfma_f32_16x16x32_bf16 v[76:79], a[172:175], a[24:27], v[76:79]
  ds_read_b64_tr_b16 a[164:165], v236 offset:30720
  v_mfma_f32_16x16x32_bf16 v[96:99], a[172:175], a[28:31], v[96:99]
  v_mfma_f32_16x16x32_bf16 v[116:119], a[172:175], a[32:35], v[116:119]
  ds_read_b64_tr_b16 a[166:167], v236 offset:33280
  v_mfma_f32_16x16x32_bf16 v[176:179], a[172:175], a[36:39], v[176:179]
  s_waitcnt vmcnt(10) lgkmcnt(2)
  v_mfma_f32_16x16x32_bf16 v[40:43], a[160:163], a[40:43], v[40:43]
  s_add_u32 s48, s3, 15
  s_and_b32 s48, s48, 31
  s_mul_i32 s48, s48, 10240
  s_add_u32 s95, s101, s48
  buffer_load_dwordx4 a[0:3], v240, s[36:39], s95 offen sc1
  v_mfma_f32_16x16x32_bf16 v[60:63], a[160:163], a[44:47], v[60:63]
  ds_read_b64_tr_b16 a[168:169], v237 offset:30720
  v_mfma_f32_16x16x32_bf16 v[80:83], a[160:163], a[48:51], v[80:83]
  v_mfma_f32_16x16x32_bf16 v[100:103], a[160:163], a[52:55], v[100:103]
  ds_read_b64_tr_b16 a[170:171], v237 offset:33280
  v_mfma_f32_16x16x32_bf16 v[160:163], a[160:163], a[56:59], v[160:163]
  s_waitcnt lgkmcnt(2)
  v_mfma_f32_16x16x32_bf16 v[44:47], a[164:167], a[40:43], v[44:47]
  buffer_load_dwordx4 a[4:7], v241, s[36:39], s95 offen sc1
  v_mfma_f32_16x16x32_bf16 v[64:67], a[164:167], a[44:47], v[64:67]
  ds_read_b64_tr_b16 a[172:173], v238 offset:30720
  v_mfma_f32_16x16x32_bf16 v[84:87], a[164:167], a[48:51], v[84:87]
  v_mfma_f32_16x16x32_bf16 v[104:107], a[164:167], a[52:55], v[104:107]
  ds_read_b64_tr_b16 a[174:175], v238 offset:33280
  v_mfma_f32_16x16x32_bf16 v[164:167], a[164:167], a[56:59], v[164:167]
  s_waitcnt lgkmcnt(2)
  v_mfma_f32_16x16x32_bf16 v[48:51], a[168:171], a[40:43], v[48:51]
  buffer_load_dwordx4 a[8:11], v242, s[36:39], s95 offen sc1
  v_mfma_f32_16x16x32_bf16 v[68:71], a[168:171], a[44:47], v[68:71]
  ds_read_b64_tr_b16 a[160:161], v239 offset:30720
  v_mfma_f32_16x16x32_bf16 v[88:91], a[168:171], a[48:51], v[88:91]
  v_mfma_f32_16x16x32_bf16 v[108:111], a[168:171], a[52:55], v[108:111]
  ds_read_b64_tr_b16 a[162:163], v239 offset:33280
  v_mfma_f32_16x16x32_bf16 v[168:171], a[168:171], a[56:59], v[168:171]
  s_waitcnt lgkmcnt(2)
  v_mfma_f32_16x16x32_bf16 v[52:55], a[172:175], a[40:43], v[52:55]
  buffer_load_dwordx4 a[12:15], v243, s[36:39], s95 offen sc1
  v_mfma_f32_16x16x32_bf16 v[72:75], a[172:175], a[44:47], v[72:75]
  ds_read_b64_tr_b16 a[164:165], v235 offset:35840
  v_mfma_f32_16x16x32_bf16 v[92:95], a[172:175], a[48:51], v[92:95]
  v_mfma_f32_16x16x32_bf16 v[112:115], a[172:175], a[52:55], v[112:115]
  ds_read_b64_tr_b16 a[166:167], v235 offset:38400
  v_mfma_f32_16x16x32_bf16 v[172:175], a[172:175], a[56:59], v[172:175]
  s_waitcnt lgkmcnt(2)
  v_mfma_f32_16x16x32_bf16 v[56:59], a[160:163], a[40:43], v[56:59]
  buffer_load_dwordx4 a[16:19], v244, s[36:39], s95 offen sc1
  v_mfma_f32_16x16x32_bf16 v[76:79], a[160:163], a[44:47], v[76:79]
  ds_read_b64_tr_b16 a[168:169], v236 offset:35840
  v_mfma_f32_16x16x32_bf16 v[96:99], a[160:163], a[48:51], v[96:99]
  v_mfma_f32_16x16x32_bf16 v[116:119], a[160:163], a[52:55], v[116:119]
  ds_read_b64_tr_b16 a[170:171], v236 offset:38400
  v_mfma_f32_16x16x32_bf16 v[176:179], a[160:163], a[56:59], v[176:179]
  s_waitcnt vmcnt(10) lgkmcnt(2)
  v_mfma_f32_16x16x32_bf16 v[40:43], a[164:167], a[60:63], v[40:43]
  v_mfma_f32_16x16x32_bf16 v[60:63], a[164:167], a[64:67], v[60:63]
  ds_read_b64_tr_b16 a[172:173], v237 offset:35840
  v_mfma_f32_16x16x32_bf16 v[80:83], a[164:167], a[68:71], v[80:83]
  v_mfma_f32_16x16x32_bf16 v[100:103], a[164:167], a[72:75], v[100:103]
  ds_read_b64_tr_b16 a[174:175], v237 offset:38400
  v_mfma_f32_16x16x32_bf16 v[160:163], a[164:167], a[76:79], v[160:163]
  s_waitcnt lgkmcnt(2)
  v_mfma_f32_16x16x32_bf16 v[44:47], a[168:171], a[60:63], v[44:47]
  v_mfma_f32_16x16x32_bf16 v[64:67], a[168:171], a[64:67], v[64:67]
  ds_read_b64_tr_b16 a[160:161], v238 offset:35840
  v_mfma_f32_16x16x32_bf16 v[84:87], a[168:171], a[68:71], v[84:87]
  v_mfma_f32_16x16x32_bf16 v[104:107], a[168:171], a[72:75], v[104:107]
  ds_read_b64_tr_b16 a[162:163], v238 offset:38400
  v_mfma_f32_16x16x32_bf16 v[164:167], a[168:171], a[76:79], v[164:167]
  s_waitcnt lgkmcnt(2)
  v_mfma_f32_16x16x32_bf16 v[48:51], a[172:175], a[60:63], v[48:51]
  v_mfma_f32_16x16x32_bf16 v[68:71], a[172:175], a[64:67], v[68:71]
  ds_read_b64_tr_b16 a[164:165], v239 offset:35840
  v_mfma_f32_16x16x32_bf16 v[88:91], a[172:175], a[68:71], v[88:91]
  v_mfma_f32_16x16x32_bf16 v[108:111], a[172:175], a[72:75], v[108:111]
  ds_read_b64_tr_b16 a[166:167], v239 offset:38400
  v_mfma_f32_16x16x32_bf16 v[168:171], a[172:175], a[76:79], v[168:171]
  s_waitcnt lgkmcnt(2)
  v_mfma_f32_16x16x32_bf16 v[52:55], a[160:163], a[60:63], v[52:55]
  v_mfma_f32_16x16x32_bf16 v[72:75], a[160:163], a[64:67], v[72:75]
  ds_read_b64_tr_b16 a[168:169], v235 offset:40960
  v_mfma_f32_16x16x32_bf16 v[92:95], a[160:163], a[68:71], v[92:95]
  v_mfma_f32_16x16x32_bf16 v[112:115], a[160:163], a[72:75], v[112:115]
  ds_read_b64_tr_b16 a[170:171], v235 offset:43520
  v_mfma_f32_16x16x32_bf16 v[172:175], a[160:163], a[76:79], v[172:175]
  s_waitcnt lgkmcnt(2)
  v_mfma_f32_16x16x32_bf16 v[56:59], a[164:167], a[60:63], v[56:59]
  v_mfma_f32_16x16x32_bf16 v[76:79], a[164:167], a[64:67], v[76:79]
  ds_read_b64_tr_b16 a[172:173], v236 offset:40960
  v_mfma_f32_16x16x32_bf16 v[96:99], a[164:167], a[68:71], v[96:99]
  v_mfma_f32_16x16x32_bf16 v[116:119], a[164:167], a[72:75], v[116:119]
  ds_read_b64_tr_b16 a[174:175], v236 offset:43520
  v_mfma_f32_16x16x32_bf16 v[176:179], a[164:167], a[76:79], v[176:179]
  s_waitcnt vmcnt(5) lgkmcnt(2)
  v_mfma_f32_16x16x32_bf16 v[40:43], a[168:171], a[80:83], v[40:43]
  s_and_b32 s48, s42, 1
  v_mfma_f32_16x16x32_bf16 v[60:63], a[168:171], a[84:87], v[60:63]
  ds_read_b64_tr_b16 a[160:161], v237 offset:40960
  s_mul_i32 s48, s48, 13312
  v_mfma_f32_16x16x32_bf16 v[80:83], a[168:171], a[88:91], v[80:83]
  s_lshr_b32 s50, s42, 1
  v_mfma_f32_16x16x32_bf16 v[100:103], a[168:171], a[92:95], v[100:103]
  ds_read_b64_tr_b16 a[162:163], v237 offset:43520
  s_mul_i32 s50, s50, 133120
  v_mfma_f32_16x16x32_bf16 v[160:163], a[168:171], a[96:99], v[160:163]
  s_add_u32 s48, s48, s50
  s_waitcnt lgkmcnt(2)
  v_mfma_f32_16x16x32_bf16 v[44:47], a[172:175], a[80:83], v[44:47]
  v_add_u32 v210, s48, v2
  v_mfma_f32_16x16x32_bf16 v[64:67], a[172:175], a[84:87], v[64:67]
  ds_read_b64_tr_b16 a[164:165], v238 offset:40960
  s_xor_b32 s51, s42, 2
  v_mfma_f32_16x16x32_bf16 v[84:87], a[172:175], a[88:91], v[84:87]
  s_and_b32 s48, s51, 1
  v_mfma_f32_16x16x32_bf16 v[104:107], a[172:175], a[92:95], v[104:107]
  ds_read_b64_tr_b16 a[166:167], v238 offset:43520
  s_mul_i32 s48, s48, 13312
  v_mfma_f32_16x16x32_bf16 v[164:167], a[172:175], a[96:99], v[164:167]
  s_lshr_b32 s50, s51, 1
  s_waitcnt lgkmcnt(2)
  v_mfma_f32_16x16x32_bf16 v[48:51], a[160:163], a[80:83], v[48:51]
  s_mul_i32 s50, s50, 133120
  v_mfma_f32_16x16x32_bf16 v[68:71], a[160:163], a[84:87], v[68:71]
  ds_read_b64_tr_b16 a[168:169], v239 offset:40960
  s_add_u32 s48, s48, s50
  v_mfma_f32_16x16x32_bf16 v[88:91], a[160:163], a[88:91], v[88:91]
  v_add_u32 v211, s48, v2
  v_mfma_f32_16x16x32_bf16 v[108:111], a[160:163], a[92:95], v[108:111]
  ds_read_b64_tr_b16 a[170:171], v239 offset:43520
  v_mfma_f32_16x16x32_bf16 v[168:171], a[160:163], a[96:99], v[168:171]
  s_waitcnt lgkmcnt(2)
  v_mfma_f32_16x16x32_bf16 v[52:55], a[164:167], a[80:83], v[52:55]
  v_mfma_f32_16x16x32_bf16 v[72:75], a[164:167], a[84:87], v[72:75]
  ds_read_b64_tr_b16 a[172:173], v235 offset:46080
  v_mfma_f32_16x16x32_bf16 v[92:95], a[164:167], a[88:91], v[92:95]
  v_mfma_f32_16x16x32_bf16 v[112:115], a[164:167], a[92:95], v[112:115]
  ds_read_b64_tr_b16 a[174:175], v235 offset:48640
  v_mfma_f32_16x16x32_bf16 v[172:175], a[164:167], a[96:99], v[172:175]
  s_waitcnt lgkmcnt(2)
  v_mfma_f32_16x16x32_bf16 v[56:59], a[168:171], a[80:83], v[56:59]
  v_mfma_f32_16x16x32_bf16 v[76:79], a[168:171], a[84:87], v[76:79]
  ds_read_b64_tr_b16 a[160:161], v236 offset:46080
  v_mfma_f32_16x16x32_bf16 v[96:99], a[168:171], a[88:91], v[96:99]
  v_mfma_f32_16x16x32_bf16 v[116:119], a[168:171], a[92:95], v[116:119]
  ds_read_b64_tr_b16 a[162:163], v236 offset:48640
  v_mfma_f32_16x16x32_bf16 v[176:179], a[168:171], a[96:99], v[176:179]
  s_waitcnt vmcnt(0) lgkmcnt(2)
  v_mfma_f32_16x16x32_bf16 v[40:43], a[172:175], a[0:3], v[40:43]
  v_mfma_f32_16x16x32_bf16 v[60:63], a[172:175], a[4:7], v[60:63]
  ds_read_b64_tr_b16 a[164:165], v237 offset:46080
  v_mfma_f32_16x16x32_bf16 v[80:83], a[172:175], a[8:11], v[80:83]
  v_mfma_f32_16x16x32_bf16 v[100:103], a[172:175], a[12:15], v[100:103]
  ds_read_b64_tr_b16 a[166:167], v237 offset:48640
  v_mfma_f32_16x16x32_bf16 v[160:163], a[172:175], a[16:19], v[160:163]
  s_waitcnt lgkmcnt(2)
  v_mfma_f32_16x16x32_bf16 v[44:47], a[160:163], a[0:3], v[44:47]
  v_mfma_f32_16x16x32_bf16 v[64:67], a[160:163], a[4:7], v[64:67]
  ds_read_b64_tr_b16 a[168:169], v238 offset:46080
  v_mfma_f32_16x16x32_bf16 v[84:87], a[160:163], a[8:11], v[84:87]
  v_mfma_f32_16x16x32_bf16 v[104:107], a[160:163], a[12:15], v[104:107]
  ds_read_b64_tr_b16 a[170:171], v238 offset:48640
  v_mfma_f32_16x16x32_bf16 v[164:167], a[160:163], a[16:19], v[164:167]
  s_waitcnt lgkmcnt(2)
  v_mfma_f32_16x16x32_bf16 v[48:51], a[164:167], a[0:3], v[48:51]
  v_mfma_f32_16x16x32_bf16 v[68:71], a[164:167], a[4:7], v[68:71]
  ds_read_b64_tr_b16 a[172:173], v239 offset:46080
  ds_write_b128 v210, v[100:103] offset:3072
  v_mfma_f32_16x16x32_bf16 v[88:91], a[164:167], a[8:11], v[88:91]
  ds_write_b128 v210, v[160:163] offset:8192
  v_mfma_f32_16x16x32_bf16 v[108:111], a[164:167], a[12:15], v[108:111]
  ds_read_b64_tr_b16 a[174:175], v239 offset:48640
  v_mfma_f32_16x16x32_bf16 v[168:171], a[164:167], a[16:19], v[168:171]
  s_waitcnt lgkmcnt(4)
  v_mfma_f32_16x16x32_bf16 v[52:55], a[168:171], a[0:3], v[52:55]
  v_mfma_f32_16x16x32_bf16 v[72:75], a[168:171], a[4:7], v[72:75]
  ds_write_b128 v210, v[104:107] offset:4096
  v_mfma_f32_16x16x32_bf16 v[92:95], a[168:171], a[8:11], v[92:95]
  ds_write_b128 v210, v[164:167] offset:9216
  v_mfma_f32_16x16x32_bf16 v[112:115], a[168:171], a[12:15], v[112:115]
  v_mfma_f32_16x16x32_bf16 v[172:175], a[168:171], a[16:19], v[172:175]
  s_waitcnt lgkmcnt(2)
  v_mfma_f32_16x16x32_bf16 v[56:59], a[172:175], a[0:3], v[56:59]
  ds_write_b128 v210, v[88:91]
  v_mfma_f32_16x16x32_bf16 v[76:79], a[172:175], a[4:7], v[76:79]
  ds_write_b128 v210, v[108:111] offset:5120
  v_mfma_f32_16x16x32_bf16 v[96:99], a[172:175], a[8:11], v[96:99]
  ds_write_b128 v210, v[168:171] offset:10240
  v_mfma_f32_16x16x32_bf16 v[116:119], a[172:175], a[12:15], v[116:119]
  v_mfma_f32_16x16x32_bf16 v[176:179], a[172:175], a[16:19], v[176:179]
  ds_write_b128 v210, v[92:95] offset:1024
  ds_write_b128 v210, v[112:115] offset:6144
  ds_write_b128 v210, v[172:175] offset:11264
  s_nop 1
  ds_write_b128 v210, v[96:99] offset:2048
  s_nop 0
  ds_write_b128 v210, v[116:119] offset:7168
  ds_write_b128 v210, v[176:179] offset:12288
  v_lshrrev_b32 v204, 4, v1
  v_and_b32 v206, 3, v1
  v_and_b32 v207, 15, v1
  s_lshl_b32 s48, s40, 3
  s_add_u32 s48, s48, s92
  s_mul_i32 s44, s48, 106496
  s_add_u32 s44, s44, 20971520
  s_mul_i32 s48, s93, 26624
  s_add_u32 s45, s44, s48
  s_lshl_b32 s48, s58, 10
  s_add_u32 s51, s45, s48
  s_add_u32 s51, s51, 24576
  s_lshl_b32 s48, s59, 30
  v_add_u32 v38, s48, v2
  s_mul_i32 s48, s58, 12288
  s_mul_i32 s50, s59, 6144
  s_add_u32 s48, s48, s50
  s_add_u32 s45, s45, s48
  v_add_u32 v37, 4096, v2
  s_waitcnt lgkmcnt(0)
  s_barrier
  ds_read_b128 v[120:123], v211 offset:12288
  ds_read_b128 v[124:127], v211 offset:11264
  ds_read_b128 v[128:131], v211 offset:10240
  ds_read_b128 v[132:135], v211 offset:9216
  ds_read_b128 v[136:139], v211 offset:8192
  ds_read_b128 v[140:143], v211 offset:7168
  ds_read_b128 v[144:147], v211 offset:6144
  ds_read_b128 v[148:151], v211 offset:5120
  ds_read_b128 v[152:155], v211 offset:4096
  ds_read_b128 v[156:159], v211 offset:3072
  ds_read_b128 v[180:183], v211 offset:2048
  ds_read_b128 v[184:187], v211 offset:1024
  ds_read_b128 v[188:191], v211
  s_waitcnt lgkmcnt(12)
  v_pk_add_f32 v[40:41], v[40:41], v[120:121]
  v_pk_add_f32 v[42:43], v[42:43], v[122:123]
  v_cvt_pk_bf16_f32 v192, v40, v41
  v_cvt_pk_bf16_f32 v193, v42, v43
  s_waitcnt lgkmcnt(11)
  v_pk_add_f32 v[44:45], v[44:45], v[124:125]
  v_pk_add_f32 v[46:47], v[46:47], v[126:127]
  v_cvt_pk_bf16_f32 v194, v44, v45
  v_cvt_pk_bf16_f32 v195, v46, v47
  buffer_store_dwordx4 v[192:195], v2, s[36:39], s45 offen sc1
  s_waitcnt lgkmcnt(10)
  v_pk_add_f32 v[48:49], v[48:49], v[128:129]
  v_pk_add_f32 v[50:51], v[50:51], v[130:131]
  v_cvt_pk_bf16_f32 v196, v48, v49
  v_cvt_pk_bf16_f32 v197, v50, v51
  s_waitcnt lgkmcnt(9)
  v_pk_add_f32 v[52:53], v[52:53], v[132:133]
  v_pk_add_f32 v[54:55], v[54:55], v[134:135]
  v_cvt_pk_bf16_f32 v198, v52, v53
  v_cvt_pk_bf16_f32 v199, v54, v55
  buffer_store_dwordx4 v[196:199], v2, s[36:39], s45 offen offset:1024 sc1
  s_waitcnt lgkmcnt(8)
  v_pk_add_f32 v[56:57], v[56:57], v[136:137]
  v_pk_add_f32 v[58:59], v[58:59], v[138:139]
  v_cvt_pk_bf16_f32 v192, v56, v57
  v_cvt_pk_bf16_f32 v193, v58, v59
  s_waitcnt lgkmcnt(7)
  v_pk_add_f32 v[60:61], v[60:61], v[140:141]
  v_pk_add_f32 v[62:63], v[62:63], v[142:143]
  v_cvt_pk_bf16_f32 v194, v60, v61
  v_cvt_pk_bf16_f32 v195, v62, v63
  buffer_store_dwordx4 v[192:195], v2, s[36:39], s45 offen offset:2048 sc1
  s_waitcnt lgkmcnt(6)
  v_pk_add_f32 v[64:65], v[64:65], v[144:145]
  v_pk_add_f32 v[66:67], v[66:67], v[146:147]
  v_cvt_pk_bf16_f32 v196, v64, v65
  v_cvt_pk_bf16_f32 v197, v66, v67
  s_waitcnt lgkmcnt(5)
  v_pk_add_f32 v[68:69], v[68:69], v[148:149]
  v_pk_add_f32 v[70:71], v[70:71], v[150:151]
  v_cvt_pk_bf16_f32 v198, v68, v69
  v_cvt_pk_bf16_f32 v199, v70, v71
  buffer_store_dwordx4 v[196:199], v2, s[36:39], s45 offen offset:3072 sc1
  s_waitcnt lgkmcnt(4)
  v_pk_add_f32 v[72:73], v[72:73], v[152:153]
  v_pk_add_f32 v[74:75], v[74:75], v[154:155]
  v_cvt_pk_bf16_f32 v192, v72, v73
  v_cvt_pk_bf16_f32 v193, v74, v75
  s_waitcnt lgkmcnt(3)
  v_pk_add_f32 v[76:77], v[76:77], v[156:157]
  v_pk_add_f32 v[78:79], v[78:79], v[158:159]
  v_cvt_pk_bf16_f32 v194, v76, v77
  v_cvt_pk_bf16_f32 v195, v78, v79
  buffer_store_dwordx4 v[192:195], v37, s[36:39], s45 offen sc1
  s_waitcnt lgkmcnt(2)
  v_pk_add_f32 v[80:81], v[80:81], v[180:181]
  v_pk_add_f32 v[82:83], v[82:83], v[182:183]
  v_cvt_pk_bf16_f32 v196, v80, v81
  v_cvt_pk_bf16_f32 v197, v82, v83
  s_waitcnt lgkmcnt(1)
  v_pk_add_f32 v[84:85], v[84:85], v[184:185]
  v_pk_add_f32 v[86:87], v[86:87], v[186:187]
  v_cvt_pk_bf16_f32 v198, v84, v85
  v_cvt_pk_bf16_f32 v199, v86, v87
  buffer_store_dwordx4 v[196:199], v37, s[36:39], s45 offen offset:1024 sc1
  s_waitcnt lgkmcnt(0)
  v_pk_add_f32 v[88:89], v[88:89], v[188:189]
  v_pk_add_f32 v[90:91], v[90:91], v[190:191]
  v_cvt_pk_bf16_f32 v192, v88, v89
  v_cvt_pk_bf16_f32 v193, v90, v91
  buffer_store_dwordx4 v[192:195], v38, s[36:39], s51 offen sc1
  s_lshl_b32 s48, s93, 2
  s_add_u32 s48, s48, s42
  s_add_u32 s48, s48, 0
  s_lshl_b32 s56, s48, 10
  s_add_u32 s56, s56, s44
  s_mul_i32 s51, s48, 43
  s_lshr_b32 s51, s51, 8
  s_mul_i32 s95, s51, 6
  s_sub_u32 s95, s48, s95
  s_lshr_b32 s50, s51, 1
  s_and_b32 s51, s51, 1
  v_and_b32 v215, 1, v204
  s_lshl_b32 s95, s95, 1
  v_add_u32 v215, s95, v215
  s_mul_i32 s95, s51, 24
  s_mul_i32 s51, s51, -2
  s_add_u32 s51, s51, 1
  v_mul_i32_i24 v215, s51, v215
  v_add_u32 v215, s95, v215
  v_mul_u32_u24 v216, 52, v215
  v_lshrrev_b32 v216, 8, v216
  v_mul_u32_u24 v214, 5, v216
  v_sub_u32 v215, v215, v214
  v_lshl_add_u32 v216, v216, 4, v207
  s_mul_i32 s50, s50, 80
  s_mul_i32 s95, s40, 160
  s_add_u32 s50, s50, s95
  v_add_u32 v216, s50, v216
  v_mul_u32_u24 v216, 1280, v216
  v_lshl_add_u32 v216, v215, 5, v216
  v_lshrrev_b32 v214, 1, v204
  v_lshl_add_u32 v216, v214, 4, v216
  s_mul_i32 s95, s92, 160
  v_add_u32 v212, s95, v216
  s_lshl_b32 s48, s93, 2
  s_add_u32 s48, s48, s42
  s_add_u32 s48, s48, 16
  s_lshl_b32 s57, s48, 10
  s_add_u32 s57, s57, s44
  s_mul_i32 s51, s48, 43
  s_lshr_b32 s51, s51, 8
  s_mul_i32 s95, s51, 6
  s_sub_u32 s95, s48, s95
  s_lshr_b32 s50, s51, 1
  s_and_b32 s51, s51, 1
  s_cmp_ge_u32 s48, 24
  s_cselect_b32 s50, s95, s50
  s_cselect_b32 s95, 6, s95
  v_and_b32 v215, 1, v204
  s_lshl_b32 s95, s95, 1
  v_add_u32 v215, s95, v215
  v_cmp_lt_u32 vcc, 12, v215
  s_mul_i32 s95, s51, 24
  s_mul_i32 s51, s51, -2
  s_add_u32 s51, s51, 1
  v_mul_i32_i24 v215, s51, v215
  v_add_u32 v215, s95, v215
  v_mul_u32_u24 v216, 52, v215
  v_lshrrev_b32 v216, 8, v216
  v_mul_u32_u24 v214, 5, v216
  v_sub_u32 v215, v215, v214
  v_lshl_add_u32 v216, v216, 4, v207
  s_mul_i32 s50, s50, 80
  s_mul_i32 s95, s40, 160
  s_add_u32 s50, s50, s95
  v_add_u32 v216, s50, v216
  v_mul_u32_u24 v216, 1280, v216
  v_lshl_add_u32 v216, v215, 5, v216
  v_lshrrev_b32 v214, 1, v204
  v_lshl_add_u32 v216, v214, 4, v216
  s_mul_i32 s95, s92, 160
  v_add_u32 v213, s95, v216
  v_mov_b32 v214, 1073741824
  v_cndmask_b32 v213, v213, v214, vcc
  s_cmp_ge_u32 s48, 26
  s_cselect_b32 s48, 1073741824, 0
  v_add_u32 v39, s48, v2
  v_add_u32 v213, s48, v213
  s_lshl_b32 s48, s40, 5
  s_add_u32 s48, s48, s92
  s_lshl_b32 s48, s48, 7
  s_add_u32 s46, s48, 29360128
  v_max_u32 v208, 1, v206
  v_xor_b32 v208, s93, v208
  v_lshlrev_b32 v208, 10, v208
  v_min_u32 v254, 1, v0
  v_lshlrev_b32 v254, 30, v254
  v_mov_b32 v3, 2
  s_lshl_b32 s9, s40, 5
  s_add_u32 s9, s9, s41
  s_lshl_b32 s9, s9, 7
  s_add_u32 s9, s9, 29360128
  s_waitcnt vmcnt(0)
  s_barrier
  buffer_store_dword v3, v254, s[36:39], s9 offen sc1
  s_cmp_eq_u32 s42, 3
  s_cbranch_scc0 Lpoll2_x
  s_mov_b32 s94, 262144
Lpoll2:
  buffer_load_dword v36, v208, s[36:39], s46 offen sc1
  s_waitcnt vmcnt(0)
  s_sub_u32 s94, s94, 1
  v_cmp_gt_u32 vcc, 2, v36
  s_cbranch_scc1 Lpoll2_x
  s_cbranch_vccnz Lpoll2
Lpoll2_x:
  s_barrier
  buffer_load_dwordx4 v[40:43], v2, s[36:39], s56 offen sc1
  s_add_u32 s56, s56, 26624
  buffer_load_dwordx4 v[44:47], v2, s[36:39], s56 offen sc1
  s_add_u32 s56, s56, 26624
  buffer_load_dwordx4 v[48:51], v2, s[36:39], s56 offen sc1
  s_add_u32 s56, s56, 26624
  buffer_load_dwordx4 v[52:55], v2, s[36:39], s56 offen sc1
  buffer_load_dwordx4 v[56:59], v39, s[36:39], s57 offen sc1
  s_add_u32 s57, s57, 26624
  buffer_load_dwordx4 v[60:63], v39, s[36:39], s57 offen sc1
  s_add_u32 s57, s57, 26624
  buffer_load_dwordx4 v[64:67], v39, s[36:39], s57 offen sc1
  s_add_u32 s57, s57, 26624
  buffer_load_dwordx4 v[68:71], v39, s[36:39], s57 offen sc1
  s_mov_b32 s48, 0xffff0000
  s_waitcnt vmcnt(7)
  v_lshlrev_b32 v80, 16, v40
  v_and_b32 v81, s48, v40
  v_lshlrev_b32 v82, 16, v41
  v_and_b32 v83, s48, v41
  v_lshlrev_b32 v84, 16, v42
  v_and_b32 v85, s48, v42
  v_lshlrev_b32 v86, 16, v43
  v_and_b32 v87, s48, v43
  s_waitcnt vmcnt(6)
  v_lshlrev_b32 v88, 16, v44
  v_and_b32 v89, s48, v44
  v_lshlrev_b32 v90, 16, v45
  v_and_b32 v91, s48, v45
  v_lshlrev_b32 v92, 16, v46
  v_and_b32 v93, s48, v46
  v_lshlrev_b32 v94, 16, v47
  v_and_b32 v95, s48, v47
  v_pk_add_f32 v[80:81], v[80:81], v[88:89]
  v_pk_add_f32 v[82:83], v[82:83], v[90:91]
  v_pk_add_f32 v[84:85], v[84:85], v[92:93]
  v_pk_add_f32 v[86:87], v[86:87], v[94:95]
  s_waitcnt vmcnt(5)
  v_lshlrev_b32 v88, 16, v48
  v_and_b32 v89, s48, v48
  v_lshlrev_b32 v90, 16, v49
  v_and_b32 v91, s48, v49
  v_lshlrev_b32 v92, 16, v50
  v_and_b32 v93, s48, v50
  v_lshlrev_b32 v94, 16, v51
  v_and_b32 v95, s48, v51
  v_pk_add_f32 v[80:81], v[80:81], v[88:89]
  v_pk_add_f32 v[82:83], v[82:83], v[90:91]
  v_pk_add_f32 v[84:85], v[84:85], v[92:93]
  v_pk_add_f32 v[86:87], v[86:87], v[94:95]
  s_waitcnt vmcnt(4)
  v_lshlrev_b32 v88, 16, v52
  v_and_b32 v89, s48, v52
  v_lshlrev_b32 v90, 16, v53
  v_and_b32 v91, s48, v53
  v_lshlrev_b32 v92, 16, v54
  v_and_b32 v93, s48, v54
  v_lshlrev_b32 v94, 16, v55
  v_and_b32 v95, s48, v55
  v_pk_add_f32 v[80:81], v[80:81], v[88:89]
  v_pk_add_f32 v[82:83], v[82:83], v[90:91]
  v_pk_add_f32 v[84:85], v[84:85], v[92:93]
  v_pk_add_f32 v[86:87], v[86:87], v[94:95]
  v_cvt_pk_bf16_f32 v96, v80, v81
  v_cvt_pk_bf16_f32 v97, v82, v83
  v_cvt_pk_bf16_f32 v98, v84, v85
  v_cvt_pk_bf16_f32 v99, v86, v87
  s_nop 0
  v_permlane16_swap_b32 v96, v98
  v_permlane16_swap_b32 v97, v99
  buffer_store_dwordx4 v[96:99], v212, s[88:91], 0 offen
  s_waitcnt vmcnt(4)
  v_lshlrev_b32 v104, 16, v56
  v_and_b32 v105, s48, v56
  v_lshlrev_b32 v106, 16, v57
  v_and_b32 v107, s48, v57
  v_lshlrev_b32 v108, 16, v58
  v_and_b32 v109, s48, v58
  v_lshlrev_b32 v110, 16, v59
  v_and_b32 v111, s48, v59
  s_waitcnt vmcnt(3)
  v_lshlrev_b32 v112, 16, v60
  v_and_b32 v113, s48, v60
  v_lshlrev_b32 v114, 16, v61
  v_and_b32 v115, s48, v61
  v_lshlrev_b32 v116, 16, v62
  v_and_b32 v117, s48, v62
  v_lshlrev_b32 v118, 16, v63
  v_and_b32 v119, s48, v63
  v_pk_add_f32 v[104:105], v[104:105], v[112:113]
  v_pk_add_f32 v[106:107], v[106:107], v[114:115]
  v_pk_add_f32 v[108:109], v[108:109], v[116:117]
  v_pk_add_f32 v[110:111], v[110:111], v[118:119]
  s_waitcnt vmcnt(2)
  v_lshlrev_b32 v112, 16, v64
  v_and_b32 v113, s48, v64
  v_lshlrev_b32 v114, 16, v65
  v_and_b32 v115, s48, v65
  v_lshlrev_b32 v116, 16, v66
  v_and_b32 v117, s48, v66
  v_lshlrev_b32 v118, 16, v67
  v_and_b32 v119, s48, v67
  v_pk_add_f32 v[104:105], v[104:105], v[112:113]
  v_pk_add_f32 v[106:107], v[106:107], v[114:115]
  v_pk_add_f32 v[108:109], v[108:109], v[116:117]
  v_pk_add_f32 v[110:111], v[110:111], v[118:119]
  s_waitcnt vmcnt(1)
  v_lshlrev_b32 v112, 16, v68
  v_and_b32 v113, s48, v68
  v_lshlrev_b32 v114, 16, v69
  v_and_b32 v115, s48, v69
  v_lshlrev_b32 v116, 16, v70
  v_and_b32 v117, s48, v70
  v_lshlrev_b32 v118, 16, v71
  v_and_b32 v119, s48, v71
  v_pk_add_f32 v[104:105], v[104:105], v[112:113]
  v_pk_add_f32 v[106:107], v[106:107], v[114:115]
  v_pk_add_f32 v[108:109], v[108:109], v[116:117]
  v_pk_add_f32 v[110:111], v[110:111], v[118:119]
  v_cvt_pk_bf16_f32 v120, v104, v105
  v_cvt_pk_bf16_f32 v121, v106, v107
  v_cvt_pk_bf16_f32 v122, v108, v109
  v_cvt_pk_bf16_f32 v123, v110, v111
  s_nop 0
  v_permlane16_swap_b32 v120, v122
  v_permlane16_swap_b32 v121, v123
  buffer_store_dwordx4 v[120:123], v213, s[88:91], 0 offen
L1_done:
  s_endpgm
Lstub1:
  s_call_b64 s[52:53], Lslow1
  s_branch Lret1
Lstub2:
  s_call_b64 s[52:53], Lslow0
  s_branch Lret2
Lstub3:
  s_call_b64 s[52:53], Lslow1
  s_branch Lret3
Lstub4:
  s_call_b64 s[52:53], Lslow0
  s_branch Lret4
Lstub5:
  s_call_b64 s[52:53], Lslow1
  s_branch Lret5
Lstub6:
  s_call_b64 s[52:53], Lslow0
  s_branch Lret6
Lstub7:
  s_call_b64 s[52:53], Lslow1
  s_branch Lret7
Lstub8:
  s_call_b64 s[52:53], Lslow0
  s_branch Lret8
Lstub9:
  s_call_b64 s[52:53], Lslow1
  s_branch Lret9
Lstub10:
  s_call_b64 s[52:53], Lslow0
  s_branch Lret10
Lstub11:
  s_call_b64 s[52:53], Lslow1
  s_branch Lret11
Lstub12:
  s_call_b64 s[52:53], Lslow0
  s_branch Lret12
Lstub13:
  s_call_b64 s[52:53], Lslow1
  s_branch Lret13
Lstub14:
  s_call_b64 s[52:53], Lslow0
  s_branch Lret14
Lstub15:
  s_call_b64 s[52:53], Lslow1
  s_branch Lret15
Lslow0:
  s_nop 15
  v_max3_f32 v204, v40, v41, v42
  v_max3_f32 v204, v204, v43, v44
  v_max3_f32 v204, v204, v45, v46
  v_max_f32 v204, v204, v47
  v_max3_f32 v205, v48, v49, v50
  v_max3_f32 v205, v205, v51, v52
  v_max3_f32 v205, v205, v53, v54
  v_max_f32 v205, v205, v55
  v_max3_f32 v206, v56, v57, v58
  v_max3_f32 v206, v206, v59, v60
  v_max3_f32 v206, v206, v61, v62
  v_max_f32 v206, v206, v63
  v_max3_f32 v207, v64, v65, v66
  v_max3_f32 v207, v207, v67, v68
  v_max3_f32 v207, v207, v69, v70
  v_max_f32 v207, v207, v71
  v_max3_f32 v208, v72, v73, v74
  v_max3_f32 v208, v208, v75, v76
  v_max3_f32 v208, v208, v77, v78
  v_max_f32 v208, v208, v79
  v_mov_b32 v209, v204
  v_mov_b32 v210, v205
  v_mov_b32 v211, v206
  v_mov_b32 v212, v207
  v_mov_b32 v213, v208
  v_permlane32_swap_b32 v204, v209
  v_permlane32_swap_b32 v205, v210
  v_permlane32_swap_b32 v206, v211
  v_permlane32_swap_b32 v207, v212
  v_permlane32_swap_b32 v208, v213
  v_max_f32 v204, v204, v209
  v_max_f32 v205, v205, v210
  v_max_f32 v206, v206, v211
  v_max_f32 v207, v207, v212
  v_max_f32 v208, v208, v213
  v_mov_b32 v209, v204
  v_mov_b32 v210, v205
  v_mov_b32 v211, v206
  v_mov_b32 v212, v207
  v_mov_b32 v213, v208
  v_permlane16_swap_b32 v204, v209
  v_permlane16_swap_b32 v205, v210
  v_permlane16_swap_b32 v206, v211
  v_permlane16_swap_b32 v207, v212
  v_permlane16_swap_b32 v208, v213
  v_max_f32 v204, v204, v209
  v_max_f32 v205, v205, v210
  v_max_f32 v206, v206, v211
  v_max_f32 v207, v207, v212
  v_max_f32 v208, v208, v213
  v_max_f32 v204, 0, v204
  v_exp_f32 v214, -v204
  v_max_f32 v205, 0, v205
  v_exp_f32 v215, -v205
  v_max_f32 v206, 0, v206
  v_exp_f32 v216, -v206
  v_max_f32 v207, 0, v207
  v_exp_f32 v217, -v207
  v_max_f32 v208, 0, v208
  v_exp_f32 v218, -v208
  v_sub_f32 v160, v160, v204
  v_sub_f32 v161, v161, v204
  v_sub_f32 v162, v162, v204
  v_sub_f32 v163, v163, v204
  v_sub_f32 v40, v40, v204
  v_sub_f32 v80, v80, v204
  v_sub_f32 v41, v41, v204
  v_sub_f32 v81, v81, v204
  v_sub_f32 v42, v42, v204
  v_sub_f32 v82, v82, v204
  v_sub_f32 v43, v43, v204
  v_sub_f32 v83, v83, v204
  v_sub_f32 v44, v44, v204
  v_sub_f32 v84, v84, v204
  v_sub_f32 v45, v45, v204
  v_sub_f32 v85, v85, v204
  v_sub_f32 v46, v46, v204
  v_sub_f32 v86, v86, v204
  v_sub_f32 v47, v47, v204
  v_sub_f32 v87, v87, v204
  v_mul_f32 v22, v22, v214
  v_sub_f32 v164, v164, v205
  v_sub_f32 v165, v165, v205
  v_sub_f32 v166, v166, v205
  v_sub_f32 v167, v167, v205
  v_sub_f32 v48, v48, v205
  v_sub_f32 v88, v88, v205
  v_sub_f32 v49, v49, v205
  v_sub_f32 v89, v89, v205
  v_sub_f32 v50, v50, v205
  v_sub_f32 v90, v90, v205
  v_sub_f32 v51, v51, v205
  v_sub_f32 v91, v91, v205
  v_sub_f32 v52, v52, v205
  v_sub_f32 v92, v92, v205
  v_sub_f32 v53, v53, v205
  v_sub_f32 v93, v93, v205
  v_sub_f32 v54, v54, v205
  v_sub_f32 v94, v94, v205
  v_sub_f32 v55, v55, v205
  v_sub_f32 v95, v95, v205
  v_mul_f32 v23, v23, v215
  v_sub_f32 v168, v168, v206
  v_sub_f32 v169, v169, v206
  v_sub_f32 v170, v170, v206
  v_sub_f32 v171, v171, v206
  v_sub_f32 v56, v56, v206
  v_sub_f32 v96, v96, v206
  v_sub_f32 v57, v57, v206
  v_sub_f32 v97, v97, v206
  v_sub_f32 v58, v58, v206
  v_sub_f32 v98, v98, v206
  v_sub_f32 v59, v59, v206
  v_sub_f32 v99, v99, v206
  v_sub_f32 v60, v60, v206
  v_sub_f32 v100, v100, v206
  v_sub_f32 v61, v61, v206
  v_sub_f32 v101, v101, v206
  v_sub_f32 v62, v62, v206
  v_sub_f32 v102, v102, v206
  v_sub_f32 v63, v63, v206
  v_sub_f32 v103, v103, v206
  v_mul_f32 v24, v24, v216
  v_sub_f32 v172, v172, v207
  v_sub_f32 v173, v173, v207
  v_sub_f32 v174, v174, v207
  v_sub_f32 v175, v175, v207
  v_sub_f32 v64, v64, v207
  v_sub_f32 v104, v104, v207
  v_sub_f32 v65, v65, v207
  v_sub_f32 v105, v105, v207
  v_sub_f32 v66, v66, v207
  v_sub_f32 v106, v106, v207
  v_sub_f32 v67, v67, v207
  v_sub_f32 v107, v107, v207
  v_sub_f32 v68, v68, v207
  v_sub_f32 v108, v108, v207
  v_sub_f32 v69, v69, v207
  v_sub_f32 v109, v109, v207
  v_sub_f32 v70, v70, v207
  v_sub_f32 v110, v110, v207
  v_sub_f32 v71, v71, v207
  v_sub_f32 v111, v111, v207
  v_mul_f32 v25, v25, v217
  v_sub_f32 v176, v176, v208
  v_sub_f32 v177, v177, v208
  v_sub_f32 v178, v178, v208
  v_sub_f32 v179, v179, v208
  v_sub_f32 v72, v72, v208
  v_sub_f32 v112, v112, v208
  v_sub_f32 v73, v73, v208
  v_sub_f32 v113, v113, v208
  v_sub_f32 v74, v74, v208
  v_sub_f32 v114, v114, v208
  v_sub_f32 v75, v75, v208
  v_sub_f32 v115, v115, v208
  v_sub_f32 v76, v76, v208
  v_sub_f32 v116, v116, v208
  v_sub_f32 v77, v77, v208
  v_sub_f32 v117, v117, v208
  v_sub_f32 v78, v78, v208
  v_sub_f32 v118, v118, v208
  v_sub_f32 v79, v79, v208
  v_sub_f32 v119, v119, v208
  v_mul_f32 v26, v26, v218
  v_accvgpr_read_b32 v32, a0
  v_accvgpr_read_b32 v33, a1
  v_accvgpr_read_b32 v34, a2
  v_accvgpr_read_b32 v35, a3
  v_mul_f32 v32, v32, v214
  v_mul_f32 v33, v33, v214
  v_mul_f32 v34, v34, v214
  v_mul_f32 v35, v35, v214
  v_accvgpr_write_b32 a0, v32
  v_accvgpr_write_b32 a1, v33
  v_accvgpr_write_b32 a2, v34
  v_accvgpr_write_b32 a3, v35
  v_accvgpr_read_b32 v32, a4
  v_accvgpr_read_b32 v33, a5
  v_accvgpr_read_b32 v34, a6
  v_accvgpr_read_b32 v35, a7
  v_mul_f32 v32, v32, v215
  v_mul_f32 v33, v33, v215
  v_mul_f32 v34, v34, v215
  v_mul_f32 v35, v35, v215
  v_accvgpr_write_b32 a4, v32
  v_accvgpr_write_b32 a5, v33
  v_accvgpr_write_b32 a6, v34
  v_accvgpr_write_b32 a7, v35
  v_accvgpr_read_b32 v32, a8
  v_accvgpr_read_b32 v33, a9
  v_accvgpr_read_b32 v34, a10
  v_accvgpr_read_b32 v35, a11
  v_mul_f32 v32, v32, v216
  v_mul_f32 v33, v33, v216
  v_mul_f32 v34, v34, v216
  v_mul_f32 v35, v35, v216
  v_accvgpr_write_b32 a8, v32
  v_accvgpr_write_b32 a9, v33
  v_accvgpr_write_b32 a10, v34
  v_accvgpr_write_b32 a11, v35
  v_accvgpr_read_b32 v32, a12
  v_accvgpr_read_b32 v33, a13
  v_accvgpr_read_b32 v34, a14
  v_accvgpr_read_b32 v35, a15
  v_mul_f32 v32, v32, v217
  v_mul_f32 v33, v33, v217
  v_mul_f32 v34, v34, v217
  v_mul_f32 v35, v35, v217
  v_accvgpr_write_b32 a12, v32
  v_accvgpr_write_b32 a13, v33
  v_accvgpr_write_b32 a14, v34
  v_accvgpr_write_b32 a15, v35
  v_accvgpr_read_b32 v32, a16
  v_accvgpr_read_b32 v33, a17
  v_accvgpr_read_b32 v34, a18
  v_accvgpr_read_b32 v35, a19
  v_mul_f32 v32, v32, v218
  v_mul_f32 v33, v33, v218
  v_mul_f32 v34, v34, v218
  v_mul_f32 v35, v35, v218
  v_accvgpr_write_b32 a16, v32
  v_accvgpr_write_b32 a17, v33
  v_accvgpr_write_b32 a18, v34
  v_accvgpr_write_b32 a19, v35
  v_accvgpr_read_b32 v32, a20
  v_accvgpr_read_b32 v33, a21
  v_accvgpr_read_b32 v34, a22
  v_accvgpr_read_b32 v35, a23
  v_mul_f32 v32, v32, v214
  v_mul_f32 v33, v33, v214
  v_mul_f32 v34, v34, v214
  v_mul_f32 v35, v35, v214
  v_accvgpr_write_b32 a20, v32
  v_accvgpr_write_b32 a21, v33
  v_accvgpr_write_b32 a22, v34
  v_accvgpr_write_b32 a23, v35
  v_accvgpr_read_b32 v32, a24
  v_accvgpr_read_b32 v33, a25
  v_accvgpr_read_b32 v34, a26
  v_accvgpr_read_b32 v35, a27
  v_mul_f32 v32, v32, v215
  v_mul_f32 v33, v33, v215
  v_mul_f32 v34, v34, v215
  v_mul_f32 v35, v35, v215
  v_accvgpr_write_b32 a24, v32
  v_accvgpr_write_b32 a25, v33
  v_accvgpr_write_b32 a26, v34
  v_accvgpr_write_b32 a27, v35
  v_accvgpr_read_b32 v32, a28
  v_accvgpr_read_b32 v33, a29
  v_accvgpr_read_b32 v34, a30
  v_accvgpr_read_b32 v35, a31
  v_mul_f32 v32, v32, v216
  v_mul_f32 v33, v33, v216
  v_mul_f32 v34, v34, v216
  v_mul_f32 v35, v35, v216
  v_accvgpr_write_b32 a28, v32
  v_accvgpr_write_b32 a29, v33
  v_accvgpr_write_b32 a30, v34
  v_accvgpr_write_b32 a31, v35
  v_accvgpr_read_b32 v32, a32
  v_accvgpr_read_b32 v33, a33
  v_accvgpr_read_b32 v34, a34
  v_accvgpr_read_b32 v35, a35
  v_mul_f32 v32, v32, v217
  v_mul_f32 v33, v33, v217
  v_mul_f32 v34, v34, v217
  v_mul_f32 v35, v35, v217
  v_accvgpr_write_b32 a32, v32
  v_accvgpr_write_b32 a33, v33
  v_accvgpr_write_b32 a34, v34
  v_accvgpr_write_b32 a35, v35
  v_accvgpr_read_b32 v32, a36
  v_accvgpr_read_b32 v33, a37
  v_accvgpr_read_b32 v34, a38
  v_accvgpr_read_b32 v35, a39
  v_mul_f32 v32, v32, v218
  v_mul_f32 v33, v33, v218
  v_mul_f32 v34, v34, v218
  v_mul_f32 v35, v35, v218
  v_accvgpr_write_b32 a36, v32
  v_accvgpr_write_b32 a37, v33
  v_accvgpr_write_b32 a38, v34
  v_accvgpr_write_b32 a39, v35
  v_accvgpr_read_b32 v32, a40
  v_accvgpr_read_b32 v33, a41
  v_accvgpr_read_b32 v34, a42
  v_accvgpr_read_b32 v35, a43
  v_mul_f32 v32, v32, v214
  v_mul_f32 v33, v33, v214
  v_mul_f32 v34, v34, v214
  v_mul_f32 v35, v35, v214
  v_accvgpr_write_b32 a40, v32
  v_accvgpr_write_b32 a41, v33
  v_accvgpr_write_b32 a42, v34
  v_accvgpr_write_b32 a43, v35
  v_accvgpr_read_b32 v32, a44
  v_accvgpr_read_b32 v33, a45
  v_accvgpr_read_b32 v34, a46
  v_accvgpr_read_b32 v35, a47
  v_mul_f32 v32, v32, v215
  v_mul_f32 v33, v33, v215
  v_mul_f32 v34, v34, v215
  v_mul_f32 v35, v35, v215
  v_accvgpr_write_b32 a44, v32
  v_accvgpr_write_b32 a45, v33
  v_accvgpr_write_b32 a46, v34
  v_accvgpr_write_b32 a47, v35
  v_accvgpr_read_b32 v32, a48
  v_accvgpr_read_b32 v33, a49
  v_accvgpr_read_b32 v34, a50
  v_accvgpr_read_b32 v35, a51
  v_mul_f32 v32, v32, v216
  v_mul_f32 v33, v33, v216
  v_mul_f32 v34, v34, v216
  v_mul_f32 v35, v35, v216
  v_accvgpr_write_b32 a48, v32
  v_accvgpr_write_b32 a49, v33
  v_accvgpr_write_b32 a50, v34
  v_accvgpr_write_b32 a51, v35
  v_accvgpr_read_b32 v32, a52
  v_accvgpr_read_b32 v33, a53
  v_accvgpr_read_b32 v34, a54
  v_accvgpr_read_b32 v35, a55
  v_mul_f32 v32, v32, v217
  v_mul_f32 v33, v33, v217
  v_mul_f32 v34, v34, v217
  v_mul_f32 v35, v35, v217
  v_accvgpr_write_b32 a52, v32
  v_accvgpr_write_b32 a53, v33
  v_accvgpr_write_b32 a54, v34
  v_accvgpr_write_b32 a55, v35
  v_accvgpr_read_b32 v32, a56
  v_accvgpr_read_b32 v33, a57
  v_accvgpr_read_b32 v34, a58
  v_accvgpr_read_b32 v35, a59
  v_mul_f32 v32, v32, v218
  v_mul_f32 v33, v33, v218
  v_mul_f32 v34, v34, v218
  v_mul_f32 v35, v35, v218
  v_accvgpr_write_b32 a56, v32
  v_accvgpr_write_b32 a57, v33
  v_accvgpr_write_b32 a58, v34
  v_accvgpr_write_b32 a59, v35
  v_accvgpr_read_b32 v32, a60
  v_accvgpr_read_b32 v33, a61
  v_accvgpr_read_b32 v34, a62
  v_accvgpr_read_b32 v35, a63
  v_mul_f32 v32, v32, v214
  v_mul_f32 v33, v33, v214
  v_mul_f32 v34, v34, v214
  v_mul_f32 v35, v35, v214
  v_accvgpr_write_b32 a60, v32
  v_accvgpr_write_b32 a61, v33
  v_accvgpr_write_b32 a62, v34
  v_accvgpr_write_b32 a63, v35
  v_accvgpr_read_b32 v32, a64
  v_accvgpr_read_b32 v33, a65
  v_accvgpr_read_b32 v34, a66
  v_accvgpr_read_b32 v35, a67
  v_mul_f32 v32, v32, v215
  v_mul_f32 v33, v33, v215
  v_mul_f32 v34, v34, v215
  v_mul_f32 v35, v35, v215
  v_accvgpr_write_b32 a64, v32
  v_accvgpr_write_b32 a65, v33
  v_accvgpr_write_b32 a66, v34
  v_accvgpr_write_b32 a67, v35
  v_accvgpr_read_b32 v32, a68
  v_accvgpr_read_b32 v33, a69
  v_accvgpr_read_b32 v34, a70
  v_accvgpr_read_b32 v35, a71
  v_mul_f32 v32, v32, v216
  v_mul_f32 v33, v33, v216
  v_mul_f32 v34, v34, v216
  v_mul_f32 v35, v35, v216
  v_accvgpr_write_b32 a68, v32
  v_accvgpr_write_b32 a69, v33
  v_accvgpr_write_b32 a70, v34
  v_accvgpr_write_b32 a71, v35
  v_accvgpr_read_b32 v32, a72
  v_accvgpr_read_b32 v33, a73
  v_accvgpr_read_b32 v34, a74
  v_accvgpr_read_b32 v35, a75
  v_mul_f32 v32, v32, v217
  v_mul_f32 v33, v33, v217
  v_mul_f32 v34, v34, v217
  v_mul_f32 v35, v35, v217
  v_accvgpr_write_b32 a72, v32
  v_accvgpr_write_b32 a73, v33
  v_accvgpr_write_b32 a74, v34
  v_accvgpr_write_b32 a75, v35
  v_accvgpr_read_b32 v32, a76
  v_accvgpr_read_b32 v33, a77
  v_accvgpr_read_b32 v34, a78
  v_accvgpr_read_b32 v35, a79
  v_mul_f32 v32, v32, v218
  v_mul_f32 v33, v33, v218
  v_mul_f32 v34, v34, v218
  v_mul_f32 v35, v35, v218
  v_accvgpr_write_b32 a76, v32
  v_accvgpr_write_b32 a77, v33
  v_accvgpr_write_b32 a78, v34
  v_accvgpr_write_b32 a79, v35
  v_accvgpr_read_b32 v32, a80
  v_accvgpr_read_b32 v33, a81
  v_accvgpr_read_b32 v34, a82
  v_accvgpr_read_b32 v35, a83
  v_mul_f32 v32, v32, v214
  v_mul_f32 v33, v33, v214
  v_mul_f32 v34, v34, v214
  v_mul_f32 v35, v35, v214
  v_accvgpr_write_b32 a80, v32
  v_accvgpr_write_b32 a81, v33
  v_accvgpr_write_b32 a82, v34
  v_accvgpr_write_b32 a83, v35
  v_accvgpr_read_b32 v32, a84
  v_accvgpr_read_b32 v33, a85
  v_accvgpr_read_b32 v34, a86
  v_accvgpr_read_b32 v35, a87
  v_mul_f32 v32, v32, v215
  v_mul_f32 v33, v33, v215
  v_mul_f32 v34, v34, v215
  v_mul_f32 v35, v35, v215
  v_accvgpr_write_b32 a84, v32
  v_accvgpr_write_b32 a85, v33
  v_accvgpr_write_b32 a86, v34
  v_accvgpr_write_b32 a87, v35
  v_accvgpr_read_b32 v32, a88
  v_accvgpr_read_b32 v33, a89
  v_accvgpr_read_b32 v34, a90
  v_accvgpr_read_b32 v35, a91
  v_mul_f32 v32, v32, v216
  v_mul_f32 v33, v33, v216
  v_mul_f32 v34, v34, v216
  v_mul_f32 v35, v35, v216
  v_accvgpr_write_b32 a88, v32
  v_accvgpr_write_b32 a89, v33
  v_accvgpr_write_b32 a90, v34
  v_accvgpr_write_b32 a91, v35
  v_accvgpr_read_b32 v32, a92
  v_accvgpr_read_b32 v33, a93
  v_accvgpr_read_b32 v34, a94
  v_accvgpr_read_b32 v35, a95
  v_mul_f32 v32, v32, v217
  v_mul_f32 v33, v33, v217
  v_mul_f32 v34, v34, v217
  v_mul_f32 v35, v35, v217
  v_accvgpr_write_b32 a92, v32
  v_accvgpr_write_b32 a93, v33
  v_accvgpr_write_b32 a94, v34
  v_accvgpr_write_b32 a95, v35
  v_accvgpr_read_b32 v32, a96
  v_accvgpr_read_b32 v33, a97
  v_accvgpr_read_b32 v34, a98
  v_accvgpr_read_b32 v35, a99
  v_mul_f32 v32, v32, v218
  v_mul_f32 v33, v33, v218
  v_mul_f32 v34, v34, v218
  v_mul_f32 v35, v35, v218
  v_accvgpr_write_b32 a96, v32
  v_accvgpr_write_b32 a97, v33
  v_accvgpr_write_b32 a98, v34
  v_accvgpr_write_b32 a99, v35
  v_accvgpr_read_b32 v32, a100
  v_accvgpr_read_b32 v33, a101
  v_accvgpr_read_b32 v34, a102
  v_accvgpr_read_b32 v35, a103
  v_mul_f32 v32, v32, v214
  v_mul_f32 v33, v33, v214
  v_mul_f32 v34, v34, v214
  v_mul_f32 v35, v35, v214
  v_accvgpr_write_b32 a100, v32
  v_accvgpr_write_b32 a101, v33
  v_accvgpr_write_b32 a102, v34
  v_accvgpr_write_b32 a103, v35
  v_accvgpr_read_b32 v32, a104
  v_accvgpr_read_b32 v33, a105
  v_accvgpr_read_b32 v34, a106
  v_accvgpr_read_b32 v35, a107
  v_mul_f32 v32, v32, v215
  v_mul_f32 v33, v33, v215
  v_mul_f32 v34, v34, v215
  v_mul_f32 v35, v35, v215
  v_accvgpr_write_b32 a104, v32
  v_accvgpr_write_b32 a105, v33
  v_accvgpr_write_b32 a106, v34
  v_accvgpr_write_b32 a107, v35
  v_accvgpr_read_b32 v32, a108
  v_accvgpr_read_b32 v33, a109
  v_accvgpr_read_b32 v34, a110
  v_accvgpr_read_b32 v35, a111
  v_mul_f32 v32, v32, v216
  v_mul_f32 v33, v33, v216
  v_mul_f32 v34, v34, v216
  v_mul_f32 v35, v35, v216
  v_accvgpr_write_b32 a108, v32
  v_accvgpr_write_b32 a109, v33
  v_accvgpr_write_b32 a110, v34
  v_accvgpr_write_b32 a111, v35
  v_accvgpr_read_b32 v32, a112
  v_accvgpr_read_b32 v33, a113
  v_accvgpr_read_b32 v34, a114
  v_accvgpr_read_b32 v35, a115
  v_mul_f32 v32, v32, v217
  v_mul_f32 v33, v33, v217
  v_mul_f32 v34, v34, v217
  v_mul_f32 v35, v35, v217
  v_accvgpr_write_b32 a112, v32
  v_accvgpr_write_b32 a113, v33
  v_accvgpr_write_b32 a114, v34
  v_accvgpr_write_b32 a115, v35
  v_accvgpr_read_b32 v32, a116
  v_accvgpr_read_b32 v33, a117
  v_accvgpr_read_b32 v34, a118
  v_accvgpr_read_b32 v35, a119
  v_mul_f32 v32, v32, v218
  v_mul_f32 v33, v33, v218
  v_mul_f32 v34, v34, v218
  v_mul_f32 v35, v35, v218
  v_accvgpr_write_b32 a116, v32
  v_accvgpr_write_b32 a117, v33
  v_accvgpr_write_b32 a118, v34
  v_accvgpr_write_b32 a119, v35
  v_accvgpr_read_b32 v32, a120
  v_accvgpr_read_b32 v33, a121
  v_accvgpr_read_b32 v34, a122
  v_accvgpr_read_b32 v35, a123
  v_mul_f32 v32, v32, v214
  v_mul_f32 v33, v33, v214
  v_mul_f32 v34, v34, v214
  v_mul_f32 v35, v35, v214
  v_accvgpr_write_b32 a120, v32
  v_accvgpr_write_b32 a121, v33
  v_accvgpr_write_b32 a122, v34
  v_accvgpr_write_b32 a123, v35
  v_accvgpr_read_b32 v32, a124
  v_accvgpr_read_b32 v33, a125
  v_accvgpr_read_b32 v34, a126
  v_accvgpr_read_b32 v35, a127
  v_mul_f32 v32, v32, v215
  v_mul_f32 v33, v33, v215
  v_mul_f32 v34, v34, v215
  v_mul_f32 v35, v35, v215
  v_accvgpr_write_b32 a124, v32
  v_accvgpr_write_b32 a125, v33
  v_accvgpr_write_b32 a126, v34
  v_accvgpr_write_b32 a127, v35
  v_accvgpr_read_b32 v32, a128
  v_accvgpr_read_b32 v33, a129
  v_accvgpr_read_b32 v34, a130
  v_accvgpr_read_b32 v35, a131
  v_mul_f32 v32, v32, v216
  v_mul_f32 v33, v33, v216
  v_mul_f32 v34, v34, v216
  v_mul_f32 v35, v35, v216
  v_accvgpr_write_b32 a128, v32
  v_accvgpr_write_b32 a129, v33
  v_accvgpr_write_b32 a130, v34
  v_accvgpr_write_b32 a131, v35
  v_accvgpr_read_b32 v32, a132
  v_accvgpr_read_b32 v33, a133
  v_accvgpr_read_b32 v34, a134
  v_accvgpr_read_b32 v35, a135
  v_mul_f32 v32, v32, v217
  v_mul_f32 v33, v33, v217
  v_mul_f32 v34, v34, v217
  v_mul_f32 v35, v35, v217
  v_accvgpr_write_b32 a132, v32
  v_accvgpr_write_b32 a133, v33
  v_accvgpr_write_b32 a134, v34
  v_accvgpr_write_b32 a135, v35
  v_accvgpr_read_b32 v32, a136
  v_accvgpr_read_b32 v33, a137
  v_accvgpr_read_b32 v34, a138
  v_accvgpr_read_b32 v35, a139
  v_mul_f32 v32, v32, v218
  v_mul_f32 v33, v33, v218
  v_mul_f32 v34, v34, v218
  v_mul_f32 v35, v35, v218
  v_accvgpr_write_b32 a136, v32
  v_accvgpr_write_b32 a137, v33
  v_accvgpr_write_b32 a138, v34
  v_accvgpr_write_b32 a139, v35
  v_accvgpr_read_b32 v32, a140
  v_accvgpr_read_b32 v33, a141
  v_accvgpr_read_b32 v34, a142
  v_accvgpr_read_b32 v35, a143
  v_mul_f32 v32, v32, v214
  v_mul_f32 v33, v33, v214
  v_mul_f32 v34, v34, v214
  v_mul_f32 v35, v35, v214
  v_accvgpr_write_b32 a140, v32
  v_accvgpr_write_b32 a141, v33
  v_accvgpr_write_b32 a142, v34
  v_accvgpr_write_b32 a143, v35
  v_accvgpr_read_b32 v32, a144
  v_accvgpr_read_b32 v33, a145
  v_accvgpr_read_b32 v34, a146
  v_accvgpr_read_b32 v35, a147
  v_mul_f32 v32, v32, v215
  v_mul_f32 v33, v33, v215
  v_mul_f32 v34, v34, v215
  v_mul_f32 v35, v35, v215
  v_accvgpr_write_b32 a144, v32
  v_accvgpr_write_b32 a145, v33
  v_accvgpr_write_b32 a146, v34
  v_accvgpr_write_b32 a147, v35
  v_accvgpr_read_b32 v32, a148
  v_accvgpr_read_b32 v33, a149
  v_accvgpr_read_b32 v34, a150
  v_accvgpr_read_b32 v35, a151
  v_mul_f32 v32, v32, v216
  v_mul_f32 v33, v33, v216
  v_mul_f32 v34, v34, v216
  v_mul_f32 v35, v35, v216
  v_accvgpr_write_b32 a148, v32
  v_accvgpr_write_b32 a149, v33
  v_accvgpr_write_b32 a150, v34
  v_accvgpr_write_b32 a151, v35
  v_accvgpr_read_b32 v32, a152
  v_accvgpr_read_b32 v33, a153
  v_accvgpr_read_b32 v34, a154
  v_accvgpr_read_b32 v35, a155
  v_mul_f32 v32, v32, v217
  v_mul_f32 v33, v33, v217
  v_mul_f32 v34, v34, v217
  v_mul_f32 v35, v35, v217
  v_accvgpr_write_b32 a152, v32
  v_accvgpr_write_b32 a153, v33
  v_accvgpr_write_b32 a154, v34
  v_accvgpr_write_b32 a155, v35
  v_accvgpr_read_b32 v32, a156
  v_accvgpr_read_b32 v33, a157
  v_accvgpr_read_b32 v34, a158
  v_accvgpr_read_b32 v35, a159
  v_mul_f32 v32, v32, v218
  v_mul_f32 v33, v33, v218
  v_mul_f32 v34, v34, v218
  v_mul_f32 v35, v35, v218
  v_accvgpr_write_b32 a156, v32
  v_accvgpr_write_b32 a157, v33
  v_accvgpr_write_b32 a158, v34
  v_accvgpr_write_b32 a159, v35
  v_exp_f32 v32, v40
  v_exp_f32 v33, v41
  v_exp_f32 v34, v42
  v_add_f32 v27, v32, v33
  v_cvt_pk_bf16_f32 v120, v32, v33
  v_exp_f32 v35, v43
  v_add_f32 v27, v27, v34
  v_exp_f32 v32, v44
  v_add_f32 v27, v27, v35
  v_cvt_pk_bf16_f32 v121, v34, v35
  v_exp_f32 v33, v45
  v_add_f32 v27, v27, v32
  v_exp_f32 v34, v46
  v_add_f32 v27, v27, v33
  v_cvt_pk_bf16_f32 v122, v32, v33
  v_exp_f32 v35, v47
  v_add_f32 v27, v27, v34
  v_exp_f32 v32, v48
  v_add_f32 v27, v27, v35
  v_cvt_pk_bf16_f32 v123, v34, v35
  v_exp_f32 v33, v49
  v_exp_f32 v34, v50
  v_add_f32 v28, v32, v33
  v_cvt_pk_bf16_f32 v124, v32, v33
  v_exp_f32 v35, v51
  v_add_f32 v28, v28, v34
  v_exp_f32 v32, v52
  v_add_f32 v28, v28, v35
  v_cvt_pk_bf16_f32 v125, v34, v35
  v_exp_f32 v33, v53
  v_add_f32 v28, v28, v32
  v_exp_f32 v34, v54
  v_add_f32 v28, v28, v33
  v_cvt_pk_bf16_f32 v126, v32, v33
  v_exp_f32 v35, v55
  v_add_f32 v28, v28, v34
  v_exp_f32 v32, v56
  v_add_f32 v28, v28, v35
  v_cvt_pk_bf16_f32 v127, v34, v35
  v_exp_f32 v33, v57
  v_exp_f32 v34, v58
  v_add_f32 v29, v32, v33
  v_cvt_pk_bf16_f32 v128, v32, v33
  v_exp_f32 v35, v59
  v_add_f32 v29, v29, v34
  v_exp_f32 v32, v60
  v_add_f32 v29, v29, v35
  v_cvt_pk_bf16_f32 v129, v34, v35
  v_exp_f32 v33, v61
  v_add_f32 v29, v29, v32
  v_exp_f32 v34, v62
  v_add_f32 v29, v29, v33
  v_cvt_pk_bf16_f32 v130, v32, v33
  v_exp_f32 v35, v63
  v_add_f32 v29, v29, v34
  v_exp_f32 v32, v64
  v_add_f32 v29, v29, v35
  v_cvt_pk_bf16_f32 v131, v34, v35
  v_exp_f32 v33, v65
  v_exp_f32 v34, v66
  v_add_f32 v30, v32, v33
  v_cvt_pk_bf16_f32 v132, v32, v33
  v_exp_f32 v35, v67
  v_add_f32 v30, v30, v34
  v_exp_f32 v32, v68
  v_add_f32 v30, v30, v35
  v_cvt_pk_bf16_f32 v133, v34, v35
  v_exp_f32 v33, v69
  v_add_f32 v30, v30, v32
  v_exp_f32 v34, v70
  v_add_f32 v30, v30, v33
  v_cvt_pk_bf16_f32 v134, v32, v33
  v_exp_f32 v35, v71
  v_add_f32 v30, v30, v34
  v_exp_f32 v32, v72
  v_add_f32 v30, v30, v35
  v_cvt_pk_bf16_f32 v135, v34, v35
  v_exp_f32 v33, v73
  v_exp_f32 v34, v74
  v_add_f32 v31, v32, v33
  v_cvt_pk_bf16_f32 v136, v32, v33
  v_exp_f32 v35, v75
  v_add_f32 v31, v31, v34
  v_exp_f32 v32, v76
  v_add_f32 v31, v31, v35
  v_cvt_pk_bf16_f32 v137, v34, v35
  v_exp_f32 v33, v77
  v_add_f32 v31, v31, v32
  v_exp_f32 v34, v78
  v_add_f32 v31, v31, v33
  v_cvt_pk_bf16_f32 v138, v32, v33
  v_exp_f32 v35, v79
  v_add_f32 v31, v31, v34
  v_add_f32 v31, v31, v35
  v_cvt_pk_bf16_f32 v139, v34, v35
  s_nop 4
  s_setpc_b64 s[52:53]
Lslow1:
  s_nop 15
  v_max3_f32 v204, v80, v81, v82
  v_max3_f32 v204, v204, v83, v84
  v_max3_f32 v204, v204, v85, v86
  v_max_f32 v204, v204, v87
  v_max3_f32 v205, v88, v89, v90
  v_max3_f32 v205, v205, v91, v92
  v_max3_f32 v205, v205, v93, v94
  v_max_f32 v205, v205, v95
  v_max3_f32 v206, v96, v97, v98
  v_max3_f32 v206, v206, v99, v100
  v_max3_f32 v206, v206, v101, v102
  v_max_f32 v206, v206, v103
  v_max3_f32 v207, v104, v105, v106
  v_max3_f32 v207, v207, v107, v108
  v_max3_f32 v207, v207, v109, v110
  v_max_f32 v207, v207, v111
  v_max3_f32 v208, v112, v113, v114
  v_max3_f32 v208, v208, v115, v116
  v_max3_f32 v208, v208, v117, v118
  v_max_f32 v208, v208, v119
  v_mov_b32 v209, v204
  v_mov_b32 v210, v205
  v_mov_b32 v211, v206
  v_mov_b32 v212, v207
  v_mov_b32 v213, v208
  v_permlane32_swap_b32 v204, v209
  v_permlane32_swap_b32 v205, v210
  v_permlane32_swap_b32 v206, v211
  v_permlane32_swap_b32 v207, v212
  v_permlane32_swap_b32 v208, v213
  v_max_f32 v204, v204, v209
  v_max_f32 v205, v205, v210
  v_max_f32 v206, v206, v211
  v_max_f32 v207, v207, v212
  v_max_f32 v208, v208, v213
  v_mov_b32 v209, v204
  v_mov_b32 v210, v205
  v_mov_b32 v211, v206
  v_mov_b32 v212, v207
  v_mov_b32 v213, v208
  v_permlane16_swap_b32 v204, v209
  v_permlane16_swap_b32 v205, v210
  v_permlane16_swap_b32 v206, v211
  v_permlane16_swap_b32 v207, v212
  v_permlane16_swap_b32 v208, v213
  v_max_f32 v204, v204, v209
  v_max_f32 v205, v205, v210
  v_max_f32 v206, v206, v211
  v_max_f32 v207, v207, v212
  v_max_f32 v208, v208, v213
  v_max_f32 v204, 0, v204
  v_exp_f32 v214, -v204
  v_max_f32 v205, 0, v205
  v_exp_f32 v215, -v205
  v_max_f32 v206, 0, v206
  v_exp_f32 v216, -v206
  v_max_f32 v207, 0, v207
  v_exp_f32 v217, -v207
  v_max_f32 v208, 0, v208
  v_exp_f32 v218, -v208
  v_sub_f32 v160, v160, v204
  v_sub_f32 v161, v161, v204
  v_sub_f32 v162, v162, v204
  v_sub_f32 v163, v163, v204
  v_sub_f32 v80, v80, v204
  v_sub_f32 v40, v40, v204
  v_sub_f32 v81, v81, v204
  v_sub_f32 v41, v41, v204
  v_sub_f32 v82, v82, v204
  v_sub_f32 v42, v42, v204
  v_sub_f32 v83, v83, v204
  v_sub_f32 v43, v43, v204
  v_sub_f32 v84, v84, v204
  v_sub_f32 v44, v44, v204
  v_sub_f32 v85, v85, v204
  v_sub_f32 v45, v45, v204
  v_sub_f32 v86, v86, v204
  v_sub_f32 v46, v46, v204
  v_sub_f32 v87, v87, v204
  v_sub_f32 v47, v47, v204
  v_mul_f32 v22, v22, v214
  v_sub_f32 v164, v164, v205
  v_sub_f32 v165, v165, v205
  v_sub_f32 v166, v166, v205
  v_sub_f32 v167, v167, v205
  v_sub_f32 v88, v88, v205
  v_sub_f32 v48, v48, v205
  v_sub_f32 v89, v89, v205
  v_sub_f32 v49, v49, v205
  v_sub_f32 v90, v90, v205
  v_sub_f32 v50, v50, v205
  v_sub_f32 v91, v91, v205
  v_sub_f32 v51, v51, v205
  v_sub_f32 v92, v92, v205
  v_sub_f32 v52, v52, v205
  v_sub_f32 v93, v93, v205
  v_sub_f32 v53, v53, v205
  v_sub_f32 v94, v94, v205
  v_sub_f32 v54, v54, v205
  v_sub_f32 v95, v95, v205
  v_sub_f32 v55, v55, v205
  v_mul_f32 v23, v23, v215
  v_sub_f32 v168, v168, v206
  v_sub_f32 v169, v169, v206
  v_sub_f32 v170, v170, v206
  v_sub_f32 v171, v171, v206
  v_sub_f32 v96, v96, v206
  v_sub_f32 v56, v56, v206
  v_sub_f32 v97, v97, v206
  v_sub_f32 v57, v57, v206
  v_sub_f32 v98, v98, v206
  v_sub_f32 v58, v58, v206
  v_sub_f32 v99, v99, v206
  v_sub_f32 v59, v59, v206
  v_sub_f32 v100, v100, v206
  v_sub_f32 v60, v60, v206
  v_sub_f32 v101, v101, v206
  v_sub_f32 v61, v61, v206
  v_sub_f32 v102, v102, v206
  v_sub_f32 v62, v62, v206
  v_sub_f32 v103, v103, v206
  v_sub_f32 v63, v63, v206
  v_mul_f32 v24, v24, v216
  v_sub_f32 v172, v172, v207
  v_sub_f32 v173, v173, v207
  v_sub_f32 v174, v174, v207
  v_sub_f32 v175, v175, v207
  v_sub_f32 v104, v104, v207
  v_sub_f32 v64, v64, v207
  v_sub_f32 v105, v105, v207
  v_sub_f32 v65, v65, v207
  v_sub_f32 v106, v106, v207
  v_sub_f32 v66, v66, v207
  v_sub_f32 v107, v107, v207
  v_sub_f32 v67, v67, v207
  v_sub_f32 v108, v108, v207
  v_sub_f32 v68, v68, v207
  v_sub_f32 v109, v109, v207
  v_sub_f32 v69, v69, v207
  v_sub_f32 v110, v110, v207
  v_sub_f32 v70, v70, v207
  v_sub_f32 v111, v111, v207
  v_sub_f32 v71, v71, v207
  v_mul_f32 v25, v25, v217
  v_sub_f32 v176, v176, v208
  v_sub_f32 v177, v177, v208
  v_sub_f32 v178, v178, v208
  v_sub_f32 v179, v179, v208
  v_sub_f32 v112, v112, v208
  v_sub_f32 v72, v72, v208
  v_sub_f32 v113, v113, v208
  v_sub_f32 v73, v73, v208
  v_sub_f32 v114, v114, v208
  v_sub_f32 v74, v74, v208
  v_sub_f32 v115, v115, v208
  v_sub_f32 v75, v75, v208
  v_sub_f32 v116, v116, v208
  v_sub_f32 v76, v76, v208
  v_sub_f32 v117, v117, v208
  v_sub_f32 v77, v77, v208
  v_sub_f32 v118, v118, v208
  v_sub_f32 v78, v78, v208
  v_sub_f32 v119, v119, v208
  v_sub_f32 v79, v79, v208
  v_mul_f32 v26, v26, v218
  v_accvgpr_read_b32 v32, a0
  v_accvgpr_read_b32 v33, a1
  v_accvgpr_read_b32 v34, a2
  v_accvgpr_read_b32 v35, a3
  v_mul_f32 v32, v32, v214
  v_mul_f32 v33, v33, v214
  v_mul_f32 v34, v34, v214
  v_mul_f32 v35, v35, v214
  v_accvgpr_write_b32 a0, v32
  v_accvgpr_write_b32 a1, v33
  v_accvgpr_write_b32 a2, v34
  v_accvgpr_write_b32 a3, v35
  v_accvgpr_read_b32 v32, a4
  v_accvgpr_read_b32 v33, a5
  v_accvgpr_read_b32 v34, a6
  v_accvgpr_read_b32 v35, a7
  v_mul_f32 v32, v32, v215
  v_mul_f32 v33, v33, v215
  v_mul_f32 v34, v34, v215
  v_mul_f32 v35, v35, v215
  v_accvgpr_write_b32 a4, v32
  v_accvgpr_write_b32 a5, v33
  v_accvgpr_write_b32 a6, v34
  v_accvgpr_write_b32 a7, v35
  v_accvgpr_read_b32 v32, a8
  v_accvgpr_read_b32 v33, a9
  v_accvgpr_read_b32 v34, a10
  v_accvgpr_read_b32 v35, a11
  v_mul_f32 v32, v32, v216
  v_mul_f32 v33, v33, v216
  v_mul_f32 v34, v34, v216
  v_mul_f32 v35, v35, v216
  v_accvgpr_write_b32 a8, v32
  v_accvgpr_write_b32 a9, v33
  v_accvgpr_write_b32 a10, v34
  v_accvgpr_write_b32 a11, v35
  v_accvgpr_read_b32 v32, a12
  v_accvgpr_read_b32 v33, a13
  v_accvgpr_read_b32 v34, a14
  v_accvgpr_read_b32 v35, a15
  v_mul_f32 v32, v32, v217
  v_mul_f32 v33, v33, v217
  v_mul_f32 v34, v34, v217
  v_mul_f32 v35, v35, v217
  v_accvgpr_write_b32 a12, v32
  v_accvgpr_write_b32 a13, v33
  v_accvgpr_write_b32 a14, v34
  v_accvgpr_write_b32 a15, v35
  v_accvgpr_read_b32 v32, a16
  v_accvgpr_read_b32 v33, a17
  v_accvgpr_read_b32 v34, a18
  v_accvgpr_read_b32 v35, a19
  v_mul_f32 v32, v32, v218
  v_mul_f32 v33, v33, v218
  v_mul_f32 v34, v34, v218
  v_mul_f32 v35, v35, v218
  v_accvgpr_write_b32 a16, v32
  v_accvgpr_write_b32 a17, v33
  v_accvgpr_write_b32 a18, v34
  v_accvgpr_write_b32 a19, v35
  v_accvgpr_read_b32 v32, a20
  v_accvgpr_read_b32 v33, a21
  v_accvgpr_read_b32 v34, a22
  v_accvgpr_read_b32 v35, a23
  v_mul_f32 v32, v32, v214
  v_mul_f32 v33, v33, v214
  v_mul_f32 v34, v34, v214
  v_mul_f32 v35, v35, v214
  v_accvgpr_write_b32 a20, v32
  v_accvgpr_write_b32 a21, v33
  v_accvgpr_write_b32 a22, v34
  v_accvgpr_write_b32 a23, v35
  v_accvgpr_read_b32 v32, a24
  v_accvgpr_read_b32 v33, a25
  v_accvgpr_read_b32 v34, a26
  v_accvgpr_read_b32 v35, a27
  v_mul_f32 v32, v32, v215
  v_mul_f32 v33, v33, v215
  v_mul_f32 v34, v34, v215
  v_mul_f32 v35, v35, v215
  v_accvgpr_write_b32 a24, v32
  v_accvgpr_write_b32 a25, v33
  v_accvgpr_write_b32 a26, v34
  v_accvgpr_write_b32 a27, v35
  v_accvgpr_read_b32 v32, a28
  v_accvgpr_read_b32 v33, a29
  v_accvgpr_read_b32 v34, a30
  v_accvgpr_read_b32 v35, a31
  v_mul_f32 v32, v32, v216
  v_mul_f32 v33, v33, v216
  v_mul_f32 v34, v34, v216
  v_mul_f32 v35, v35, v216
  v_accvgpr_write_b32 a28, v32
  v_accvgpr_write_b32 a29, v33
  v_accvgpr_write_b32 a30, v34
  v_accvgpr_write_b32 a31, v35
  v_accvgpr_read_b32 v32, a32
  v_accvgpr_read_b32 v33, a33
  v_accvgpr_read_b32 v34, a34
  v_accvgpr_read_b32 v35, a35
  v_mul_f32 v32, v32, v217
  v_mul_f32 v33, v33, v217
  v_mul_f32 v34, v34, v217
  v_mul_f32 v35, v35, v217
  v_accvgpr_write_b32 a32, v32
  v_accvgpr_write_b32 a33, v33
  v_accvgpr_write_b32 a34, v34
  v_accvgpr_write_b32 a35, v35
  v_accvgpr_read_b32 v32, a36
  v_accvgpr_read_b32 v33, a37
  v_accvgpr_read_b32 v34, a38
  v_accvgpr_read_b32 v35, a39
  v_mul_f32 v32, v32, v218
  v_mul_f32 v33, v33, v218
  v_mul_f32 v34, v34, v218
  v_mul_f32 v35, v35, v218
  v_accvgpr_write_b32 a36, v32
  v_accvgpr_write_b32 a37, v33
  v_accvgpr_write_b32 a38, v34
  v_accvgpr_write_b32 a39, v35
  v_accvgpr_read_b32 v32, a40
  v_accvgpr_read_b32 v33, a41
  v_accvgpr_read_b32 v34, a42
  v_accvgpr_read_b32 v35, a43
  v_mul_f32 v32, v32, v214
  v_mul_f32 v33, v33, v214
  v_mul_f32 v34, v34, v214
  v_mul_f32 v35, v35, v214
  v_accvgpr_write_b32 a40, v32
  v_accvgpr_write_b32 a41, v33
  v_accvgpr_write_b32 a42, v34
  v_accvgpr_write_b32 a43, v35
  v_accvgpr_read_b32 v32, a44
  v_accvgpr_read_b32 v33, a45
  v_accvgpr_read_b32 v34, a46
  v_accvgpr_read_b32 v35, a47
  v_mul_f32 v32, v32, v215
  v_mul_f32 v33, v33, v215
  v_mul_f32 v34, v34, v215
  v_mul_f32 v35, v35, v215
  v_accvgpr_write_b32 a44, v32
  v_accvgpr_write_b32 a45, v33
  v_accvgpr_write_b32 a46, v34
  v_accvgpr_write_b32 a47, v35
  v_accvgpr_read_b32 v32, a48
  v_accvgpr_read_b32 v33, a49
  v_accvgpr_read_b32 v34, a50
  v_accvgpr_read_b32 v35, a51
  v_mul_f32 v32, v32, v216
  v_mul_f32 v33, v33, v216
  v_mul_f32 v34, v34, v216
  v_mul_f32 v35, v35, v216
  v_accvgpr_write_b32 a48, v32
  v_accvgpr_write_b32 a49, v33
  v_accvgpr_write_b32 a50, v34
  v_accvgpr_write_b32 a51, v35
  v_accvgpr_read_b32 v32, a52
  v_accvgpr_read_b32 v33, a53
  v_accvgpr_read_b32 v34, a54
  v_accvgpr_read_b32 v35, a55
  v_mul_f32 v32, v32, v217
  v_mul_f32 v33, v33, v217
  v_mul_f32 v34, v34, v217
  v_mul_f32 v35, v35, v217
  v_accvgpr_write_b32 a52, v32
  v_accvgpr_write_b32 a53, v33
  v_accvgpr_write_b32 a54, v34
  v_accvgpr_write_b32 a55, v35
  v_accvgpr_read_b32 v32, a56
  v_accvgpr_read_b32 v33, a57
  v_accvgpr_read_b32 v34, a58
  v_accvgpr_read_b32 v35, a59
  v_mul_f32 v32, v32, v218
  v_mul_f32 v33, v33, v218
  v_mul_f32 v34, v34, v218
  v_mul_f32 v35, v35, v218
  v_accvgpr_write_b32 a56, v32
  v_accvgpr_write_b32 a57, v33
  v_accvgpr_write_b32 a58, v34
  v_accvgpr_write_b32 a59, v35
  v_accvgpr_read_b32 v32, a60
  v_accvgpr_read_b32 v33, a61
  v_accvgpr_read_b32 v34, a62
  v_accvgpr_read_b32 v35, a63
  v_mul_f32 v32, v32, v214
  v_mul_f32 v33, v33, v214
  v_mul_f32 v34, v34, v214
  v_mul_f32 v35, v35, v214
  v_accvgpr_write_b32 a60, v32
  v_accvgpr_write_b32 a61, v33
  v_accvgpr_write_b32 a62, v34
  v_accvgpr_write_b32 a63, v35
  v_accvgpr_read_b32 v32, a64
  v_accvgpr_read_b32 v33, a65
  v_accvgpr_read_b32 v34, a66
  v_accvgpr_read_b32 v35, a67
  v_mul_f32 v32, v32, v215
  v_mul_f32 v33, v33, v215
  v_mul_f32 v34, v34, v215
  v_mul_f32 v35, v35, v215
  v_accvgpr_write_b32 a64, v32
  v_accvgpr_write_b32 a65, v33
  v_accvgpr_write_b32 a66, v34
  v_accvgpr_write_b32 a67, v35
  v_accvgpr_read_b32 v32, a68
  v_accvgpr_read_b32 v33, a69
  v_accvgpr_read_b32 v34, a70
  v_accvgpr_read_b32 v35, a71
  v_mul_f32 v32, v32, v216
  v_mul_f32 v33, v33, v216
  v_mul_f32 v34, v34, v216
  v_mul_f32 v35, v35, v216
  v_accvgpr_write_b32 a68, v32
  v_accvgpr_write_b32 a69, v33
  v_accvgpr_write_b32 a70, v34
  v_accvgpr_write_b32 a71, v35
  v_accvgpr_read_b32 v32, a72
  v_accvgpr_read_b32 v33, a73
  v_accvgpr_read_b32 v34, a74
  v_accvgpr_read_b32 v35, a75
  v_mul_f32 v32, v32, v217
  v_mul_f32 v33, v33, v217
  v_mul_f32 v34, v34, v217
  v_mul_f32 v35, v35, v217
  v_accvgpr_write_b32 a72, v32
  v_accvgpr_write_b32 a73, v33
  v_accvgpr_write_b32 a74, v34
  v_accvgpr_write_b32 a75, v35
  v_accvgpr_read_b32 v32, a76
  v_accvgpr_read_b32 v33, a77
  v_accvgpr_read_b32 v34, a78
  v_accvgpr_read_b32 v35, a79
  v_mul_f32 v32, v32, v218
  v_mul_f32 v33, v33, v218
  v_mul_f32 v34, v34, v218
  v_mul_f32 v35, v35, v218
  v_accvgpr_write_b32 a76, v32
  v_accvgpr_write_b32 a77, v33
  v_accvgpr_write_b32 a78, v34
  v_accvgpr_write_b32 a79, v35
  v_accvgpr_read_b32 v32, a80
  v_accvgpr_read_b32 v33, a81
  v_accvgpr_read_b32 v34, a82
  v_accvgpr_read_b32 v35, a83
  v_mul_f32 v32, v32, v214
  v_mul_f32 v33, v33, v214
  v_mul_f32 v34, v34, v214
  v_mul_f32 v35, v35, v214
  v_accvgpr_write_b32 a80, v32
  v_accvgpr_write_b32 a81, v33
  v_accvgpr_write_b32 a82, v34
  v_accvgpr_write_b32 a83, v35
  v_accvgpr_read_b32 v32, a84
  v_accvgpr_read_b32 v33, a85
  v_accvgpr_read_b32 v34, a86
  v_accvgpr_read_b32 v35, a87
  v_mul_f32 v32, v32, v215
  v_mul_f32 v33, v33, v215
  v_mul_f32 v34, v34, v215
  v_mul_f32 v35, v35, v215
  v_accvgpr_write_b32 a84, v32
  v_accvgpr_write_b32 a85, v33
  v_accvgpr_write_b32 a86, v34
  v_accvgpr_write_b32 a87, v35
  v_accvgpr_read_b32 v32, a88
  v_accvgpr_read_b32 v33, a89
  v_accvgpr_read_b32 v34, a90
  v_accvgpr_read_b32 v35, a91
  v_mul_f32 v32, v32, v216
  v_mul_f32 v33, v33, v216
  v_mul_f32 v34, v34, v216
  v_mul_f32 v35, v35, v216
  v_accvgpr_write_b32 a88, v32
  v_accvgpr_write_b32 a89, v33
  v_accvgpr_write_b32 a90, v34
  v_accvgpr_write_b32 a91, v35
  v_accvgpr_read_b32 v32, a92
  v_accvgpr_read_b32 v33, a93
  v_accvgpr_read_b32 v34, a94
  v_accvgpr_read_b32 v35, a95
  v_mul_f32 v32, v32, v217
  v_mul_f32 v33, v33, v217
  v_mul_f32 v34, v34, v217
  v_mul_f32 v35, v35, v217
  v_accvgpr_write_b32 a92, v32
  v_accvgpr_write_b32 a93, v33
  v_accvgpr_write_b32 a94, v34
  v_accvgpr_write_b32 a95, v35
  v_accvgpr_read_b32 v32, a96
  v_accvgpr_read_b32 v33, a97
  v_accvgpr_read_b32 v34, a98
  v_accvgpr_read_b32 v35, a99
  v_mul_f32 v32, v32, v218
  v_mul_f32 v33, v33, v218
  v_mul_f32 v34, v34, v218
  v_mul_f32 v35, v35, v218
  v_accvgpr_write_b32 a96, v32
  v_accvgpr_write_b32 a97, v33
  v_accvgpr_write_b32 a98, v34
  v_accvgpr_write_b32 a99, v35
  v_accvgpr_read_b32 v32, a100
  v_accvgpr_read_b32 v33, a101
  v_accvgpr_read_b32 v34, a102
  v_accvgpr_read_b32 v35, a103
  v_mul_f32 v32, v32, v214
  v_mul_f32 v33, v33, v214
  v_mul_f32 v34, v34, v214
  v_mul_f32 v35, v35, v214
  v_accvgpr_write_b32 a100, v32
  v_accvgpr_write_b32 a101, v33
  v_accvgpr_write_b32 a102, v34
  v_accvgpr_write_b32 a103, v35
  v_accvgpr_read_b32 v32, a104
  v_accvgpr_read_b32 v33, a105
  v_accvgpr_read_b32 v34, a106
  v_accvgpr_read_b32 v35, a107
  v_mul_f32 v32, v32, v215
  v_mul_f32 v33, v33, v215
  v_mul_f32 v34, v34, v215
  v_mul_f32 v35, v35, v215
  v_accvgpr_write_b32 a104, v32
  v_accvgpr_write_b32 a105, v33
  v_accvgpr_write_b32 a106, v34
  v_accvgpr_write_b32 a107, v35
  v_accvgpr_read_b32 v32, a108
  v_accvgpr_read_b32 v33, a109
  v_accvgpr_read_b32 v34, a110
  v_accvgpr_read_b32 v35, a111
  v_mul_f32 v32, v32, v216
  v_mul_f32 v33, v33, v216
  v_mul_f32 v34, v34, v216
  v_mul_f32 v35, v35, v216
  v_accvgpr_write_b32 a108, v32
  v_accvgpr_write_b32 a109, v33
  v_accvgpr_write_b32 a110, v34
  v_accvgpr_write_b32 a111, v35
  v_accvgpr_read_b32 v32, a112
  v_accvgpr_read_b32 v33, a113
  v_accvgpr_read_b32 v34, a114
  v_accvgpr_read_b32 v35, a115
  v_mul_f32 v32, v32, v217
  v_mul_f32 v33, v33, v217
  v_mul_f32 v34, v34, v217
  v_mul_f32 v35, v35, v217
  v_accvgpr_write_b32 a112, v32
  v_accvgpr_write_b32 a113, v33
  v_accvgpr_write_b32 a114, v34
  v_accvgpr_write_b32 a115, v35
  v_accvgpr_read_b32 v32, a116
  v_accvgpr_read_b32 v33, a117
  v_accvgpr_read_b32 v34, a118
  v_accvgpr_read_b32 v35, a119
  v_mul_f32 v32, v32, v218
  v_mul_f32 v33, v33, v218
  v_mul_f32 v34, v34, v218
  v_mul_f32 v35, v35, v218
  v_accvgpr_write_b32 a116, v32
  v_accvgpr_write_b32 a117, v33
  v_accvgpr_write_b32 a118, v34
  v_accvgpr_write_b32 a119, v35
  v_accvgpr_read_b32 v32, a120
  v_accvgpr_read_b32 v33, a121
  v_accvgpr_read_b32 v34, a122
  v_accvgpr_read_b32 v35, a123
  v_mul_f32 v32, v32, v214
  v_mul_f32 v33, v33, v214
  v_mul_f32 v34, v34, v214
  v_mul_f32 v35, v35, v214
  v_accvgpr_write_b32 a120, v32
  v_accvgpr_write_b32 a121, v33
  v_accvgpr_write_b32 a122, v34
  v_accvgpr_write_b32 a123, v35
  v_accvgpr_read_b32 v32, a124
  v_accvgpr_read_b32 v33, a125
  v_accvgpr_read_b32 v34, a126
  v_accvgpr_read_b32 v35, a127
  v_mul_f32 v32, v32, v215
  v_mul_f32 v33, v33, v215
  v_mul_f32 v34, v34, v215
  v_mul_f32 v35, v35, v215
  v_accvgpr_write_b32 a124, v32
  v_accvgpr_write_b32 a125, v33
  v_accvgpr_write_b32 a126, v34
  v_accvgpr_write_b32 a127, v35
  v_accvgpr_read_b32 v32, a128
  v_accvgpr_read_b32 v33, a129
  v_accvgpr_read_b32 v34, a130
  v_accvgpr_read_b32 v35, a131
  v_mul_f32 v32, v32, v216
  v_mul_f32 v33, v33, v216
  v_mul_f32 v34, v34, v216
  v_mul_f32 v35, v35, v216
  v_accvgpr_write_b32 a128, v32
  v_accvgpr_write_b32 a129, v33
  v_accvgpr_write_b32 a130, v34
  v_accvgpr_write_b32 a131, v35
  v_accvgpr_read_b32 v32, a132
  v_accvgpr_read_b32 v33, a133
  v_accvgpr_read_b32 v34, a134
  v_accvgpr_read_b32 v35, a135
  v_mul_f32 v32, v32, v217
  v_mul_f32 v33, v33, v217
  v_mul_f32 v34, v34, v217
  v_mul_f32 v35, v35, v217
  v_accvgpr_write_b32 a132, v32
  v_accvgpr_write_b32 a133, v33
  v_accvgpr_write_b32 a134, v34
  v_accvgpr_write_b32 a135, v35
  v_accvgpr_read_b32 v32, a136
  v_accvgpr_read_b32 v33, a137
  v_accvgpr_read_b32 v34, a138
  v_accvgpr_read_b32 v35, a139
  v_mul_f32 v32, v32, v218
  v_mul_f32 v33, v33, v218
  v_mul_f32 v34, v34, v218
  v_mul_f32 v35, v35, v218
  v_accvgpr_write_b32 a136, v32
  v_accvgpr_write_b32 a137, v33
  v_accvgpr_write_b32 a138, v34
  v_accvgpr_write_b32 a139, v35
  v_accvgpr_read_b32 v32, a140
  v_accvgpr_read_b32 v33, a141
  v_accvgpr_read_b32 v34, a142
  v_accvgpr_read_b32 v35, a143
  v_mul_f32 v32, v32, v214
  v_mul_f32 v33, v33, v214
  v_mul_f32 v34, v34, v214
  v_mul_f32 v35, v35, v214
  v_accvgpr_write_b32 a140, v32
  v_accvgpr_write_b32 a141, v33
  v_accvgpr_write_b32 a142, v34
  v_accvgpr_write_b32 a143, v35
  v_accvgpr_read_b32 v32, a144
  v_accvgpr_read_b32 v33, a145
  v_accvgpr_read_b32 v34, a146
  v_accvgpr_read_b32 v35, a147
  v_mul_f32 v32, v32, v215
  v_mul_f32 v33, v33, v215
  v_mul_f32 v34, v34, v215
  v_mul_f32 v35, v35, v215
  v_accvgpr_write_b32 a144, v32
  v_accvgpr_write_b32 a145, v33
  v_accvgpr_write_b32 a146, v34
  v_accvgpr_write_b32 a147, v35
  v_accvgpr_read_b32 v32, a148
  v_accvgpr_read_b32 v33, a149
  v_accvgpr_read_b32 v34, a150
  v_accvgpr_read_b32 v35, a151
  v_mul_f32 v32, v32, v216
  v_mul_f32 v33, v33, v216
  v_mul_f32 v34, v34, v216
  v_mul_f32 v35, v35, v216
  v_accvgpr_write_b32 a148, v32
  v_accvgpr_write_b32 a149, v33
  v_accvgpr_write_b32 a150, v34
  v_accvgpr_write_b32 a151, v35
  v_accvgpr_read_b32 v32, a152
  v_accvgpr_read_b32 v33, a153
  v_accvgpr_read_b32 v34, a154
  v_accvgpr_read_b32 v35, a155
  v_mul_f32 v32, v32, v217
  v_mul_f32 v33, v33, v217
  v_mul_f32 v34, v34, v217
  v_mul_f32 v35, v35, v217
  v_accvgpr_write_b32 a152, v32
  v_accvgpr_write_b32 a153, v33
  v_accvgpr_write_b32 a154, v34
  v_accvgpr_write_b32 a155, v35
  v_accvgpr_read_b32 v32, a156
  v_accvgpr_read_b32 v33, a157
  v_accvgpr_read_b32 v34, a158
  v_accvgpr_read_b32 v35, a159
  v_mul_f32 v32, v32, v218
  v_mul_f32 v33, v33, v218
  v_mul_f32 v34, v34, v218
  v_mul_f32 v35, v35, v218
  v_accvgpr_write_b32 a156, v32
  v_accvgpr_write_b32 a157, v33
  v_accvgpr_write_b32 a158, v34
  v_accvgpr_write_b32 a159, v35
  v_exp_f32 v32, v80
  v_exp_f32 v33, v81
  v_exp_f32 v34, v82
  v_add_f32 v27, v32, v33
  v_cvt_pk_bf16_f32 v140, v32, v33
  v_exp_f32 v35, v83
  v_add_f32 v27, v27, v34
  v_exp_f32 v32, v84
  v_add_f32 v27, v27, v35
  v_cvt_pk_bf16_f32 v141, v34, v35
  v_exp_f32 v33, v85
  v_add_f32 v27, v27, v32
  v_exp_f32 v34, v86
  v_add_f32 v27, v27, v33
  v_cvt_pk_bf16_f32 v142, v32, v33
  v_exp_f32 v35, v87
  v_add_f32 v27, v27, v34
  v_exp_f32 v32, v88
  v_add_f32 v27, v27, v35
  v_cvt_pk_bf16_f32 v143, v34, v35
  v_exp_f32 v33, v89
  v_exp_f32 v34, v90
  v_add_f32 v28, v32, v33
  v_cvt_pk_bf16_f32 v144, v32, v33
  v_exp_f32 v35, v91
  v_add_f32 v28, v28, v34
  v_exp_f32 v32, v92
  v_add_f32 v28, v28, v35
  v_cvt_pk_bf16_f32 v145, v34, v35
  v_exp_f32 v33, v93
  v_add_f32 v28, v28, v32
  v_exp_f32 v34, v94
  v_add_f32 v28, v28, v33
  v_cvt_pk_bf16_f32 v146, v32, v33
  v_exp_f32 v35, v95
  v_add_f32 v28, v28, v34
  v_exp_f32 v32, v96
  v_add_f32 v28, v28, v35
  v_cvt_pk_bf16_f32 v147, v34, v35
  v_exp_f32 v33, v97
  v_exp_f32 v34, v98
  v_add_f32 v29, v32, v33
  v_cvt_pk_bf16_f32 v148, v32, v33
  v_exp_f32 v35, v99
  v_add_f32 v29, v29, v34
  v_exp_f32 v32, v100
  v_add_f32 v29, v29, v35
  v_cvt_pk_bf16_f32 v149, v34, v35
  v_exp_f32 v33, v101
  v_add_f32 v29, v29, v32
  v_exp_f32 v34, v102
  v_add_f32 v29, v29, v33
  v_cvt_pk_bf16_f32 v150, v32, v33
  v_exp_f32 v35, v103
  v_add_f32 v29, v29, v34
  v_exp_f32 v32, v104
  v_add_f32 v29, v29, v35
  v_cvt_pk_bf16_f32 v151, v34, v35
  v_exp_f32 v33, v105
  v_exp_f32 v34, v106
  v_add_f32 v30, v32, v33
  v_cvt_pk_bf16_f32 v152, v32, v33
  v_exp_f32 v35, v107
  v_add_f32 v30, v30, v34
  v_exp_f32 v32, v108
  v_add_f32 v30, v30, v35
  v_cvt_pk_bf16_f32 v153, v34, v35
  v_exp_f32 v33, v109
  v_add_f32 v30, v30, v32
  v_exp_f32 v34, v110
  v_add_f32 v30, v30, v33
  v_cvt_pk_bf16_f32 v154, v32, v33
  v_exp_f32 v35, v111
  v_add_f32 v30, v30, v34
  v_exp_f32 v32, v112
  v_add_f32 v30, v30, v35
  v_cvt_pk_bf16_f32 v155, v34, v35
  v_exp_f32 v33, v113
  v_exp_f32 v34, v114
  v_add_f32 v31, v32, v33
  v_cvt_pk_bf16_f32 v156, v32, v33
  v_exp_f32 v35, v115
  v_add_f32 v31, v31, v34
  v_exp_f32 v32, v116
  v_add_f32 v31, v31, v35
  v_cvt_pk_bf16_f32 v157, v34, v35
  v_exp_f32 v33, v117
  v_add_f32 v31, v31, v32
  v_exp_f32 v34, v118
  v_add_f32 v31, v31, v33
  v_cvt_pk_bf16_f32 v158, v32, v33
  v_exp_f32 v35, v119
  v_add_f32 v31, v31, v34
  v_add_f32 v31, v31, v35
  v_cvt_pk_bf16_f32 v159, v34, v35
  s_nop 4
  s_setpc_b64 s[52:53]
.section .rodata,"a"
.p2align 6
.amdhsa_kernel standalone__gqa_block_cached__near_ridge_kernel
  .amdhsa_next_free_vgpr 512
  .amdhsa_next_free_sgpr 102
  .amdhsa_accum_offset 256
  .amdhsa_group_segment_fixed_size 0
  .amdhsa_kernarg_size 64
  .amdhsa_user_sgpr_count 2
  .amdhsa_user_sgpr_kernarg_segment_ptr 1
  .amdhsa_system_sgpr_workgroup_id_x 1
  .amdhsa_float_denorm_mode_32 3
.end_amdhsa_kernel
```
